```python
import torch

def _softmax(x, axis=-1):
    return torch.softmax(x, dim=axis)
def _gelu(x):
    return torch.nn.functional.gelu(x, approximate="tanh")
def _silu(x):
    return torch.nn.functional.silu(x)
def _sigmoid(x):
    return torch.sigmoid(x)
def _layernorm(x, axis=-1, eps=1e-5):
    m = x.mean(dim=axis, keepdim=True)
    v = x.var(dim=axis, keepdim=True, unbiased=False)
    return (x - m) / torch.sqrt(v + eps)
def _scatter_add(tgt, idx, src, axis=0):
    return tgt.clone().index_add_(axis, idx, src)
def _segment_sum(src, seg, n):
    out = torch.zeros((n,) + src.shape[1:], dtype=src.dtype)
    return out.index_add_(0, seg, src)
def _pad(x, pw):
    flat = tuple(v for pair in reversed(pw) for v in pair)
    return torch.nn.functional.pad(x, flat)

kernel_name = 'sequential_preLN__mha_block__mixer_s_mlp__prompt'

def setup_inputs():

    _w = (lambda a: (lambda t: t.to(torch.bfloat16) if t.is_floating_point() else t)(torch.as_tensor(a)))
    def _A_setup():
        B, S, D, H = 1, 2048, 640, 32
        return {
            "x": _w((lambda *s: torch.randn(*s, dtype=torch.bfloat16) * 0.05)(B, S, D)),
            "wqkv": _w((lambda *s: torch.randn(*s, dtype=torch.bfloat16) * 0.05)(D, 3 * D)),
            "wo": _w((lambda *s: torch.randn(*s, dtype=torch.bfloat16) * 0.05)(D, D)),
        }
    _A_in = _A_setup()

    def _B_setup():
        B, S, D, F = 1, 2048, 640, 1728
        return {
            "x":  _w((lambda *s: torch.randn(*s, dtype=torch.bfloat16) * 0.05)(B, S, D)),
            "w1": _w((lambda *s: torch.randn(*s, dtype=torch.bfloat16) * 3.2)(D, D) * (D ** -0.5)),
            "w2": _w((lambda *s: torch.randn(*s, dtype=torch.bfloat16) * 3.2)(D, D) * (D ** -0.5)),
            "w3": _w((lambda *s: torch.randn(*s, dtype=torch.bfloat16) * 3.2)(D, F) * (D ** -0.5)),
            "w4": _w((lambda *s: torch.randn(*s, dtype=torch.bfloat16) * 3.2)(F, D) * (F ** -0.5)),
        }
    _B_in = _B_setup()

    return {
        "A_x": _A_in["x"],
        "A_wqkv": _A_in["wqkv"],
        "A_wo": _A_in["wo"],
        "B_x": _B_in["x"],
        "B_w1": _B_in["w1"],
        "B_w2": _B_in["w2"],
        "B_w3": _B_in["w3"],
        "B_w4": _B_in["w4"],
    }

def reference(A_x, A_wqkv, A_wo, B_x, B_w1, B_w2, B_w3, B_w4):
    def _A_ref(x, wqkv, wo):
        B, S, D = x.shape
        H = 32
        Dh = D // H
        qkv = (lambda x, *d: x.permute(*d))((x @ wqkv).reshape(B, S, 3, H, Dh), 2, 0, 3, 1, 4)
        q, k, v = qkv[0], qkv[1], qkv[2]
        scores = torch.einsum("bhqd,bhkd->bhqk", q, k) * (Dh ** -0.5)
        p = _softmax(scores, axis=-1)
        o = torch.einsum("bhqk,bhkd->bhqd", p, v)
        return (lambda x, *d: x.permute(*d))(o, 0, 2, 1, 3).reshape(B, S, D) @ wo

    def _B_ref(x, w1, w2, w3, w4):
        B, S, D = x.shape
        h = _gelu(_layernorm(x, axis=-1) @ w1)
        c = D // 4
        g0 = _pad(h[:, :, 0*c:1*c], ((0, 0), (1, 0), (0, 0)))[:, :S, :]
        g1 = _pad(h[:, :, 1*c:2*c], ((0, 0), (0, 1), (0, 0)))[:, 1:, :]
        g2 = _pad(h[:, :, 2*c:3*c], ((0, 0), (2, 0), (0, 0)))[:, :S, :]
        g3 = _pad(h[:, :, 3*c:   ], ((0, 0), (0, 2), (0, 0)))[:, 2:, :]
        hs = torch.concatenate([g0, g1, g2, g3], axis=-1) @ w2
        x1 = x + hs
        h2 = _gelu(_layernorm(x1, axis=-1) @ w3) @ w4
        return x1 + h2

    x = A_x
    h = x + _A_ref(_layernorm(x, axis=-1), A_wqkv, A_wo)
    h2 = h + _B_ref(_layernorm(h, axis=-1), B_w1, B_w2, B_w3, B_w4)
    return h2
```

```asm
; @launch grid=(256,1,1) block=(512,1,1) lds=163840
.amdgcn_target "amdgcn-amd-amdhsa--gfx950"
.text
.globl sequential_preLN__mha_block__mixer_s_mlp__prompt_kernel
.p2align 8
.type sequential_preLN__mha_block__mixer_s_mlp__prompt_kernel,@function
sequential_preLN__mha_block__mixer_s_mlp__prompt_kernel:
code_start:
  s_cmp_ge_u32 s2, 256
  s_cbranch_scc1 k1_end
  s_load_dwordx4 s[44:47], s[0:1], 0
  s_load_dwordx2 s[6:7], s[0:1], 80
  s_getpc_b64 s[48:49]
k1_pcref:
  s_lshr_b32 s28, s2, 3
  s_lshl_b32 s27, s28, 11
  v_lshrrev_b32 v254, 5, v0
  v_lshl_add_u32 v254, v254, 7, s27
  v_min_u32 v254, code_end-k1_pcref, v254
  s_mov_b32 exec_lo, 1
  s_mov_b32 exec_hi, 1
  global_load_dword v255, v254, s[48:49]
  s_mov_b64 exec, -1
  v_lshrrev_b32 v1, 6, v0
  v_and_b32 v0, 63, v0
  s_and_b32 s27, s2, 7
  v_readfirstlane_b32 s66, v1
  s_lshr_b32 s25, s27, 1
  s_lshl_b32 s25, s25, 2
  s_and_b32 s29, s28, 3
  s_add_u32 s25, s25, s29
  s_and_b32 s26, s27, 1
  s_lshl_b32 s26, s26, 3
  s_lshr_b32 s29, s28, 2
  s_xor_b32 s29, s29, 7
  s_add_u32 s26, s26, s29
  s_and_b32 s24, s66, 3
  s_cmp_eq_u32 s26, 15
  s_cbranch_scc1 k1_aux
  s_cmp_ge_u32 s66, 4
  s_cbranch_scc1 k1_mfma
  v_lshrrev_b32 v1, 3, v0
  v_mul_u32_u24 v1, 1280, v1
  v_and_b32 v2, 7, v0
  v_lshrrev_b32 v3, 4, v0
  v_xor_b32 v4, v2, v3
  v_lshl_add_u32 v7, v4, 4, v1
  v_xor_b32 v4, 4, v4
  v_lshl_add_u32 v8, v4, 4, v1
  v_add_u32 v8, 9216, v8
  v_add_u32 v9, 18432, v7
  v_add_u32 v10, 18432, v8
  v_mul_u32_u24 v1, 3840, v3
  v_and_b32 v2, 15, v0
  v_lshlrev_b32 v4, 2, v3
  v_xor_b32 v2, v2, v4
  v_lshl_add_u32 v11, v2, 4, v1
  v_add_u32 v12, 14336, v11
  v_add_u32 v13, 28672, v11
  v_add_u32 v14, 43008, v11
  s_lshl_b32 s27, s25, 2
  s_add_u32 s27, s27, s24
  s_mul_i32 s30, s27, 40960
  s_mul_i32 s31, s24, 61440
  s_lshl_b32 s27, s26, 8
  s_add_u32 s31, s31, s27
  s_lshl_b32 s32, s24, 12
  s_waitcnt lgkmcnt(0)
  s_mov_b32 s8, s44
  s_mov_b32 s9, s45
  s_mov_b32 s10, 0x280000
  s_mov_b32 s11, 0x00020000
  s_mov_b32 s12, s46
  s_mov_b32 s13, s47
  s_mov_b32 s14, 0x258000
  s_mov_b32 s15, 0x00020000
  s_add_u32 m0, s32, 0
  s_add_u32 s27, s30, 0
  buffer_load_dwordx4 v7, s[8:11], s27 offen offset:0 lds
  buffer_load_dwordx4 v8, s[8:11], s27 offen offset:1024 lds
  buffer_load_dwordx4 v9, s[8:11], s27 offen offset:2048 lds
  buffer_load_dwordx4 v10, s[8:11], s27 offen offset:3072 lds
  s_add_u32 m0, s32, 16384
  s_add_u32 s27, s31, 0
  buffer_load_dwordx4 v11, s[12:15], s27 offen offset:0 lds
  buffer_load_dwordx4 v12, s[12:15], s27 offen offset:1024 lds
  buffer_load_dwordx4 v13, s[12:15], s27 offen offset:2048 lds
  buffer_load_dwordx4 v14, s[12:15], s27 offen offset:3072 lds
  s_add_u32 m0, s32, 32768
  s_add_u32 s27, s30, 128
  buffer_load_dwordx4 v7, s[8:11], s27 offen offset:0 lds
  buffer_load_dwordx4 v8, s[8:11], s27 offen offset:1024 lds
  buffer_load_dwordx4 v9, s[8:11], s27 offen offset:2048 lds
  buffer_load_dwordx4 v10, s[8:11], s27 offen offset:3072 lds
  s_add_u32 m0, s32, 49152
  s_add_u32 s27, s31, 245760
  buffer_load_dwordx4 v11, s[12:15], s27 offen offset:0 lds
  buffer_load_dwordx4 v12, s[12:15], s27 offen offset:1024 lds
  buffer_load_dwordx4 v13, s[12:15], s27 offen offset:2048 lds
  buffer_load_dwordx4 v14, s[12:15], s27 offen offset:3072 lds
  s_add_u32 m0, s32, 65536
  s_add_u32 s27, s30, 256
  buffer_load_dwordx4 v7, s[8:11], s27 offen offset:0 lds
  buffer_load_dwordx4 v8, s[8:11], s27 offen offset:1024 lds
  buffer_load_dwordx4 v9, s[8:11], s27 offen offset:2048 lds
  buffer_load_dwordx4 v10, s[8:11], s27 offen offset:3072 lds
  s_add_u32 m0, s32, 81920
  s_add_u32 s27, s31, 491520
  buffer_load_dwordx4 v11, s[12:15], s27 offen offset:0 lds
  buffer_load_dwordx4 v12, s[12:15], s27 offen offset:1024 lds
  buffer_load_dwordx4 v13, s[12:15], s27 offen offset:2048 lds
  buffer_load_dwordx4 v14, s[12:15], s27 offen offset:3072 lds
  s_load_dwordx16 s[68:83], s[0:1], 0
  s_waitcnt vmcnt(16)
  s_barrier
  s_add_u32 m0, s32, 98304
  s_add_u32 s27, s30, 384
  buffer_load_dwordx4 v7, s[8:11], s27 offen offset:0 lds
  buffer_load_dwordx4 v8, s[8:11], s27 offen offset:1024 lds
  buffer_load_dwordx4 v9, s[8:11], s27 offen offset:2048 lds
  buffer_load_dwordx4 v10, s[8:11], s27 offen offset:3072 lds
  s_add_u32 m0, s32, 114688
  s_add_u32 s27, s31, 737280
  buffer_load_dwordx4 v11, s[12:15], s27 offen offset:0 lds
  buffer_load_dwordx4 v12, s[12:15], s27 offen offset:1024 lds
  buffer_load_dwordx4 v13, s[12:15], s27 offen offset:2048 lds
  buffer_load_dwordx4 v14, s[12:15], s27 offen offset:3072 lds
  s_waitcnt vmcnt(16)
  s_barrier
  s_add_u32 m0, s32, 131072
  s_add_u32 s27, s30, 512
  buffer_load_dwordx4 v7, s[8:11], s27 offen offset:0 lds
  buffer_load_dwordx4 v8, s[8:11], s27 offen offset:1024 lds
  buffer_load_dwordx4 v9, s[8:11], s27 offen offset:2048 lds
  buffer_load_dwordx4 v10, s[8:11], s27 offen offset:3072 lds
  s_add_u32 m0, s32, 147456
  s_add_u32 s27, s31, 983040
  buffer_load_dwordx4 v11, s[12:15], s27 offen offset:0 lds
  buffer_load_dwordx4 v12, s[12:15], s27 offen offset:1024 lds
  buffer_load_dwordx4 v13, s[12:15], s27 offen offset:2048 lds
  buffer_load_dwordx4 v14, s[12:15], s27 offen offset:3072 lds
  s_waitcnt vmcnt(16)
  s_barrier
  s_add_u32 m0, s32, 0
  s_add_u32 s27, s30, 640
  buffer_load_dwordx4 v7, s[8:11], s27 offen offset:0 lds
  buffer_load_dwordx4 v8, s[8:11], s27 offen offset:1024 lds
  buffer_load_dwordx4 v9, s[8:11], s27 offen offset:2048 lds
  buffer_load_dwordx4 v10, s[8:11], s27 offen offset:3072 lds
  s_add_u32 m0, s32, 16384
  s_add_u32 s27, s31, 1228800
  buffer_load_dwordx4 v11, s[12:15], s27 offen offset:0 lds
  buffer_load_dwordx4 v12, s[12:15], s27 offen offset:1024 lds
  buffer_load_dwordx4 v13, s[12:15], s27 offen offset:2048 lds
  buffer_load_dwordx4 v14, s[12:15], s27 offen offset:3072 lds
  s_waitcnt vmcnt(16)
  s_barrier
  s_add_u32 m0, s32, 32768
  s_add_u32 s27, s30, 768
  buffer_load_dwordx4 v7, s[8:11], s27 offen offset:0 lds
  buffer_load_dwordx4 v8, s[8:11], s27 offen offset:1024 lds
  buffer_load_dwordx4 v9, s[8:11], s27 offen offset:2048 lds
  buffer_load_dwordx4 v10, s[8:11], s27 offen offset:3072 lds
  s_add_u32 m0, s32, 49152
  s_add_u32 s27, s31, 1474560
  buffer_load_dwordx4 v11, s[12:15], s27 offen offset:0 lds
  buffer_load_dwordx4 v12, s[12:15], s27 offen offset:1024 lds
  buffer_load_dwordx4 v13, s[12:15], s27 offen offset:2048 lds
  buffer_load_dwordx4 v14, s[12:15], s27 offen offset:3072 lds
  s_waitcnt vmcnt(16)
  s_barrier
  s_add_u32 m0, s32, 65536
  s_add_u32 s27, s30, 896
  buffer_load_dwordx4 v7, s[8:11], s27 offen offset:0 lds
  buffer_load_dwordx4 v8, s[8:11], s27 offen offset:1024 lds
  buffer_load_dwordx4 v9, s[8:11], s27 offen offset:2048 lds
  buffer_load_dwordx4 v10, s[8:11], s27 offen offset:3072 lds
  s_add_u32 m0, s32, 81920
  s_add_u32 s27, s31, 1720320
  buffer_load_dwordx4 v11, s[12:15], s27 offen offset:0 lds
  buffer_load_dwordx4 v12, s[12:15], s27 offen offset:1024 lds
  buffer_load_dwordx4 v13, s[12:15], s27 offen offset:2048 lds
  buffer_load_dwordx4 v14, s[12:15], s27 offen offset:3072 lds
  s_waitcnt vmcnt(16)
  s_barrier
  s_add_u32 m0, s32, 98304
  s_add_u32 s27, s30, 1024
  buffer_load_dwordx4 v7, s[8:11], s27 offen offset:0 lds
  buffer_load_dwordx4 v8, s[8:11], s27 offen offset:1024 lds
  buffer_load_dwordx4 v9, s[8:11], s27 offen offset:2048 lds
  buffer_load_dwordx4 v10, s[8:11], s27 offen offset:3072 lds
  s_add_u32 m0, s32, 114688
  s_add_u32 s27, s31, 1966080
  buffer_load_dwordx4 v11, s[12:15], s27 offen offset:0 lds
  buffer_load_dwordx4 v12, s[12:15], s27 offen offset:1024 lds
  buffer_load_dwordx4 v13, s[12:15], s27 offen offset:2048 lds
  buffer_load_dwordx4 v14, s[12:15], s27 offen offset:3072 lds
  s_waitcnt vmcnt(16)
  s_barrier
  s_add_u32 m0, s32, 131072
  s_add_u32 s27, s30, 1152
  buffer_load_dwordx4 v7, s[8:11], s27 offen offset:0 lds
  buffer_load_dwordx4 v8, s[8:11], s27 offen offset:1024 lds
  buffer_load_dwordx4 v9, s[8:11], s27 offen offset:2048 lds
  buffer_load_dwordx4 v10, s[8:11], s27 offen offset:3072 lds
  s_add_u32 m0, s32, 147456
  s_add_u32 s27, s31, 2211840
  buffer_load_dwordx4 v11, s[12:15], s27 offen offset:0 lds
  buffer_load_dwordx4 v12, s[12:15], s27 offen offset:1024 lds
  buffer_load_dwordx4 v13, s[12:15], s27 offen offset:2048 lds
  buffer_load_dwordx4 v14, s[12:15], s27 offen offset:3072 lds
  s_waitcnt vmcnt(16)
  s_barrier
  s_waitcnt vmcnt(8)
  s_barrier
  s_waitcnt vmcnt(0)
  s_barrier
  s_barrier
k1_dec:
  s_waitcnt lgkmcnt(0)
  s_lshl_b32 s44, s24, 8
  s_add_u32 s44, s44, s2
  s_add_u32 s44, s44, 0
  s_mov_b32 s38, 1280
  s_mov_b32 s45, 13108
  s_mov_b32 s46, 5
  s_mov_b32 s47, 4
  s_mov_b32 s64, 10
  s_mov_b32 s65, 6554
  s_mov_b32 s84, 102400
  s_mov_b32 s50, 819200
  s_mov_b32 s51, 0x00020000
  s_mov_b32 s48, s72
  s_mov_b32 s49, s73
  s_mov_b32 s85, 0
  s_mov_b32 s86, 0
  s_mov_b32 s42, 0x7f000000
  s_cmp_ge_u32 s44, 200
  s_cselect_b32 s48, s76, s48
  s_cselect_b32 s49, s77, s49
  s_cselect_b32 s86, 200, s86
  s_cselect_b32 s85, 409600, s85
  s_cselect_b32 s42, 0, s42
  s_cmp_ge_u32 s44, 400
  s_cselect_b32 s48, s78, s48
  s_cselect_b32 s49, s79, s49
  s_cselect_b32 s86, 400, s86
  s_cselect_b32 s85, 819200, s85
  s_cselect_b32 s42, 2130706432, s42
  s_cmp_ge_u32 s44, 600
  s_cselect_b32 s48, s82, s48
  s_cselect_b32 s49, s83, s49
  s_cselect_b32 s86, 600, s86
  s_cselect_b32 s85, 2375680, s85
  s_cselect_b32 s50, 2211840, s50
  s_cselect_b32 s84, 276480, s84
  s_cmp_ge_u32 s44, 1140
  s_cselect_b32 s48, s80, s48
  s_cselect_b32 s49, s81, s49
  s_cselect_b32 s86, 1140, s86
  s_cselect_b32 s85, 1228800, s85
  s_cselect_b32 s84, 143360, s84
  s_cselect_b32 s38, 3456, s38
  s_cselect_b32 s45, 9363, s45
  s_cselect_b32 s46, 7, s46
  s_cselect_b32 s47, 8, s47
  s_cselect_b32 s64, 27, s64
  s_cselect_b32 s65, 2428, s65
  s_cselect_b32 s42, 2560, s42
  s_cmp_ge_u32 s44, 1680
  s_cselect_b32 s85, 1879048192, s85
  s_cselect_b32 s50, 0, s50
  s_cselect_b32 s42, 2130706432, s42
  s_sub_u32 s27, s44, s86
  s_mul_i32 s28, s27, s65
  s_lshr_b32 s28, s28, 16
  s_mul_i32 s29, s28, s64
  s_sub_u32 s29, s27, s29
  s_mov_b32 s65, s28
  s_mul_i32 s27, s28, 9728
  s_add_u32 s42, s42, s27
  s_lshl_b32 s27, s29, 8
  s_add_u32 s42, s42, s27
  s_mul_i32 s27, s28, s46
  s_lshl_b32 s27, s27, 10
  s_add_u32 s85, s85, s27
  s_mul_i32 s87, s84, s47
  s_sub_u32 s87, 3538944, s87
  s_mul_i32 s36, s28, s38
  s_lshl_b32 s36, s36, 5
  s_lshl_b32 s27, s29, 7
  s_add_u32 s36, s36, s27
  s_lshl_b32 s27, s29, 2
  s_add_u32 s27, s27, 0
  s_mul_i32 s28, s27, s45
  s_lshr_b32 s28, s28, 16
  s_mul_i32 s35, s28, s46
  s_sub_u32 s27, s27, s35
  s_lshl_b32 s27, s27, 10
  s_mul_i32 s56, s28, s84
  s_add_u32 s56, s56, s27
  s_add_u32 s56, s56, s85
  s_cmp_ge_u32 s28, s47
  s_cselect_b32 s27, s87, 0
  s_add_u32 s56, s56, s27
  s_lshl_b32 s27, s29, 2
  s_add_u32 s27, s27, 1
  s_mul_i32 s28, s27, s45
  s_lshr_b32 s28, s28, 16
  s_mul_i32 s35, s28, s46
  s_sub_u32 s27, s27, s35
  s_lshl_b32 s27, s27, 10
  s_mul_i32 s57, s28, s84
  s_add_u32 s57, s57, s27
  s_add_u32 s57, s57, s85
  s_cmp_ge_u32 s28, s47
  s_cselect_b32 s27, s87, 0
  s_add_u32 s57, s57, s27
  s_lshl_b32 s27, s29, 2
  s_add_u32 s27, s27, 2
  s_mul_i32 s28, s27, s45
  s_lshr_b32 s28, s28, 16
  s_mul_i32 s35, s28, s46
  s_sub_u32 s27, s27, s35
  s_lshl_b32 s27, s27, 10
  s_mul_i32 s58, s28, s84
  s_add_u32 s58, s58, s27
  s_add_u32 s58, s58, s85
  s_cmp_ge_u32 s28, s47
  s_cselect_b32 s27, s87, 0
  s_add_u32 s58, s58, s27
  s_lshl_b32 s27, s29, 2
  s_add_u32 s27, s27, 3
  s_mul_i32 s28, s27, s45
  s_lshr_b32 s28, s28, 16
  s_mul_i32 s35, s28, s46
  s_sub_u32 s27, s27, s35
  s_lshl_b32 s27, s27, 10
  s_mul_i32 s59, s28, s84
  s_add_u32 s59, s59, s27
  s_add_u32 s59, s59, s85
  s_cmp_ge_u32 s28, s47
  s_cselect_b32 s27, s87, 0
  s_add_u32 s59, s59, s27
  s_mov_b32 s45, 8
  s_mov_b32 s46, 8
  s_mov_b32 s47, 4
  s_mov_b32 s64, 0
  s_mul_i32 s27, s65, 10240
  s_cmp_lt_u32 s44, 200
  s_cselect_b32 s45, 40, s45
  s_cselect_b32 s46, 40, s46
  s_cselect_b32 s47, 20, s47
  s_mul_i32 s28, s65, 163840
  s_sub_u32 s28, s28, 3256320
  s_cmp_lt_u32 s44, 200
  s_cselect_b32 s64, s28, s64
  s_cmp_lt_u32 s44, 160
  s_cselect_b32 s45, 4, s45
  s_cselect_b32 s46, 16, s46
  s_cselect_b32 s47, 8, s47
  s_cselect_b32 s64, s27, s64
  s_add_u32 s36, s36, s64
  v_bfe_u32 v34, v0, 3, 2
  v_lshrrev_b32 v35, 5, v0
  v_mul_u32_u24 v35, s47, v35
  v_add_u32 v34, v34, v35
  v_and_b32 v35, 7, v0
  v_mul_lo_u32 v140, v34, s38
  v_lshl_add_u32 v140, v35, 4, v140
  s_mul_i32 s33, s38, s46
  s_sub_u32 s33, s33, 1024
  s_mul_i32 s38, s38, s45
  s_sub_u32 s38, s38, 1024
  s_lshl_b32 s44, s24, 8
  s_add_u32 s44, s44, s2
  s_add_u32 s44, s44, 1024
  s_mov_b32 s39, 1280
  s_mov_b32 s45, 13108
  s_mov_b32 s46, 5
  s_mov_b32 s47, 4
  s_mov_b32 s64, 10
  s_mov_b32 s65, 6554
  s_mov_b32 s84, 102400
  s_mov_b32 s54, 819200
  s_mov_b32 s55, 0x00020000
  s_mov_b32 s52, s72
  s_mov_b32 s53, s73
  s_mov_b32 s85, 0
  s_mov_b32 s86, 0
  s_mov_b32 s43, 0x7f000000
  s_cmp_ge_u32 s44, 200
  s_cselect_b32 s52, s76, s52
  s_cselect_b32 s53, s77, s53
  s_cselect_b32 s86, 200, s86
  s_cselect_b32 s85, 409600, s85
  s_cselect_b32 s43, 0, s43
  s_cmp_ge_u32 s44, 400
  s_cselect_b32 s52, s78, s52
  s_cselect_b32 s53, s79, s53
  s_cselect_b32 s86, 400, s86
  s_cselect_b32 s85, 819200, s85
  s_cselect_b32 s43, 2130706432, s43
  s_cmp_ge_u32 s44, 600
  s_cselect_b32 s52, s82, s52
  s_cselect_b32 s53, s83, s53
  s_cselect_b32 s86, 600, s86
  s_cselect_b32 s85, 2375680, s85
  s_cselect_b32 s54, 2211840, s54
  s_cselect_b32 s84, 276480, s84
  s_cmp_ge_u32 s44, 1140
  s_cselect_b32 s52, s80, s52
  s_cselect_b32 s53, s81, s53
  s_cselect_b32 s86, 1140, s86
  s_cselect_b32 s85, 1228800, s85
  s_cselect_b32 s84, 143360, s84
  s_cselect_b32 s39, 3456, s39
  s_cselect_b32 s45, 9363, s45
  s_cselect_b32 s46, 7, s46
  s_cselect_b32 s47, 8, s47
  s_cselect_b32 s64, 27, s64
  s_cselect_b32 s65, 2428, s65
  s_cselect_b32 s43, 2560, s43
  s_cmp_ge_u32 s44, 1680
  s_cselect_b32 s85, 1879048192, s85
  s_cselect_b32 s54, 0, s54
  s_cselect_b32 s43, 2130706432, s43
  s_sub_u32 s27, s44, s86
  s_mul_i32 s28, s27, s65
  s_lshr_b32 s28, s28, 16
  s_mul_i32 s29, s28, s64
  s_sub_u32 s29, s27, s29
  s_mov_b32 s65, s28
  s_mul_i32 s27, s28, 9728
  s_add_u32 s43, s43, s27
  s_lshl_b32 s27, s29, 8
  s_add_u32 s43, s43, s27
  s_mul_i32 s27, s28, s46
  s_lshl_b32 s27, s27, 10
  s_add_u32 s85, s85, s27
  s_mul_i32 s87, s84, s47
  s_sub_u32 s87, 3538944, s87
  s_mul_i32 s37, s28, s39
  s_lshl_b32 s37, s37, 5
  s_lshl_b32 s27, s29, 7
  s_add_u32 s37, s37, s27
  s_lshl_b32 s27, s29, 2
  s_add_u32 s27, s27, 0
  s_mul_i32 s28, s27, s45
  s_lshr_b32 s28, s28, 16
  s_mul_i32 s35, s28, s46
  s_sub_u32 s27, s27, s35
  s_lshl_b32 s27, s27, 10
  s_mul_i32 s60, s28, s84
  s_add_u32 s60, s60, s27
  s_add_u32 s60, s60, s85
  s_cmp_ge_u32 s28, s47
  s_cselect_b32 s27, s87, 0
  s_add_u32 s60, s60, s27
  s_lshl_b32 s27, s29, 2
  s_add_u32 s27, s27, 1
  s_mul_i32 s28, s27, s45
  s_lshr_b32 s28, s28, 16
  s_mul_i32 s35, s28, s46
  s_sub_u32 s27, s27, s35
  s_lshl_b32 s27, s27, 10
  s_mul_i32 s61, s28, s84
  s_add_u32 s61, s61, s27
  s_add_u32 s61, s61, s85
  s_cmp_ge_u32 s28, s47
  s_cselect_b32 s27, s87, 0
  s_add_u32 s61, s61, s27
  s_lshl_b32 s27, s29, 2
  s_add_u32 s27, s27, 2
  s_mul_i32 s28, s27, s45
  s_lshr_b32 s28, s28, 16
  s_mul_i32 s35, s28, s46
  s_sub_u32 s27, s27, s35
  s_lshl_b32 s27, s27, 10
  s_mul_i32 s62, s28, s84
  s_add_u32 s62, s62, s27
  s_add_u32 s62, s62, s85
  s_cmp_ge_u32 s28, s47
  s_cselect_b32 s27, s87, 0
  s_add_u32 s62, s62, s27
  s_lshl_b32 s27, s29, 2
  s_add_u32 s27, s27, 3
  s_mul_i32 s28, s27, s45
  s_lshr_b32 s28, s28, 16
  s_mul_i32 s35, s28, s46
  s_sub_u32 s27, s27, s35
  s_lshl_b32 s27, s27, 10
  s_mul_i32 s63, s28, s84
  s_add_u32 s63, s63, s27
  s_add_u32 s63, s63, s85
  s_cmp_ge_u32 s28, s47
  s_cselect_b32 s27, s87, 0
  s_add_u32 s63, s63, s27
  s_mov_b32 s45, 8
  s_mov_b32 s46, 8
  s_mov_b32 s47, 4
  s_mov_b32 s64, 0
  s_mul_i32 s27, s65, 10240
  s_cmp_lt_u32 s44, 200
  s_cselect_b32 s45, 40, s45
  s_cselect_b32 s46, 40, s46
  s_cselect_b32 s47, 20, s47
  s_mul_i32 s28, s65, 163840
  s_sub_u32 s28, s28, 3256320
  s_cmp_lt_u32 s44, 200
  s_cselect_b32 s64, s28, s64
  s_cmp_lt_u32 s44, 160
  s_cselect_b32 s45, 4, s45
  s_cselect_b32 s46, 16, s46
  s_cselect_b32 s47, 8, s47
  s_cselect_b32 s64, s27, s64
  s_add_u32 s37, s37, s64
  v_bfe_u32 v34, v0, 3, 2
  v_lshrrev_b32 v35, 5, v0
  v_mul_u32_u24 v35, s47, v35
  v_add_u32 v34, v34, v35
  v_and_b32 v35, 7, v0
  v_mul_lo_u32 v141, v34, s39
  v_lshl_add_u32 v141, v35, 4, v141
  s_mul_i32 s34, s39, s46
  s_sub_u32 s34, s34, 1024
  s_mul_i32 s39, s39, s45
  s_sub_u32 s39, s39, 1024
  v_lshrrev_b32 v34, 4, v0
  v_bfe_u32 v35, v0, 2, 2
  v_lshl_add_u32 v34, v34, 3, v35
  v_and_b32 v35, 3, v0
  v_lshlrev_b32 v35, 3, v35
  v_lshl_add_u32 v142, v34, 7, v35
  s_lshl_b32 s35, s24, 13
  v_add_u32 v142, s35, v142
  v_lshlrev_b32 v143, 4, v0
  v_mov_b32 v176, 0x3f803f80
  v_mov_b32 v177, 0x3f803f80
  v_mov_b32 v178, 0x3f803f80
  v_mov_b32 v179, 0x3f803f80
  s_lshl_b32 s67, s26, 11
  s_lshl_b32 s28, s25, 7
  s_add_u32 s67, s67, s28
  s_add_u32 s67, s67, 65536
  s_mov_b64 exec, -1
  s_setprio 0
  s_branch k2_entry
k1_mfma:
  s_load_dwordx2 s[50:51], s[0:1], 72
  s_waitcnt lgkmcnt(0)
  s_lshr_b32 s35, s24, 1
  s_and_b32 s36, s24, 1
  s_mov_b32 s34, 0x3f803f80
  v_and_b32 v45, 31, v0
  v_lshrrev_b32 v46, 5, v0
  v_bfe_u32 v1, v0, 1, 3
  v_xor_b32 v1, v1, v46
  s_lshl_b32 s27, s24, 12
  s_xor_b32 s28, s27, 4096
  v_lshlrev_b32 v2, 7, v45
  v_xor_b32 v3, 0, v1
  v_lshl_add_u32 v3, v3, 4, v2
  v_add_u32 v15, s27, v3
  v_add_u32 v19, s28, v3
  v_xor_b32 v3, 2, v1
  v_lshl_add_u32 v3, v3, 4, v2
  v_add_u32 v16, s27, v3
  v_add_u32 v20, s28, v3
  v_xor_b32 v3, 4, v1
  v_lshl_add_u32 v3, v3, 4, v2
  v_add_u32 v17, s27, v3
  v_add_u32 v21, s28, v3
  v_xor_b32 v3, 6, v1
  v_lshl_add_u32 v3, v3, 4, v2
  v_add_u32 v18, s27, v3
  v_add_u32 v22, s28, v3
  s_lshl_b32 s27, s36, 1
  s_add_u32 s27, s27, s35
  v_bfe_u32 v1, v0, 2, 2
  v_lshl_add_u32 v2, v46, 3, v1
  v_lshlrev_b32 v2, 8, v2
  v_bfe_u32 v3, v0, 4, 1
  v_lshl_add_u32 v2, v3, 5, v2
  v_and_b32 v3, 3, v0
  v_lshl_add_u32 v2, v3, 3, v2
  v_add_u32 v2, 16384, v2
  v_xor_b32 v3, s27, v1
  v_lshl_add_u32 v39, v3, 6, v2
  v_xor_b32 v3, 1, v3
  v_lshl_add_u32 v40, v3, 6, v2
  v_add_u32 v23, 65536, v15
  v_add_u32 v24, 65536, v16
  v_add_u32 v25, 65536, v17
  v_add_u32 v26, 65536, v18
  v_add_u32 v41, 65536, v39
  v_add_u32 v27, 65536, v19
  v_add_u32 v28, 65536, v20
  v_add_u32 v29, 65536, v21
  v_add_u32 v30, 65536, v22
  v_add_u32 v42, 65536, v40
  v_add_u32 v31, 131072, v15
  v_add_u32 v32, 131072, v16
  v_add_u32 v33, 131072, v17
  v_add_u32 v34, 131072, v18
  v_add_u32 v43, 131072, v39
  v_add_u32 v35, 131072, v19
  v_add_u32 v36, 131072, v20
  v_add_u32 v37, 131072, v21
  v_add_u32 v38, 131072, v22
  v_add_u32 v44, 131072, v40
  s_add_u32 s52, s6, 0x25b0000
  s_addc_u32 s53, s7, 0
  s_mov_b32 s54, 0x4000
  s_mov_b32 s55, 0x00020000
  s_lshl_b32 s28, s25, 4
  v_mov_b32 v159, s28
  s_mov_b32 s42, 400000
  s_lshl_b32 s43, s25, 9
  s_add_u32 s41, s43, 8192
  v_mov_b32 v156, 0
  v_mov_b32 v157, 0
  v_mov_b32 v158, 0
  s_mov_b32 s40, s27
  s_cmp_ge_u32 s26, 10
  s_cbranch_scc1 k1_vpath
  s_cmp_lt_u32 s26, 5
  s_mov_b32 s37, 163840
  s_cselect_b32 s37, 81920, s37
  s_mov_b32 s38, 2560
  s_cselect_b32 s38, 1280, s38
  s_cselect_b32 s39, 0x3ea52b5c, 1.0
  s_cselect_b32 s28, 0, 2621440
  s_cselect_b32 s29, 0, 5
  s_add_u32 s16, s6, s28
  s_addc_u32 s17, s7, 0
  s_mov_b32 s18, 5242880
  s_mov_b32 s19, 0x00020000
  s_sub_u32 s29, s26, s29
  s_lshl_b32 s29, s29, 4
  s_lshl_b32 s44, s37, 1
  s_sub_u32 s45, s37, 1536
  s_xor_b32 s27, s40, 0
  s_lshl_b32 s27, s27, 2
  s_add_u32 s27, s27, s29
  v_add_u32 v1, s27, v46
  v_add_u32 v1, 0, v1
  v_mul_u32_u24 v2, 205, v1
  v_lshrrev_b32 v2, 10, v2
  v_mul_u32_u24 v3, 5, v2
  v_sub_u32 v3, v1, v3
  v_mul_lo_u32 v160, v2, s44
  v_lshl_add_u32 v160, v3, 9, v160
  v_mov_b32 v4, s45
  v_cmp_lt_u32 vcc, 2, v3
  s_nop 1
  v_cndmask_b32 v4, 0, v4, vcc
  v_add_u32 v160, v160, v4
  v_cmp_eq_u32 s[56:57], 2, v3
  s_nop 1
  v_cndmask_b32_e64 v4, 4, 3, s[56:57]
  v_lshlrev_b32 v4, v4, v45
  v_add_u32 v160, v160, v4
  v_add_u32 v1, s27, v46
  v_add_u32 v1, 2, v1
  v_mul_u32_u24 v2, 205, v1
  v_lshrrev_b32 v2, 10, v2
  v_mul_u32_u24 v3, 5, v2
  v_sub_u32 v3, v1, v3
  v_mul_lo_u32 v161, v2, s44
  v_lshl_add_u32 v161, v3, 9, v161
  v_mov_b32 v4, s45
  v_cmp_lt_u32 vcc, 2, v3
  s_nop 1
  v_cndmask_b32 v4, 0, v4, vcc
  v_add_u32 v161, v161, v4
  v_cmp_eq_u32 s[58:59], 2, v3
  s_nop 1
  v_cndmask_b32_e64 v4, 4, 3, s[58:59]
  v_lshlrev_b32 v4, v4, v45
  v_add_u32 v161, v161, v4
  s_xor_b32 s27, s40, 1
  s_lshl_b32 s27, s27, 2
  s_add_u32 s27, s27, s29
  v_add_u32 v1, s27, v46
  v_add_u32 v1, 0, v1
  v_mul_u32_u24 v2, 205, v1
  v_lshrrev_b32 v2, 10, v2
  v_mul_u32_u24 v3, 5, v2
  v_sub_u32 v3, v1, v3
  v_mul_lo_u32 v162, v2, s44
  v_lshl_add_u32 v162, v3, 9, v162
  v_mov_b32 v4, s45
  v_cmp_lt_u32 vcc, 2, v3
  s_nop 1
  v_cndmask_b32 v4, 0, v4, vcc
  v_add_u32 v162, v162, v4
  v_cmp_eq_u32 s[60:61], 2, v3
  s_nop 1
  v_cndmask_b32_e64 v4, 4, 3, s[60:61]
  v_lshlrev_b32 v4, v4, v45
  v_add_u32 v162, v162, v4
  v_add_u32 v1, s27, v46
  v_add_u32 v1, 2, v1
  v_mul_u32_u24 v2, 205, v1
  v_lshrrev_b32 v2, 10, v2
  v_mul_u32_u24 v3, 5, v2
  v_sub_u32 v3, v1, v3
  v_mul_lo_u32 v163, v2, s44
  v_lshl_add_u32 v163, v3, 9, v163
  v_mov_b32 v4, s45
  v_cmp_lt_u32 vcc, 2, v3
  s_nop 1
  v_cndmask_b32 v4, 0, v4, vcc
  v_add_u32 v163, v163, v4
  v_cmp_eq_u32 s[62:63], 2, v3
  s_nop 1
  v_cndmask_b32_e64 v4, 4, 3, s[62:63]
  v_lshlrev_b32 v4, v4, v45
  v_add_u32 v163, v163, v4
  s_setprio 2
  s_barrier
  ds_read_b128 v[112:115], v15 offset:0
  ds_read_b64_tr_b16 v[128:129], v39 offset:0
  ds_read_b64_tr_b16 v[130:131], v39 offset:1024
  ds_read_b64_tr_b16 v[148:149], v40 offset:0
  ds_read_b64_tr_b16 v[150:151], v40 offset:1024
  ds_read_b128 v[116:119], v19 offset:0
  s_waitcnt lgkmcnt(3)
  v_mfma_f32_32x32x16_bf16 v[48:63], v[128:131], v[112:115], 0
  ds_read_b128 v[120:123], v16 offset:0
  ds_read_b64_tr_b16 v[132:133], v39 offset:4096
  ds_read_b64_tr_b16 v[134:135], v39 offset:5120
  s_waitcnt lgkmcnt(4)
  v_mfma_f32_32x32x16_bf16 v[64:79], v[148:151], v[112:115], 0
  ds_read_b64_tr_b16 v[152:153], v40 offset:4096
  ds_read_b64_tr_b16 v[154:155], v40 offset:5120
  s_waitcnt lgkmcnt(5)
  v_mfma_f32_32x32x16_bf16 v[80:95], v[128:131], v[116:119], 0
  ds_read_b128 v[124:127], v20 offset:0
  v_mfma_f32_32x32x16_bf16 v[96:111], v[148:151], v[116:119], 0
  s_waitcnt lgkmcnt(3)
  v_mfma_f32_32x32x16_bf16 v[48:63], v[132:135], v[120:123], v[48:63]
  ds_read_b128 v[112:115], v17 offset:0
  ds_read_b64_tr_b16 v[136:137], v39 offset:8192
  ds_read_b64_tr_b16 v[138:139], v39 offset:9216
  s_waitcnt lgkmcnt(4)
  v_mfma_f32_32x32x16_bf16 v[64:79], v[152:155], v[120:123], v[64:79]
  ds_read_b64_tr_b16 v[148:149], v40 offset:8192
  ds_read_b64_tr_b16 v[150:151], v40 offset:9216
  s_waitcnt lgkmcnt(5)
  v_mfma_f32_32x32x16_bf16 v[80:95], v[132:135], v[124:127], v[80:95]
  ds_read_b128 v[116:119], v21 offset:0
  v_mfma_f32_32x32x16_bf16 v[96:111], v[152:155], v[124:127], v[96:111]
  s_waitcnt lgkmcnt(3)
  v_mfma_f32_32x32x16_bf16 v[48:63], v[136:139], v[112:115], v[48:63]
  ds_read_b128 v[120:123], v18 offset:0
  ds_read_b64_tr_b16 v[140:141], v39 offset:12288
  ds_read_b64_tr_b16 v[142:143], v39 offset:13312
  s_waitcnt lgkmcnt(4)
  v_mfma_f32_32x32x16_bf16 v[64:79], v[148:151], v[112:115], v[64:79]
  ds_read_b64_tr_b16 v[152:153], v40 offset:12288
  ds_read_b64_tr_b16 v[154:155], v40 offset:13312
  s_waitcnt lgkmcnt(5)
  v_mfma_f32_32x32x16_bf16 v[80:95], v[136:139], v[116:119], v[80:95]
  ds_read_b128 v[124:127], v22 offset:0
  v_mfma_f32_32x32x16_bf16 v[96:111], v[148:151], v[116:119], v[96:111]
  s_waitcnt lgkmcnt(3)
  v_mfma_f32_32x32x16_bf16 v[48:63], v[140:143], v[120:123], v[48:63]
  s_barrier
  ds_read_b128 v[112:115], v15 offset:32768
  ds_read_b64_tr_b16 v[144:145], v39 offset:32768
  ds_read_b64_tr_b16 v[146:147], v39 offset:33792
  s_waitcnt lgkmcnt(4)
  v_mfma_f32_32x32x16_bf16 v[64:79], v[152:155], v[120:123], v[64:79]
  ds_read_b64_tr_b16 v[148:149], v40 offset:32768
  ds_read_b64_tr_b16 v[150:151], v40 offset:33792
  s_waitcnt lgkmcnt(5)
  v_mfma_f32_32x32x16_bf16 v[80:95], v[140:143], v[124:127], v[80:95]
  ds_read_b128 v[116:119], v19 offset:32768
  v_mfma_f32_32x32x16_bf16 v[96:111], v[152:155], v[124:127], v[96:111]
  v_dot2_f32_bf16 v158, v128, s34, v158
  v_dot2_f32_bf16 v156, v129, s34, v156
  v_dot2_f32_bf16 v158, v130, s34, v158
  v_dot2_f32_bf16 v156, v131, s34, v156
  v_dot2_f32_bf16 v158, v132, s34, v158
  v_dot2_f32_bf16 v156, v133, s34, v156
  v_dot2_f32_bf16 v158, v134, s34, v158
  v_dot2_f32_bf16 v156, v135, s34, v156
  v_dot2_f32_bf16 v158, v136, s34, v158
  v_dot2_f32_bf16 v156, v137, s34, v156
  v_dot2_f32_bf16 v158, v138, s34, v158
  v_dot2_f32_bf16 v156, v139, s34, v156
  v_dot2_f32_bf16 v158, v140, s34, v158
  v_dot2_f32_bf16 v156, v141, s34, v156
  v_dot2_f32_bf16 v158, v142, s34, v158
  v_dot2_f32_bf16 v156, v143, s34, v156
  s_waitcnt lgkmcnt(3)
  v_mfma_f32_32x32x16_bf16 v[48:63], v[144:147], v[112:115], v[48:63]
  ds_read_b128 v[120:123], v16 offset:32768
  ds_read_b64_tr_b16 v[128:129], v39 offset:36864
  ds_read_b64_tr_b16 v[130:131], v39 offset:37888
  s_waitcnt lgkmcnt(4)
  v_mfma_f32_32x32x16_bf16 v[64:79], v[148:151], v[112:115], v[64:79]
  ds_read_b64_tr_b16 v[152:153], v40 offset:36864
  ds_read_b64_tr_b16 v[154:155], v40 offset:37888
  s_waitcnt lgkmcnt(5)
  v_mfma_f32_32x32x16_bf16 v[80:95], v[144:147], v[116:119], v[80:95]
  ds_read_b128 v[124:127], v20 offset:32768
  v_mfma_f32_32x32x16_bf16 v[96:111], v[148:151], v[116:119], v[96:111]
  s_waitcnt lgkmcnt(3)
  v_mfma_f32_32x32x16_bf16 v[48:63], v[128:131], v[120:123], v[48:63]
  ds_read_b128 v[112:115], v17 offset:32768
  ds_read_b64_tr_b16 v[132:133], v39 offset:40960
  ds_read_b64_tr_b16 v[134:135], v39 offset:41984
  s_waitcnt lgkmcnt(4)
  v_mfma_f32_32x32x16_bf16 v[64:79], v[152:155], v[120:123], v[64:79]
  ds_read_b64_tr_b16 v[148:149], v40 offset:40960
  ds_read_b64_tr_b16 v[150:151], v40 offset:41984
  s_waitcnt lgkmcnt(5)
  v_mfma_f32_32x32x16_bf16 v[80:95], v[128:131], v[124:127], v[80:95]
  ds_read_b128 v[116:119], v21 offset:32768
  v_mfma_f32_32x32x16_bf16 v[96:111], v[152:155], v[124:127], v[96:111]
  s_waitcnt lgkmcnt(3)
  v_mfma_f32_32x32x16_bf16 v[48:63], v[132:135], v[112:115], v[48:63]
  ds_read_b128 v[120:123], v18 offset:32768
  ds_read_b64_tr_b16 v[136:137], v39 offset:45056
  ds_read_b64_tr_b16 v[138:139], v39 offset:46080
  s_waitcnt lgkmcnt(4)
  v_mfma_f32_32x32x16_bf16 v[64:79], v[148:151], v[112:115], v[64:79]
  ds_read_b64_tr_b16 v[152:153], v40 offset:45056
  ds_read_b64_tr_b16 v[154:155], v40 offset:46080
  s_waitcnt lgkmcnt(5)
  v_mfma_f32_32x32x16_bf16 v[80:95], v[132:135], v[116:119], v[80:95]
  ds_read_b128 v[124:127], v22 offset:32768
  v_mfma_f32_32x32x16_bf16 v[96:111], v[148:151], v[116:119], v[96:111]
  s_waitcnt lgkmcnt(3)
  v_mfma_f32_32x32x16_bf16 v[48:63], v[136:139], v[120:123], v[48:63]
  s_barrier
  ds_read_b128 v[112:115], v23 offset:0
  ds_read_b64_tr_b16 v[140:141], v41 offset:0
  ds_read_b64_tr_b16 v[142:143], v41 offset:1024
  s_waitcnt lgkmcnt(4)
  v_mfma_f32_32x32x16_bf16 v[64:79], v[152:155], v[120:123], v[64:79]
  ds_read_b64_tr_b16 v[148:149], v42 offset:0
  ds_read_b64_tr_b16 v[150:151], v42 offset:1024
  s_waitcnt lgkmcnt(5)
  v_mfma_f32_32x32x16_bf16 v[80:95], v[136:139], v[124:127], v[80:95]
  ds_read_b128 v[116:119], v27 offset:0
  v_mfma_f32_32x32x16_bf16 v[96:111], v[152:155], v[124:127], v[96:111]
  v_dot2_f32_bf16 v158, v144, s34, v158
  v_dot2_f32_bf16 v156, v145, s34, v156
  v_dot2_f32_bf16 v158, v146, s34, v158
  v_dot2_f32_bf16 v156, v147, s34, v156
  v_dot2_f32_bf16 v158, v128, s34, v158
  v_dot2_f32_bf16 v156, v129, s34, v156
  v_dot2_f32_bf16 v158, v130, s34, v158
  v_dot2_f32_bf16 v156, v131, s34, v156
  v_dot2_f32_bf16 v158, v132, s34, v158
  v_dot2_f32_bf16 v156, v133, s34, v156
  v_dot2_f32_bf16 v158, v134, s34, v158
  v_dot2_f32_bf16 v156, v135, s34, v156
  v_dot2_f32_bf16 v158, v136, s34, v158
  v_dot2_f32_bf16 v156, v137, s34, v156
  v_dot2_f32_bf16 v158, v138, s34, v158
  v_dot2_f32_bf16 v156, v139, s34, v156
  s_waitcnt lgkmcnt(3)
  v_mfma_f32_32x32x16_bf16 v[48:63], v[140:143], v[112:115], v[48:63]
  ds_read_b128 v[120:123], v24 offset:0
  ds_read_b64_tr_b16 v[144:145], v41 offset:4096
  ds_read_b64_tr_b16 v[146:147], v41 offset:5120
  s_waitcnt lgkmcnt(4)
  v_mfma_f32_32x32x16_bf16 v[64:79], v[148:151], v[112:115], v[64:79]
  ds_read_b64_tr_b16 v[152:153], v42 offset:4096
  ds_read_b64_tr_b16 v[154:155], v42 offset:5120
  s_waitcnt lgkmcnt(5)
  v_mfma_f32_32x32x16_bf16 v[80:95], v[140:143], v[116:119], v[80:95]
  ds_read_b128 v[124:127], v28 offset:0
  v_mfma_f32_32x32x16_bf16 v[96:111], v[148:151], v[116:119], v[96:111]
  s_waitcnt lgkmcnt(3)
  v_mfma_f32_32x32x16_bf16 v[48:63], v[144:147], v[120:123], v[48:63]
  ds_read_b128 v[112:115], v25 offset:0
  ds_read_b64_tr_b16 v[128:129], v41 offset:8192
  ds_read_b64_tr_b16 v[130:131], v41 offset:9216
  s_waitcnt lgkmcnt(4)
  v_mfma_f32_32x32x16_bf16 v[64:79], v[152:155], v[120:123], v[64:79]
  ds_read_b64_tr_b16 v[148:149], v42 offset:8192
  ds_read_b64_tr_b16 v[150:151], v42 offset:9216
  s_waitcnt lgkmcnt(5)
  v_mfma_f32_32x32x16_bf16 v[80:95], v[144:147], v[124:127], v[80:95]
  ds_read_b128 v[116:119], v29 offset:0
  v_mfma_f32_32x32x16_bf16 v[96:111], v[152:155], v[124:127], v[96:111]
  s_waitcnt lgkmcnt(3)
  v_mfma_f32_32x32x16_bf16 v[48:63], v[128:131], v[112:115], v[48:63]
  ds_read_b128 v[120:123], v26 offset:0
  ds_read_b64_tr_b16 v[132:133], v41 offset:12288
  ds_read_b64_tr_b16 v[134:135], v41 offset:13312
  s_waitcnt lgkmcnt(4)
  v_mfma_f32_32x32x16_bf16 v[64:79], v[148:151], v[112:115], v[64:79]
  ds_read_b64_tr_b16 v[152:153], v42 offset:12288
  ds_read_b64_tr_b16 v[154:155], v42 offset:13312
  s_waitcnt lgkmcnt(5)
  v_mfma_f32_32x32x16_bf16 v[80:95], v[128:131], v[116:119], v[80:95]
  ds_read_b128 v[124:127], v30 offset:0
  v_mfma_f32_32x32x16_bf16 v[96:111], v[148:151], v[116:119], v[96:111]
  s_waitcnt lgkmcnt(3)
  v_mfma_f32_32x32x16_bf16 v[48:63], v[132:135], v[120:123], v[48:63]
  s_barrier
  ds_read_b128 v[112:115], v23 offset:32768
  ds_read_b64_tr_b16 v[136:137], v41 offset:32768
  ds_read_b64_tr_b16 v[138:139], v41 offset:33792
  s_waitcnt lgkmcnt(4)
  v_mfma_f32_32x32x16_bf16 v[64:79], v[152:155], v[120:123], v[64:79]
  ds_read_b64_tr_b16 v[148:149], v42 offset:32768
  ds_read_b64_tr_b16 v[150:151], v42 offset:33792
  s_waitcnt lgkmcnt(5)
  v_mfma_f32_32x32x16_bf16 v[80:95], v[132:135], v[124:127], v[80:95]
  ds_read_b128 v[116:119], v27 offset:32768
  v_mfma_f32_32x32x16_bf16 v[96:111], v[152:155], v[124:127], v[96:111]
  v_dot2_f32_bf16 v158, v140, s34, v158
  v_dot2_f32_bf16 v156, v141, s34, v156
  v_dot2_f32_bf16 v158, v142, s34, v158
  v_dot2_f32_bf16 v156, v143, s34, v156
  v_dot2_f32_bf16 v158, v144, s34, v158
  v_dot2_f32_bf16 v156, v145, s34, v156
  v_dot2_f32_bf16 v158, v146, s34, v158
  v_dot2_f32_bf16 v156, v147, s34, v156
  v_dot2_f32_bf16 v158, v128, s34, v158
  v_dot2_f32_bf16 v156, v129, s34, v156
  v_dot2_f32_bf16 v158, v130, s34, v158
  v_dot2_f32_bf16 v156, v131, s34, v156
  v_dot2_f32_bf16 v158, v132, s34, v158
  v_dot2_f32_bf16 v156, v133, s34, v156
  v_dot2_f32_bf16 v158, v134, s34, v158
  v_dot2_f32_bf16 v156, v135, s34, v156
  s_waitcnt lgkmcnt(3)
  v_mfma_f32_32x32x16_bf16 v[48:63], v[136:139], v[112:115], v[48:63]
  ds_read_b128 v[120:123], v24 offset:32768
  ds_read_b64_tr_b16 v[140:141], v41 offset:36864
  ds_read_b64_tr_b16 v[142:143], v41 offset:37888
  s_waitcnt lgkmcnt(4)
  v_mfma_f32_32x32x16_bf16 v[64:79], v[148:151], v[112:115], v[64:79]
  ds_read_b64_tr_b16 v[152:153], v42 offset:36864
  ds_read_b64_tr_b16 v[154:155], v42 offset:37888
  s_waitcnt lgkmcnt(5)
  v_mfma_f32_32x32x16_bf16 v[80:95], v[136:139], v[116:119], v[80:95]
  ds_read_b128 v[124:127], v28 offset:32768
  v_mfma_f32_32x32x16_bf16 v[96:111], v[148:151], v[116:119], v[96:111]
  s_waitcnt lgkmcnt(3)
  v_mfma_f32_32x32x16_bf16 v[48:63], v[140:143], v[120:123], v[48:63]
  ds_read_b128 v[112:115], v25 offset:32768
  ds_read_b64_tr_b16 v[144:145], v41 offset:40960
  ds_read_b64_tr_b16 v[146:147], v41 offset:41984
  s_waitcnt lgkmcnt(4)
  v_mfma_f32_32x32x16_bf16 v[64:79], v[152:155], v[120:123], v[64:79]
  ds_read_b64_tr_b16 v[148:149], v42 offset:40960
  ds_read_b64_tr_b16 v[150:151], v42 offset:41984
  s_waitcnt lgkmcnt(5)
  v_mfma_f32_32x32x16_bf16 v[80:95], v[140:143], v[124:127], v[80:95]
  ds_read_b128 v[116:119], v29 offset:32768
  v_mfma_f32_32x32x16_bf16 v[96:111], v[152:155], v[124:127], v[96:111]
  s_waitcnt lgkmcnt(3)
  v_mfma_f32_32x32x16_bf16 v[48:63], v[144:147], v[112:115], v[48:63]
  ds_read_b128 v[120:123], v26 offset:32768
  ds_read_b64_tr_b16 v[128:129], v41 offset:45056
  ds_read_b64_tr_b16 v[130:131], v41 offset:46080
  s_waitcnt lgkmcnt(4)
  v_mfma_f32_32x32x16_bf16 v[64:79], v[148:151], v[112:115], v[64:79]
  ds_read_b64_tr_b16 v[152:153], v42 offset:45056
  ds_read_b64_tr_b16 v[154:155], v42 offset:46080
  s_waitcnt lgkmcnt(5)
  v_mfma_f32_32x32x16_bf16 v[80:95], v[144:147], v[116:119], v[80:95]
  ds_read_b128 v[124:127], v30 offset:32768
  v_mfma_f32_32x32x16_bf16 v[96:111], v[148:151], v[116:119], v[96:111]
  s_waitcnt lgkmcnt(3)
  v_mfma_f32_32x32x16_bf16 v[48:63], v[128:131], v[120:123], v[48:63]
  s_barrier
  ds_read_b128 v[112:115], v31 offset:0
  ds_read_b64_tr_b16 v[132:133], v43 offset:0
  ds_read_b64_tr_b16 v[134:135], v43 offset:1024
  s_waitcnt lgkmcnt(4)
  v_mfma_f32_32x32x16_bf16 v[64:79], v[152:155], v[120:123], v[64:79]
  ds_read_b64_tr_b16 v[148:149], v44 offset:0
  ds_read_b64_tr_b16 v[150:151], v44 offset:1024
  s_waitcnt lgkmcnt(5)
  v_mfma_f32_32x32x16_bf16 v[80:95], v[128:131], v[124:127], v[80:95]
  ds_read_b128 v[116:119], v35 offset:0
  v_mfma_f32_32x32x16_bf16 v[96:111], v[152:155], v[124:127], v[96:111]
  v_dot2_f32_bf16 v158, v136, s34, v158
  v_dot2_f32_bf16 v156, v137, s34, v156
  v_dot2_f32_bf16 v158, v138, s34, v158
  v_dot2_f32_bf16 v156, v139, s34, v156
  v_dot2_f32_bf16 v158, v140, s34, v158
  v_dot2_f32_bf16 v156, v141, s34, v156
  v_dot2_f32_bf16 v158, v142, s34, v158
  v_dot2_f32_bf16 v156, v143, s34, v156
  v_dot2_f32_bf16 v158, v144, s34, v158
  v_dot2_f32_bf16 v156, v145, s34, v156
  v_dot2_f32_bf16 v158, v146, s34, v158
  v_dot2_f32_bf16 v156, v147, s34, v156
  v_dot2_f32_bf16 v158, v128, s34, v158
  v_dot2_f32_bf16 v156, v129, s34, v156
  v_dot2_f32_bf16 v158, v130, s34, v158
  v_dot2_f32_bf16 v156, v131, s34, v156
  s_waitcnt lgkmcnt(3)
  v_mfma_f32_32x32x16_bf16 v[48:63], v[132:135], v[112:115], v[48:63]
  ds_read_b128 v[120:123], v32 offset:0
  ds_read_b64_tr_b16 v[136:137], v43 offset:4096
  ds_read_b64_tr_b16 v[138:139], v43 offset:5120
  s_waitcnt lgkmcnt(4)
  v_mfma_f32_32x32x16_bf16 v[64:79], v[148:151], v[112:115], v[64:79]
  ds_read_b64_tr_b16 v[152:153], v44 offset:4096
  ds_read_b64_tr_b16 v[154:155], v44 offset:5120
  s_waitcnt lgkmcnt(5)
  v_mfma_f32_32x32x16_bf16 v[80:95], v[132:135], v[116:119], v[80:95]
  ds_read_b128 v[124:127], v36 offset:0
  v_mfma_f32_32x32x16_bf16 v[96:111], v[148:151], v[116:119], v[96:111]
  s_waitcnt lgkmcnt(3)
  v_mfma_f32_32x32x16_bf16 v[48:63], v[136:139], v[120:123], v[48:63]
  ds_read_b128 v[112:115], v33 offset:0
  ds_read_b64_tr_b16 v[140:141], v43 offset:8192
  ds_read_b64_tr_b16 v[142:143], v43 offset:9216
  s_waitcnt lgkmcnt(4)
  v_mfma_f32_32x32x16_bf16 v[64:79], v[152:155], v[120:123], v[64:79]
  ds_read_b64_tr_b16 v[148:149], v44 offset:8192
  ds_read_b64_tr_b16 v[150:151], v44 offset:9216
  s_waitcnt lgkmcnt(5)
  v_mfma_f32_32x32x16_bf16 v[80:95], v[136:139], v[124:127], v[80:95]
  ds_read_b128 v[116:119], v37 offset:0
  v_mfma_f32_32x32x16_bf16 v[96:111], v[152:155], v[124:127], v[96:111]
  s_waitcnt lgkmcnt(3)
  v_mfma_f32_32x32x16_bf16 v[48:63], v[140:143], v[112:115], v[48:63]
  ds_read_b128 v[120:123], v34 offset:0
  ds_read_b64_tr_b16 v[144:145], v43 offset:12288
  ds_read_b64_tr_b16 v[146:147], v43 offset:13312
  s_waitcnt lgkmcnt(4)
  v_mfma_f32_32x32x16_bf16 v[64:79], v[148:151], v[112:115], v[64:79]
  ds_read_b64_tr_b16 v[152:153], v44 offset:12288
  ds_read_b64_tr_b16 v[154:155], v44 offset:13312
  s_waitcnt lgkmcnt(5)
  v_mfma_f32_32x32x16_bf16 v[80:95], v[140:143], v[116:119], v[80:95]
  ds_read_b128 v[124:127], v38 offset:0
  v_mfma_f32_32x32x16_bf16 v[96:111], v[148:151], v[116:119], v[96:111]
  s_waitcnt lgkmcnt(3)
  v_mfma_f32_32x32x16_bf16 v[48:63], v[144:147], v[120:123], v[48:63]
  s_barrier
  ds_read_b128 v[112:115], v15 offset:0
  ds_read_b64_tr_b16 v[128:129], v39 offset:0
  ds_read_b64_tr_b16 v[130:131], v39 offset:1024
  s_waitcnt lgkmcnt(4)
  v_mfma_f32_32x32x16_bf16 v[64:79], v[152:155], v[120:123], v[64:79]
  ds_read_b64_tr_b16 v[148:149], v40 offset:0
  ds_read_b64_tr_b16 v[150:151], v40 offset:1024
  s_waitcnt lgkmcnt(5)
  v_mfma_f32_32x32x16_bf16 v[80:95], v[144:147], v[124:127], v[80:95]
  ds_read_b128 v[116:119], v19 offset:0
  v_mfma_f32_32x32x16_bf16 v[96:111], v[152:155], v[124:127], v[96:111]
  v_dot2_f32_bf16 v158, v132, s34, v158
  v_dot2_f32_bf16 v156, v133, s34, v156
  v_dot2_f32_bf16 v158, v134, s34, v158
  v_dot2_f32_bf16 v156, v135, s34, v156
  v_dot2_f32_bf16 v158, v136, s34, v158
  v_dot2_f32_bf16 v156, v137, s34, v156
  v_dot2_f32_bf16 v158, v138, s34, v158
  v_dot2_f32_bf16 v156, v139, s34, v156
  v_dot2_f32_bf16 v158, v140, s34, v158
  v_dot2_f32_bf16 v156, v141, s34, v156
  v_dot2_f32_bf16 v158, v142, s34, v158
  v_dot2_f32_bf16 v156, v143, s34, v156
  v_dot2_f32_bf16 v158, v144, s34, v158
  v_dot2_f32_bf16 v156, v145, s34, v156
  v_dot2_f32_bf16 v158, v146, s34, v158
  v_dot2_f32_bf16 v156, v147, s34, v156
  s_waitcnt lgkmcnt(3)
  v_mfma_f32_32x32x16_bf16 v[48:63], v[128:131], v[112:115], v[48:63]
  ds_read_b128 v[120:123], v16 offset:0
  ds_read_b64_tr_b16 v[132:133], v39 offset:4096
  ds_read_b64_tr_b16 v[134:135], v39 offset:5120
  s_waitcnt lgkmcnt(4)
  v_mfma_f32_32x32x16_bf16 v[64:79], v[148:151], v[112:115], v[64:79]
  ds_read_b64_tr_b16 v[152:153], v40 offset:4096
  ds_read_b64_tr_b16 v[154:155], v40 offset:5120
  s_waitcnt lgkmcnt(5)
  v_mfma_f32_32x32x16_bf16 v[80:95], v[128:131], v[116:119], v[80:95]
  ds_read_b128 v[124:127], v20 offset:0
  v_mfma_f32_32x32x16_bf16 v[96:111], v[148:151], v[116:119], v[96:111]
  s_waitcnt lgkmcnt(3)
  v_mfma_f32_32x32x16_bf16 v[48:63], v[132:135], v[120:123], v[48:63]
  ds_read_b128 v[112:115], v17 offset:0
  ds_read_b64_tr_b16 v[136:137], v39 offset:8192
  ds_read_b64_tr_b16 v[138:139], v39 offset:9216
  s_waitcnt lgkmcnt(4)
  v_mfma_f32_32x32x16_bf16 v[64:79], v[152:155], v[120:123], v[64:79]
  ds_read_b64_tr_b16 v[148:149], v40 offset:8192
  ds_read_b64_tr_b16 v[150:151], v40 offset:9216
  s_waitcnt lgkmcnt(5)
  v_mfma_f32_32x32x16_bf16 v[80:95], v[132:135], v[124:127], v[80:95]
  ds_read_b128 v[116:119], v21 offset:0
  v_mfma_f32_32x32x16_bf16 v[96:111], v[152:155], v[124:127], v[96:111]
  s_waitcnt lgkmcnt(3)
  v_mfma_f32_32x32x16_bf16 v[48:63], v[136:139], v[112:115], v[48:63]
  ds_read_b128 v[120:123], v18 offset:0
  ds_read_b64_tr_b16 v[140:141], v39 offset:12288
  ds_read_b64_tr_b16 v[142:143], v39 offset:13312
  s_waitcnt lgkmcnt(4)
  v_mfma_f32_32x32x16_bf16 v[64:79], v[148:151], v[112:115], v[64:79]
  ds_read_b64_tr_b16 v[152:153], v40 offset:12288
  ds_read_b64_tr_b16 v[154:155], v40 offset:13312
  s_waitcnt lgkmcnt(5)
  v_mfma_f32_32x32x16_bf16 v[80:95], v[136:139], v[116:119], v[80:95]
  ds_read_b128 v[124:127], v22 offset:0
  v_mfma_f32_32x32x16_bf16 v[96:111], v[148:151], v[116:119], v[96:111]
  s_waitcnt lgkmcnt(3)
  v_mfma_f32_32x32x16_bf16 v[48:63], v[140:143], v[120:123], v[48:63]
  s_barrier
  ds_read_b128 v[112:115], v15 offset:32768
  ds_read_b64_tr_b16 v[144:145], v39 offset:32768
  ds_read_b64_tr_b16 v[146:147], v39 offset:33792
  s_waitcnt lgkmcnt(4)
  v_mfma_f32_32x32x16_bf16 v[64:79], v[152:155], v[120:123], v[64:79]
  ds_read_b64_tr_b16 v[148:149], v40 offset:32768
  ds_read_b64_tr_b16 v[150:151], v40 offset:33792
  s_waitcnt lgkmcnt(5)
  v_mfma_f32_32x32x16_bf16 v[80:95], v[140:143], v[124:127], v[80:95]
  ds_read_b128 v[116:119], v19 offset:32768
  v_mfma_f32_32x32x16_bf16 v[96:111], v[152:155], v[124:127], v[96:111]
  v_dot2_f32_bf16 v158, v128, s34, v158
  v_dot2_f32_bf16 v156, v129, s34, v156
  v_dot2_f32_bf16 v158, v130, s34, v158
  v_dot2_f32_bf16 v156, v131, s34, v156
  v_dot2_f32_bf16 v158, v132, s34, v158
  v_dot2_f32_bf16 v156, v133, s34, v156
  v_dot2_f32_bf16 v158, v134, s34, v158
  v_dot2_f32_bf16 v156, v135, s34, v156
  v_dot2_f32_bf16 v158, v136, s34, v158
  v_dot2_f32_bf16 v156, v137, s34, v156
  v_dot2_f32_bf16 v158, v138, s34, v158
  v_dot2_f32_bf16 v156, v139, s34, v156
  v_dot2_f32_bf16 v158, v140, s34, v158
  v_dot2_f32_bf16 v156, v141, s34, v156
  v_dot2_f32_bf16 v158, v142, s34, v158
  v_dot2_f32_bf16 v156, v143, s34, v156
  s_waitcnt lgkmcnt(3)
  v_mfma_f32_32x32x16_bf16 v[48:63], v[144:147], v[112:115], v[48:63]
  ds_read_b128 v[120:123], v16 offset:32768
  ds_read_b64_tr_b16 v[128:129], v39 offset:36864
  ds_read_b64_tr_b16 v[130:131], v39 offset:37888
  s_waitcnt lgkmcnt(4)
  v_mfma_f32_32x32x16_bf16 v[64:79], v[148:151], v[112:115], v[64:79]
  ds_read_b64_tr_b16 v[152:153], v40 offset:36864
  ds_read_b64_tr_b16 v[154:155], v40 offset:37888
  s_waitcnt lgkmcnt(5)
  v_mfma_f32_32x32x16_bf16 v[80:95], v[144:147], v[116:119], v[80:95]
  ds_read_b128 v[124:127], v20 offset:32768
  v_mfma_f32_32x32x16_bf16 v[96:111], v[148:151], v[116:119], v[96:111]
  s_waitcnt lgkmcnt(3)
  v_mfma_f32_32x32x16_bf16 v[48:63], v[128:131], v[120:123], v[48:63]
  ds_read_b128 v[112:115], v17 offset:32768
  ds_read_b64_tr_b16 v[132:133], v39 offset:40960
  ds_read_b64_tr_b16 v[134:135], v39 offset:41984
  s_waitcnt lgkmcnt(4)
  v_mfma_f32_32x32x16_bf16 v[64:79], v[152:155], v[120:123], v[64:79]
  ds_read_b64_tr_b16 v[148:149], v40 offset:40960
  ds_read_b64_tr_b16 v[150:151], v40 offset:41984
  s_waitcnt lgkmcnt(5)
  v_mfma_f32_32x32x16_bf16 v[80:95], v[128:131], v[124:127], v[80:95]
  ds_read_b128 v[116:119], v21 offset:32768
  v_mfma_f32_32x32x16_bf16 v[96:111], v[152:155], v[124:127], v[96:111]
  s_waitcnt lgkmcnt(3)
  v_mfma_f32_32x32x16_bf16 v[48:63], v[132:135], v[112:115], v[48:63]
  ds_read_b128 v[120:123], v18 offset:32768
  ds_read_b64_tr_b16 v[136:137], v39 offset:45056
  ds_read_b64_tr_b16 v[138:139], v39 offset:46080
  s_waitcnt lgkmcnt(4)
  v_mfma_f32_32x32x16_bf16 v[64:79], v[148:151], v[112:115], v[64:79]
  ds_read_b64_tr_b16 v[152:153], v40 offset:45056
  ds_read_b64_tr_b16 v[154:155], v40 offset:46080
  s_waitcnt lgkmcnt(5)
  v_mfma_f32_32x32x16_bf16 v[80:95], v[132:135], v[116:119], v[80:95]
  ds_read_b128 v[124:127], v22 offset:32768
  v_mfma_f32_32x32x16_bf16 v[96:111], v[148:151], v[116:119], v[96:111]
  s_waitcnt lgkmcnt(3)
  v_mfma_f32_32x32x16_bf16 v[48:63], v[136:139], v[120:123], v[48:63]
  s_barrier
  ds_read_b128 v[112:115], v23 offset:0
  ds_read_b64_tr_b16 v[140:141], v41 offset:0
  ds_read_b64_tr_b16 v[142:143], v41 offset:1024
  s_waitcnt lgkmcnt(4)
  v_mfma_f32_32x32x16_bf16 v[64:79], v[152:155], v[120:123], v[64:79]
  ds_read_b64_tr_b16 v[148:149], v42 offset:0
  ds_read_b64_tr_b16 v[150:151], v42 offset:1024
  s_waitcnt lgkmcnt(5)
  v_mfma_f32_32x32x16_bf16 v[80:95], v[136:139], v[124:127], v[80:95]
  ds_read_b128 v[116:119], v27 offset:0
  v_mfma_f32_32x32x16_bf16 v[96:111], v[152:155], v[124:127], v[96:111]
  v_dot2_f32_bf16 v158, v144, s34, v158
  v_dot2_f32_bf16 v156, v145, s34, v156
  v_dot2_f32_bf16 v158, v146, s34, v158
  v_dot2_f32_bf16 v156, v147, s34, v156
  v_dot2_f32_bf16 v158, v128, s34, v158
  v_dot2_f32_bf16 v156, v129, s34, v156
  v_dot2_f32_bf16 v158, v130, s34, v158
  v_dot2_f32_bf16 v156, v131, s34, v156
  v_dot2_f32_bf16 v158, v132, s34, v158
  v_dot2_f32_bf16 v156, v133, s34, v156
  v_dot2_f32_bf16 v158, v134, s34, v158
  v_dot2_f32_bf16 v156, v135, s34, v156
  v_dot2_f32_bf16 v158, v136, s34, v158
  v_dot2_f32_bf16 v156, v137, s34, v156
  v_dot2_f32_bf16 v158, v138, s34, v158
  v_dot2_f32_bf16 v156, v139, s34, v156
  s_waitcnt lgkmcnt(3)
  v_mfma_f32_32x32x16_bf16 v[48:63], v[140:143], v[112:115], v[48:63]
  ds_read_b128 v[120:123], v24 offset:0
  ds_read_b64_tr_b16 v[144:145], v41 offset:4096
  ds_read_b64_tr_b16 v[146:147], v41 offset:5120
  s_waitcnt lgkmcnt(4)
  v_mfma_f32_32x32x16_bf16 v[64:79], v[148:151], v[112:115], v[64:79]
  ds_read_b64_tr_b16 v[152:153], v42 offset:4096
  ds_read_b64_tr_b16 v[154:155], v42 offset:5120
  s_waitcnt lgkmcnt(5)
  v_mfma_f32_32x32x16_bf16 v[80:95], v[140:143], v[116:119], v[80:95]
  ds_read_b128 v[124:127], v28 offset:0
  v_mfma_f32_32x32x16_bf16 v[96:111], v[148:151], v[116:119], v[96:111]
  s_waitcnt lgkmcnt(3)
  v_mfma_f32_32x32x16_bf16 v[48:63], v[144:147], v[120:123], v[48:63]
  ds_read_b128 v[112:115], v25 offset:0
  ds_read_b64_tr_b16 v[128:129], v41 offset:8192
  ds_read_b64_tr_b16 v[130:131], v41 offset:9216
  s_waitcnt lgkmcnt(4)
  v_mfma_f32_32x32x16_bf16 v[64:79], v[152:155], v[120:123], v[64:79]
  ds_read_b64_tr_b16 v[148:149], v42 offset:8192
  ds_read_b64_tr_b16 v[150:151], v42 offset:9216
  s_waitcnt lgkmcnt(5)
  v_mfma_f32_32x32x16_bf16 v[80:95], v[144:147], v[124:127], v[80:95]
  ds_read_b128 v[116:119], v29 offset:0
  v_mfma_f32_32x32x16_bf16 v[96:111], v[152:155], v[124:127], v[96:111]
  global_load_dword v157, v159, s[50:51] sc1
  s_waitcnt lgkmcnt(3)
  v_mfma_f32_32x32x16_bf16 v[48:63], v[128:131], v[112:115], v[48:63]
  ds_read_b128 v[120:123], v26 offset:0
  ds_read_b64_tr_b16 v[132:133], v41 offset:12288
  ds_read_b64_tr_b16 v[134:135], v41 offset:13312
  s_waitcnt lgkmcnt(4)
  v_mfma_f32_32x32x16_bf16 v[64:79], v[148:151], v[112:115], v[64:79]
  ds_read_b64_tr_b16 v[152:153], v42 offset:12288
  ds_read_b64_tr_b16 v[154:155], v42 offset:13312
  s_waitcnt lgkmcnt(5)
  v_mfma_f32_32x32x16_bf16 v[80:95], v[128:131], v[116:119], v[80:95]
  ds_read_b128 v[124:127], v30 offset:0
  v_mfma_f32_32x32x16_bf16 v[96:111], v[148:151], v[116:119], v[96:111]
  s_waitcnt lgkmcnt(3)
  v_mfma_f32_32x32x16_bf16 v[48:63], v[132:135], v[120:123], v[48:63]
  s_barrier
  ds_read_b128 v[112:115], v23 offset:32768
  ds_read_b64_tr_b16 v[136:137], v41 offset:32768
  ds_read_b64_tr_b16 v[138:139], v41 offset:33792
  s_waitcnt lgkmcnt(4)
  v_mfma_f32_32x32x16_bf16 v[64:79], v[152:155], v[120:123], v[64:79]
  ds_read_b64_tr_b16 v[148:149], v42 offset:32768
  ds_read_b64_tr_b16 v[150:151], v42 offset:33792
  s_waitcnt lgkmcnt(5)
  v_mfma_f32_32x32x16_bf16 v[80:95], v[132:135], v[124:127], v[80:95]
  ds_read_b128 v[116:119], v27 offset:32768
  v_mfma_f32_32x32x16_bf16 v[96:111], v[152:155], v[124:127], v[96:111]
  v_dot2_f32_bf16 v158, v140, s34, v158
  v_dot2_f32_bf16 v156, v141, s34, v156
  v_dot2_f32_bf16 v158, v142, s34, v158
  v_dot2_f32_bf16 v156, v143, s34, v156
  v_dot2_f32_bf16 v158, v144, s34, v158
  v_dot2_f32_bf16 v156, v145, s34, v156
  v_dot2_f32_bf16 v158, v146, s34, v158
  v_dot2_f32_bf16 v156, v147, s34, v156
  v_dot2_f32_bf16 v158, v128, s34, v158
  v_dot2_f32_bf16 v156, v129, s34, v156
  v_dot2_f32_bf16 v158, v130, s34, v158
  v_dot2_f32_bf16 v156, v131, s34, v156
  v_dot2_f32_bf16 v158, v132, s34, v158
  v_dot2_f32_bf16 v156, v133, s34, v156
  v_dot2_f32_bf16 v158, v134, s34, v158
  v_dot2_f32_bf16 v156, v135, s34, v156
  s_waitcnt lgkmcnt(3)
  v_mfma_f32_32x32x16_bf16 v[48:63], v[136:139], v[112:115], v[48:63]
  ds_read_b128 v[120:123], v24 offset:32768
  ds_read_b64_tr_b16 v[140:141], v41 offset:36864
  ds_read_b64_tr_b16 v[142:143], v41 offset:37888
  s_waitcnt lgkmcnt(4)
  v_mfma_f32_32x32x16_bf16 v[64:79], v[148:151], v[112:115], v[64:79]
  ds_read_b64_tr_b16 v[152:153], v42 offset:36864
  ds_read_b64_tr_b16 v[154:155], v42 offset:37888
  s_waitcnt lgkmcnt(5)
  v_mfma_f32_32x32x16_bf16 v[80:95], v[136:139], v[116:119], v[80:95]
  ds_read_b128 v[124:127], v28 offset:32768
  v_mfma_f32_32x32x16_bf16 v[96:111], v[148:151], v[116:119], v[96:111]
  s_waitcnt lgkmcnt(3)
  v_mfma_f32_32x32x16_bf16 v[48:63], v[140:143], v[120:123], v[48:63]
  ds_read_b128 v[112:115], v25 offset:32768
  ds_read_b64_tr_b16 v[144:145], v41 offset:40960
  ds_read_b64_tr_b16 v[146:147], v41 offset:41984
  s_waitcnt lgkmcnt(4)
  v_mfma_f32_32x32x16_bf16 v[64:79], v[152:155], v[120:123], v[64:79]
  ds_read_b64_tr_b16 v[148:149], v42 offset:40960
  ds_read_b64_tr_b16 v[150:151], v42 offset:41984
  s_waitcnt lgkmcnt(5)
  v_mfma_f32_32x32x16_bf16 v[80:95], v[140:143], v[124:127], v[80:95]
  ds_read_b128 v[116:119], v29 offset:32768
  v_mfma_f32_32x32x16_bf16 v[96:111], v[152:155], v[124:127], v[96:111]
  s_waitcnt lgkmcnt(3)
  v_mfma_f32_32x32x16_bf16 v[48:63], v[144:147], v[112:115], v[48:63]
  ds_read_b128 v[120:123], v26 offset:32768
  ds_read_b64_tr_b16 v[128:129], v41 offset:45056
  ds_read_b64_tr_b16 v[130:131], v41 offset:46080
  s_waitcnt lgkmcnt(4)
  v_mfma_f32_32x32x16_bf16 v[64:79], v[148:151], v[112:115], v[64:79]
  ds_read_b64_tr_b16 v[152:153], v42 offset:45056
  ds_read_b64_tr_b16 v[154:155], v42 offset:46080
  s_waitcnt lgkmcnt(5)
  v_mfma_f32_32x32x16_bf16 v[80:95], v[144:147], v[116:119], v[80:95]
  ds_read_b128 v[124:127], v30 offset:32768
  v_mfma_f32_32x32x16_bf16 v[96:111], v[148:151], v[116:119], v[96:111]
  s_waitcnt lgkmcnt(3)
  v_mfma_f32_32x32x16_bf16 v[48:63], v[128:131], v[120:123], v[48:63]
  s_barrier
  ds_read_b128 v[112:115], v31 offset:0
  ds_read_b64_tr_b16 v[132:133], v43 offset:0
  ds_read_b64_tr_b16 v[134:135], v43 offset:1024
  s_waitcnt lgkmcnt(4)
  v_mfma_f32_32x32x16_bf16 v[64:79], v[152:155], v[120:123], v[64:79]
  ds_read_b64_tr_b16 v[148:149], v44 offset:0
  ds_read_b64_tr_b16 v[150:151], v44 offset:1024
  s_waitcnt lgkmcnt(5)
  v_mfma_f32_32x32x16_bf16 v[80:95], v[128:131], v[124:127], v[80:95]
  ds_read_b128 v[116:119], v35 offset:0
  v_mfma_f32_32x32x16_bf16 v[96:111], v[152:155], v[124:127], v[96:111]
  v_dot2_f32_bf16 v158, v136, s34, v158
  v_dot2_f32_bf16 v156, v137, s34, v156
  v_dot2_f32_bf16 v158, v138, s34, v158
  v_dot2_f32_bf16 v156, v139, s34, v156
  v_dot2_f32_bf16 v158, v140, s34, v158
  v_dot2_f32_bf16 v156, v141, s34, v156
  v_dot2_f32_bf16 v158, v142, s34, v158
  v_dot2_f32_bf16 v156, v143, s34, v156
  v_dot2_f32_bf16 v158, v144, s34, v158
  v_dot2_f32_bf16 v156, v145, s34, v156
  v_dot2_f32_bf16 v158, v146, s34, v158
  v_dot2_f32_bf16 v156, v147, s34, v156
  v_dot2_f32_bf16 v158, v128, s34, v158
  v_dot2_f32_bf16 v156, v129, s34, v156
  v_dot2_f32_bf16 v158, v130, s34, v158
  v_dot2_f32_bf16 v156, v131, s34, v156
  s_waitcnt vmcnt(0)
  v_cmp_eq_u32 vcc, 0, v157
  s_cbranch_vccnz k1_slowq
k1_sokq:
  s_lshl_b32 s27, s24, 7
  s_xor_b32 s28, s27, 128
  v_lshl_add_u32 v1, v45, 2, s27
  v_lshl_add_u32 v2, v45, 2, s28
  buffer_load_dword v168, v1, s[52:55], s43 offen sc1
  buffer_load_dword v169, v1, s[52:55], s41 offen sc1
  buffer_load_dword v170, v2, s[52:55], s43 offen sc1
  buffer_load_dword v171, v2, s[52:55], s41 offen sc1
  s_waitcnt lgkmcnt(3)
  v_mfma_f32_32x32x16_bf16 v[48:63], v[132:135], v[112:115], v[48:63]
  ds_read_b128 v[120:123], v32 offset:0
  ds_read_b64_tr_b16 v[136:137], v43 offset:4096
  ds_read_b64_tr_b16 v[138:139], v43 offset:5120
  s_waitcnt lgkmcnt(4)
  v_mfma_f32_32x32x16_bf16 v[64:79], v[148:151], v[112:115], v[64:79]
  ds_read_b64_tr_b16 v[152:153], v44 offset:4096
  ds_read_b64_tr_b16 v[154:155], v44 offset:5120
  s_waitcnt lgkmcnt(5)
  v_mfma_f32_32x32x16_bf16 v[80:95], v[132:135], v[116:119], v[80:95]
  ds_read_b128 v[124:127], v36 offset:0
  v_mfma_f32_32x32x16_bf16 v[96:111], v[148:151], v[116:119], v[96:111]
  s_waitcnt lgkmcnt(3)
  v_mfma_f32_32x32x16_bf16 v[48:63], v[136:139], v[120:123], v[48:63]
  ds_read_b128 v[112:115], v33 offset:0
  ds_read_b64_tr_b16 v[140:141], v43 offset:8192
  ds_read_b64_tr_b16 v[142:143], v43 offset:9216
  s_waitcnt lgkmcnt(4)
  v_mfma_f32_32x32x16_bf16 v[64:79], v[152:155], v[120:123], v[64:79]
  ds_read_b64_tr_b16 v[148:149], v44 offset:8192
  ds_read_b64_tr_b16 v[150:151], v44 offset:9216
  s_waitcnt lgkmcnt(5)
  v_mfma_f32_32x32x16_bf16 v[80:95], v[136:139], v[124:127], v[80:95]
  ds_read_b128 v[116:119], v37 offset:0
  v_mfma_f32_32x32x16_bf16 v[96:111], v[152:155], v[124:127], v[96:111]
  s_waitcnt lgkmcnt(3)
  v_mfma_f32_32x32x16_bf16 v[48:63], v[140:143], v[112:115], v[48:63]
  ds_read_b128 v[120:123], v34 offset:0
  ds_read_b64_tr_b16 v[144:145], v43 offset:12288
  ds_read_b64_tr_b16 v[146:147], v43 offset:13312
  s_waitcnt lgkmcnt(4)
  v_mfma_f32_32x32x16_bf16 v[64:79], v[148:151], v[112:115], v[64:79]
  ds_read_b64_tr_b16 v[152:153], v44 offset:12288
  ds_read_b64_tr_b16 v[154:155], v44 offset:13312
  s_waitcnt lgkmcnt(5)
  v_mfma_f32_32x32x16_bf16 v[80:95], v[140:143], v[116:119], v[80:95]
  ds_read_b128 v[124:127], v38 offset:0
  v_mfma_f32_32x32x16_bf16 v[96:111], v[148:151], v[116:119], v[96:111]
  s_waitcnt lgkmcnt(3)
  v_mfma_f32_32x32x16_bf16 v[48:63], v[144:147], v[120:123], v[48:63]
  s_waitcnt lgkmcnt(1)
  v_mfma_f32_32x32x16_bf16 v[64:79], v[152:155], v[120:123], v[64:79]
  s_waitcnt lgkmcnt(0)
  v_mfma_f32_32x32x16_bf16 v[80:95], v[144:147], v[124:127], v[80:95]
  v_mfma_f32_32x32x16_bf16 v[96:111], v[152:155], v[124:127], v[96:111]
  v_dot2_f32_bf16 v158, v132, s34, v158
  v_dot2_f32_bf16 v156, v133, s34, v156
  v_dot2_f32_bf16 v158, v134, s34, v158
  v_dot2_f32_bf16 v156, v135, s34, v156
  v_dot2_f32_bf16 v158, v136, s34, v158
  v_dot2_f32_bf16 v156, v137, s34, v156
  v_dot2_f32_bf16 v158, v138, s34, v158
  v_dot2_f32_bf16 v156, v139, s34, v156
  v_dot2_f32_bf16 v158, v140, s34, v158
  v_dot2_f32_bf16 v156, v141, s34, v156
  v_dot2_f32_bf16 v158, v142, s34, v158
  v_dot2_f32_bf16 v156, v143, s34, v156
  v_dot2_f32_bf16 v158, v144, s34, v158
  v_dot2_f32_bf16 v156, v145, s34, v156
  v_dot2_f32_bf16 v158, v146, s34, v158
  v_dot2_f32_bf16 v156, v147, s34, v156
  s_nop 2
  v_add_f32 v158, v158, v156
  v_mov_b32 v1, v158
  s_nop 1
  v_permlane32_swap_b32 v158, v1
  v_add_f32 v158, v158, v1
  s_lshl_b32 s27, s40, 7
  v_lshl_add_u32 v4, v45, 2, s27
  ds_write_b32 v4, v158 offset:1024
  s_waitcnt lgkmcnt(0)
  s_barrier
  s_waitcnt vmcnt(0)
  v_mul_f32 v228, s39, v168
  v_mul_f32 v230, s39, v169
  v_mul_f32 v229, s39, v168
  v_mul_f32 v231, s39, v169
  v_mul_f32 v232, s39, v170
  v_mul_f32 v234, s39, v171
  v_mul_f32 v233, s39, v170
  v_mul_f32 v235, s39, v171
  s_lshl_b32 s27, s40, 7
  s_xor_b32 s28, s27, 128
  v_lshl_add_u32 v1, v46, 4, s27
  v_lshl_add_u32 v2, v46, 4, s28
  ds_read_b128 v[172:175], v1 offset:1024
  ds_read_b128 v[176:179], v1 offset:1056
  ds_read_b128 v[180:183], v1 offset:1088
  ds_read_b128 v[184:187], v1 offset:1120
  ds_read_b128 v[188:191], v2 offset:1024
  ds_read_b128 v[192:195], v2 offset:1056
  ds_read_b128 v[196:199], v2 offset:1088
  ds_read_b128 v[200:203], v2 offset:1120
  s_lshl_b32 s27, s25, 2
  s_add_u32 s27, s27, s24
  s_xor_b32 s28, s27, 1
  s_mul_i32 s27, s27, s38
  s_mul_i32 s28, s28, s38
  v_mov_b32 v236, 0
  s_waitcnt lgkmcnt(0)
  s_add_u32 s46, s27, s37
  s_add_u32 s47, s28, s37
  v_pk_mul_f32 v[220:221], v[48:49], v[228:229]
  v_pk_mul_f32 v[222:223], v[50:51], v[228:229]
  v_pk_mul_f32 v[224:225], v[52:53], v[228:229]
  v_pk_mul_f32 v[226:227], v[54:55], v[228:229]
  v_pk_fma_f32 v[220:221], v[172:173], v[230:231], v[220:221]
  v_pk_fma_f32 v[222:223], v[174:175], v[230:231], v[222:223]
  v_pk_fma_f32 v[224:225], v[176:177], v[230:231], v[224:225]
  v_pk_fma_f32 v[226:227], v[178:179], v[230:231], v[226:227]
  v_cvt_pk_bf16_f32 v204, v220, v221
  v_cvt_pk_bf16_f32 v205, v222, v223
  v_cvt_pk_bf16_f32 v206, v224, v225
  v_cvt_pk_bf16_f32 v207, v226, v227
  v_dot2_f32_bf16 v237, v204, v204, 0
  v_dot2_f32_bf16 v238, v206, v206, 0
  v_dot2_f32_bf16 v237, v205, v205, v237
  v_dot2_f32_bf16 v238, v207, v207, v238
  v_permlane32_swap_b32 v204, v206
  v_permlane32_swap_b32 v205, v207
  s_nop 0
  v_max3_f32 v236, v237, v238, v236
  s_not_b64 exec, s[56:57]
  buffer_store_dwordx4 v[204:207], v160, s[16:19], s27 offen sc1
  s_mov_b64 exec, s[56:57]
  s_cbranch_execz k1_ns1
  buffer_store_dwordx2 v[204:205], v160, s[16:19], s27 offen sc1
  buffer_store_dwordx2 v[206:207], v160, s[16:19], s46 offen sc1
k1_ns1:
  s_mov_b64 exec, -1
  v_pk_mul_f32 v[220:221], v[56:57], v[228:229]
  v_pk_mul_f32 v[222:223], v[58:59], v[228:229]
  v_pk_mul_f32 v[224:225], v[60:61], v[228:229]
  v_pk_mul_f32 v[226:227], v[62:63], v[228:229]
  v_pk_fma_f32 v[220:221], v[180:181], v[230:231], v[220:221]
  v_pk_fma_f32 v[222:223], v[182:183], v[230:231], v[222:223]
  v_pk_fma_f32 v[224:225], v[184:185], v[230:231], v[224:225]
  v_pk_fma_f32 v[226:227], v[186:187], v[230:231], v[226:227]
  v_cvt_pk_bf16_f32 v208, v220, v221
  v_cvt_pk_bf16_f32 v209, v222, v223
  v_cvt_pk_bf16_f32 v210, v224, v225
  v_cvt_pk_bf16_f32 v211, v226, v227
  v_dot2_f32_bf16 v237, v208, v208, 0
  v_dot2_f32_bf16 v238, v210, v210, 0
  v_dot2_f32_bf16 v237, v209, v209, v237
  v_dot2_f32_bf16 v238, v211, v211, v238
  v_permlane32_swap_b32 v208, v210
  v_permlane32_swap_b32 v209, v211
  s_nop 0
  v_max3_f32 v236, v237, v238, v236
  s_not_b64 exec, s[58:59]
  buffer_store_dwordx4 v[208:211], v161, s[16:19], s27 offen sc1
  s_mov_b64 exec, s[58:59]
  s_cbranch_execz k1_ns2
  buffer_store_dwordx2 v[208:209], v161, s[16:19], s27 offen sc1
  buffer_store_dwordx2 v[210:211], v161, s[16:19], s46 offen sc1
k1_ns2:
  s_mov_b64 exec, -1
  v_pk_mul_f32 v[220:221], v[64:65], v[228:229]
  v_pk_mul_f32 v[222:223], v[66:67], v[228:229]
  v_pk_mul_f32 v[224:225], v[68:69], v[228:229]
  v_pk_mul_f32 v[226:227], v[70:71], v[228:229]
  v_pk_fma_f32 v[220:221], v[188:189], v[230:231], v[220:221]
  v_pk_fma_f32 v[222:223], v[190:191], v[230:231], v[222:223]
  v_pk_fma_f32 v[224:225], v[192:193], v[230:231], v[224:225]
  v_pk_fma_f32 v[226:227], v[194:195], v[230:231], v[226:227]
  v_cvt_pk_bf16_f32 v212, v220, v221
  v_cvt_pk_bf16_f32 v213, v222, v223
  v_cvt_pk_bf16_f32 v214, v224, v225
  v_cvt_pk_bf16_f32 v215, v226, v227
  v_dot2_f32_bf16 v237, v212, v212, 0
  v_dot2_f32_bf16 v238, v214, v214, 0
  v_dot2_f32_bf16 v237, v213, v213, v237
  v_dot2_f32_bf16 v238, v215, v215, v238
  v_permlane32_swap_b32 v212, v214
  v_permlane32_swap_b32 v213, v215
  s_nop 0
  v_max3_f32 v236, v237, v238, v236
  s_not_b64 exec, s[60:61]
  buffer_store_dwordx4 v[212:215], v162, s[16:19], s27 offen sc1
  s_mov_b64 exec, s[60:61]
  s_cbranch_execz k1_ns3
  buffer_store_dwordx2 v[212:213], v162, s[16:19], s27 offen sc1
  buffer_store_dwordx2 v[214:215], v162, s[16:19], s46 offen sc1
k1_ns3:
  s_mov_b64 exec, -1
  v_pk_mul_f32 v[220:221], v[72:73], v[228:229]
  v_pk_mul_f32 v[222:223], v[74:75], v[228:229]
  v_pk_mul_f32 v[224:225], v[76:77], v[228:229]
  v_pk_mul_f32 v[226:227], v[78:79], v[228:229]
  v_pk_fma_f32 v[220:221], v[196:197], v[230:231], v[220:221]
  v_pk_fma_f32 v[222:223], v[198:199], v[230:231], v[222:223]
  v_pk_fma_f32 v[224:225], v[200:201], v[230:231], v[224:225]
  v_pk_fma_f32 v[226:227], v[202:203], v[230:231], v[226:227]
  v_cvt_pk_bf16_f32 v216, v220, v221
  v_cvt_pk_bf16_f32 v217, v222, v223
  v_cvt_pk_bf16_f32 v218, v224, v225
  v_cvt_pk_bf16_f32 v219, v226, v227
  v_dot2_f32_bf16 v237, v216, v216, 0
  v_dot2_f32_bf16 v238, v218, v218, 0
  v_dot2_f32_bf16 v237, v217, v217, v237
  v_dot2_f32_bf16 v238, v219, v219, v238
  v_permlane32_swap_b32 v216, v218
  v_permlane32_swap_b32 v217, v219
  s_nop 0
  v_max3_f32 v236, v237, v238, v236
  s_not_b64 exec, s[62:63]
  buffer_store_dwordx4 v[216:219], v163, s[16:19], s27 offen sc1
  s_mov_b64 exec, s[62:63]
  s_cbranch_execz k1_ns4
  buffer_store_dwordx2 v[216:217], v163, s[16:19], s27 offen sc1
  buffer_store_dwordx2 v[218:219], v163, s[16:19], s46 offen sc1
k1_ns4:
  s_mov_b64 exec, -1
  v_pk_mul_f32 v[220:221], v[80:81], v[232:233]
  v_pk_mul_f32 v[222:223], v[82:83], v[232:233]
  v_pk_mul_f32 v[224:225], v[84:85], v[232:233]
  v_pk_mul_f32 v[226:227], v[86:87], v[232:233]
  v_pk_fma_f32 v[220:221], v[172:173], v[234:235], v[220:221]
  v_pk_fma_f32 v[222:223], v[174:175], v[234:235], v[222:223]
  v_pk_fma_f32 v[224:225], v[176:177], v[234:235], v[224:225]
  v_pk_fma_f32 v[226:227], v[178:179], v[234:235], v[226:227]
  v_cvt_pk_bf16_f32 v204, v220, v221
  v_cvt_pk_bf16_f32 v205, v222, v223
  v_cvt_pk_bf16_f32 v206, v224, v225
  v_cvt_pk_bf16_f32 v207, v226, v227
  v_dot2_f32_bf16 v237, v204, v204, 0
  v_dot2_f32_bf16 v238, v206, v206, 0
  v_dot2_f32_bf16 v237, v205, v205, v237
  v_dot2_f32_bf16 v238, v207, v207, v238
  v_permlane32_swap_b32 v204, v206
  v_permlane32_swap_b32 v205, v207
  s_nop 0
  v_max3_f32 v236, v237, v238, v236
  s_not_b64 exec, s[56:57]
  buffer_store_dwordx4 v[204:207], v160, s[16:19], s28 offen sc1
  s_mov_b64 exec, s[56:57]
  s_cbranch_execz k1_ns5
  buffer_store_dwordx2 v[204:205], v160, s[16:19], s28 offen sc1
  buffer_store_dwordx2 v[206:207], v160, s[16:19], s47 offen sc1
k1_ns5:
  s_mov_b64 exec, -1
  v_pk_mul_f32 v[220:221], v[88:89], v[232:233]
  v_pk_mul_f32 v[222:223], v[90:91], v[232:233]
  v_pk_mul_f32 v[224:225], v[92:93], v[232:233]
  v_pk_mul_f32 v[226:227], v[94:95], v[232:233]
  v_pk_fma_f32 v[220:221], v[180:181], v[234:235], v[220:221]
  v_pk_fma_f32 v[222:223], v[182:183], v[234:235], v[222:223]
  v_pk_fma_f32 v[224:225], v[184:185], v[234:235], v[224:225]
  v_pk_fma_f32 v[226:227], v[186:187], v[234:235], v[226:227]
  v_cvt_pk_bf16_f32 v208, v220, v221
  v_cvt_pk_bf16_f32 v209, v222, v223
  v_cvt_pk_bf16_f32 v210, v224, v225
  v_cvt_pk_bf16_f32 v211, v226, v227
  v_dot2_f32_bf16 v237, v208, v208, 0
  v_dot2_f32_bf16 v238, v210, v210, 0
  v_dot2_f32_bf16 v237, v209, v209, v237
  v_dot2_f32_bf16 v238, v211, v211, v238
  v_permlane32_swap_b32 v208, v210
  v_permlane32_swap_b32 v209, v211
  s_nop 0
  v_max3_f32 v236, v237, v238, v236
  s_not_b64 exec, s[58:59]
  buffer_store_dwordx4 v[208:211], v161, s[16:19], s28 offen sc1
  s_mov_b64 exec, s[58:59]
  s_cbranch_execz k1_ns6
  buffer_store_dwordx2 v[208:209], v161, s[16:19], s28 offen sc1
  buffer_store_dwordx2 v[210:211], v161, s[16:19], s47 offen sc1
k1_ns6:
  s_mov_b64 exec, -1
  v_pk_mul_f32 v[220:221], v[96:97], v[232:233]
  v_pk_mul_f32 v[222:223], v[98:99], v[232:233]
  v_pk_mul_f32 v[224:225], v[100:101], v[232:233]
  v_pk_mul_f32 v[226:227], v[102:103], v[232:233]
  v_pk_fma_f32 v[220:221], v[188:189], v[234:235], v[220:221]
  v_pk_fma_f32 v[222:223], v[190:191], v[234:235], v[222:223]
  v_pk_fma_f32 v[224:225], v[192:193], v[234:235], v[224:225]
  v_pk_fma_f32 v[226:227], v[194:195], v[234:235], v[226:227]
  v_cvt_pk_bf16_f32 v212, v220, v221
  v_cvt_pk_bf16_f32 v213, v222, v223
  v_cvt_pk_bf16_f32 v214, v224, v225
  v_cvt_pk_bf16_f32 v215, v226, v227
  v_dot2_f32_bf16 v237, v212, v212, 0
  v_dot2_f32_bf16 v238, v214, v214, 0
  v_dot2_f32_bf16 v237, v213, v213, v237
  v_dot2_f32_bf16 v238, v215, v215, v238
  v_permlane32_swap_b32 v212, v214
  v_permlane32_swap_b32 v213, v215
  s_nop 0
  v_max3_f32 v236, v237, v238, v236
  s_not_b64 exec, s[60:61]
  buffer_store_dwordx4 v[212:215], v162, s[16:19], s28 offen sc1
  s_mov_b64 exec, s[60:61]
  s_cbranch_execz k1_ns7
  buffer_store_dwordx2 v[212:213], v162, s[16:19], s28 offen sc1
  buffer_store_dwordx2 v[214:215], v162, s[16:19], s47 offen sc1
k1_ns7:
  s_mov_b64 exec, -1
  v_pk_mul_f32 v[220:221], v[104:105], v[232:233]
  v_pk_mul_f32 v[222:223], v[106:107], v[232:233]
  v_pk_mul_f32 v[224:225], v[108:109], v[232:233]
  v_pk_mul_f32 v[226:227], v[110:111], v[232:233]
  v_pk_fma_f32 v[220:221], v[196:197], v[234:235], v[220:221]
  v_pk_fma_f32 v[222:223], v[198:199], v[234:235], v[222:223]
  v_pk_fma_f32 v[224:225], v[200:201], v[234:235], v[224:225]
  v_pk_fma_f32 v[226:227], v[202:203], v[234:235], v[226:227]
  v_cvt_pk_bf16_f32 v216, v220, v221
  v_cvt_pk_bf16_f32 v217, v222, v223
  v_cvt_pk_bf16_f32 v218, v224, v225
  v_cvt_pk_bf16_f32 v219, v226, v227
  v_dot2_f32_bf16 v237, v216, v216, 0
  v_dot2_f32_bf16 v238, v218, v218, 0
  v_dot2_f32_bf16 v237, v217, v217, v237
  v_dot2_f32_bf16 v238, v219, v219, v238
  v_permlane32_swap_b32 v216, v218
  v_permlane32_swap_b32 v217, v219
  s_nop 0
  v_max3_f32 v236, v237, v238, v236
  s_not_b64 exec, s[62:63]
  buffer_store_dwordx4 v[216:219], v163, s[16:19], s28 offen sc1
  s_mov_b64 exec, s[62:63]
  s_cbranch_execz k1_ns8
  buffer_store_dwordx2 v[216:217], v163, s[16:19], s28 offen sc1
  buffer_store_dwordx2 v[218:219], v163, s[16:19], s47 offen sc1
k1_ns8:
  s_mov_b64 exec, -1
  v_max_f32_dpp v236, v236, v236 row_ror:8 row_mask:0xf bank_mask:0xf
  s_nop 1
  v_max_f32_dpp v236, v236, v236 row_ror:4 row_mask:0xf bank_mask:0xf
  s_nop 1
  v_max_f32_dpp v236, v236, v236 row_ror:2 row_mask:0xf bank_mask:0xf
  s_nop 1
  v_max_f32_dpp v236, v236, v236 row_ror:1 row_mask:0xf bank_mask:0xf
  v_lshrrev_b32 v1, 4, v0
  s_lshl_b32 s27, s24, 4
  v_lshl_add_u32 v1, v1, 2, s27
  ds_write_b32 v1, v236 offset:2048
k1_qdone:
  s_lshl_b32 s67, s26, 11
  s_lshl_b32 s28, s25, 7
  s_add_u32 s67, s67, s28
  s_add_u32 s67, s67, 65536
  s_mov_b64 exec, -1
  s_mov_b32 s48, s6
  s_mov_b32 s49, s7
  s_mov_b32 s50, 0x0
  s_mov_b32 s51, 0x00020000
  s_mov_b32 s52, s6
  s_mov_b32 s53, s7
  s_mov_b32 s54, 0x0
  s_mov_b32 s55, 0x00020000
  v_mov_b32 v140, 0
  v_mov_b32 v141, 0
  v_mov_b32 v142, 0
  v_mov_b32 v143, 0
  s_setprio 0
  s_branch k2_entry
k1_vpath:
  s_add_u32 s16, s6, 0x280000
  s_addc_u32 s17, s7, 0
  s_mov_b32 s18, 0x500000
  s_mov_b32 s19, 0x00020000
  s_mov_b32 s39, 1.0
  s_sub_u32 s29, s26, 10
  s_lshl_b32 s29, s29, 7
  s_mov_b32 s37, 163840
  s_xor_b32 s27, s40, 0
  s_lshl_b32 s27, s27, 5
  s_add_u32 s27, s27, s29
  v_add_u32 v1, s27, v45
  v_mul_u32_u24 v2, 3277, v1
  v_lshrrev_b32 v2, 16, v2
  v_mul_u32_u24 v3, 20, v2
  v_sub_u32 v3, v1, v3
  v_mul_lo_u32 v160, v2, s37
  v_lshl_add_u32 v160, v3, 4, v160
  v_mul_u32_u24 v4, 320, v46
  v_add_u32 v160, v160, v4
  s_xor_b32 s27, s40, 1
  s_lshl_b32 s27, s27, 5
  s_add_u32 s27, s27, s29
  v_add_u32 v1, s27, v45
  v_mul_u32_u24 v2, 3277, v1
  v_lshrrev_b32 v2, 16, v2
  v_mul_u32_u24 v3, 20, v2
  v_sub_u32 v3, v1, v3
  v_mul_lo_u32 v161, v2, s37
  v_lshl_add_u32 v161, v3, 4, v161
  v_mul_u32_u24 v4, 320, v46
  v_add_u32 v161, v161, v4
  s_setprio 2
  s_barrier
  ds_read_b128 v[112:115], v15 offset:0
  ds_read_b64_tr_b16 v[128:129], v39 offset:0
  ds_read_b64_tr_b16 v[130:131], v39 offset:1024
  ds_read_b64_tr_b16 v[148:149], v40 offset:0
  ds_read_b64_tr_b16 v[150:151], v40 offset:1024
  ds_read_b128 v[116:119], v19 offset:0
  s_waitcnt lgkmcnt(3)
  v_mfma_f32_32x32x16_bf16 v[48:63], v[112:115], v[128:131], 0
  ds_read_b128 v[120:123], v16 offset:0
  ds_read_b64_tr_b16 v[132:133], v39 offset:4096
  ds_read_b64_tr_b16 v[134:135], v39 offset:5120
  s_waitcnt lgkmcnt(4)
  v_mfma_f32_32x32x16_bf16 v[64:79], v[112:115], v[148:151], 0
  ds_read_b64_tr_b16 v[152:153], v40 offset:4096
  ds_read_b64_tr_b16 v[154:155], v40 offset:5120
  s_waitcnt lgkmcnt(5)
  v_mfma_f32_32x32x16_bf16 v[80:95], v[116:119], v[128:131], 0
  ds_read_b128 v[124:127], v20 offset:0
  v_mfma_f32_32x32x16_bf16 v[96:111], v[116:119], v[148:151], 0
  s_waitcnt lgkmcnt(3)
  v_mfma_f32_32x32x16_bf16 v[48:63], v[120:123], v[132:135], v[48:63]
  ds_read_b128 v[112:115], v17 offset:0
  ds_read_b64_tr_b16 v[136:137], v39 offset:8192
  ds_read_b64_tr_b16 v[138:139], v39 offset:9216
  s_waitcnt lgkmcnt(4)
  v_mfma_f32_32x32x16_bf16 v[64:79], v[120:123], v[152:155], v[64:79]
  ds_read_b64_tr_b16 v[148:149], v40 offset:8192
  ds_read_b64_tr_b16 v[150:151], v40 offset:9216
  s_waitcnt lgkmcnt(5)
  v_mfma_f32_32x32x16_bf16 v[80:95], v[124:127], v[132:135], v[80:95]
  ds_read_b128 v[116:119], v21 offset:0
  v_mfma_f32_32x32x16_bf16 v[96:111], v[124:127], v[152:155], v[96:111]
  s_waitcnt lgkmcnt(3)
  v_mfma_f32_32x32x16_bf16 v[48:63], v[112:115], v[136:139], v[48:63]
  ds_read_b128 v[120:123], v18 offset:0
  ds_read_b64_tr_b16 v[140:141], v39 offset:12288
  ds_read_b64_tr_b16 v[142:143], v39 offset:13312
  s_waitcnt lgkmcnt(4)
  v_mfma_f32_32x32x16_bf16 v[64:79], v[112:115], v[148:151], v[64:79]
  ds_read_b64_tr_b16 v[152:153], v40 offset:12288
  ds_read_b64_tr_b16 v[154:155], v40 offset:13312
  s_waitcnt lgkmcnt(5)
  v_mfma_f32_32x32x16_bf16 v[80:95], v[116:119], v[136:139], v[80:95]
  ds_read_b128 v[124:127], v22 offset:0
  v_mfma_f32_32x32x16_bf16 v[96:111], v[116:119], v[148:151], v[96:111]
  s_waitcnt lgkmcnt(3)
  v_mfma_f32_32x32x16_bf16 v[48:63], v[120:123], v[140:143], v[48:63]
  s_barrier
  ds_read_b128 v[112:115], v15 offset:32768
  ds_read_b64_tr_b16 v[144:145], v39 offset:32768
  ds_read_b64_tr_b16 v[146:147], v39 offset:33792
  s_waitcnt lgkmcnt(4)
  v_mfma_f32_32x32x16_bf16 v[64:79], v[120:123], v[152:155], v[64:79]
  ds_read_b64_tr_b16 v[148:149], v40 offset:32768
  ds_read_b64_tr_b16 v[150:151], v40 offset:33792
  s_waitcnt lgkmcnt(5)
  v_mfma_f32_32x32x16_bf16 v[80:95], v[124:127], v[140:143], v[80:95]
  ds_read_b128 v[116:119], v19 offset:32768
  v_mfma_f32_32x32x16_bf16 v[96:111], v[124:127], v[152:155], v[96:111]
  v_dot2_f32_bf16 v158, v128, s34, v158
  v_dot2_f32_bf16 v156, v129, s34, v156
  v_dot2_f32_bf16 v158, v130, s34, v158
  v_dot2_f32_bf16 v156, v131, s34, v156
  v_dot2_f32_bf16 v158, v132, s34, v158
  v_dot2_f32_bf16 v156, v133, s34, v156
  v_dot2_f32_bf16 v158, v134, s34, v158
  v_dot2_f32_bf16 v156, v135, s34, v156
  v_dot2_f32_bf16 v158, v136, s34, v158
  v_dot2_f32_bf16 v156, v137, s34, v156
  v_dot2_f32_bf16 v158, v138, s34, v158
  v_dot2_f32_bf16 v156, v139, s34, v156
  v_dot2_f32_bf16 v158, v140, s34, v158
  v_dot2_f32_bf16 v156, v141, s34, v156
  v_dot2_f32_bf16 v158, v142, s34, v158
  v_dot2_f32_bf16 v156, v143, s34, v156
  s_waitcnt lgkmcnt(3)
  v_mfma_f32_32x32x16_bf16 v[48:63], v[112:115], v[144:147], v[48:63]
  ds_read_b128 v[120:123], v16 offset:32768
  ds_read_b64_tr_b16 v[128:129], v39 offset:36864
  ds_read_b64_tr_b16 v[130:131], v39 offset:37888
  s_waitcnt lgkmcnt(4)
  v_mfma_f32_32x32x16_bf16 v[64:79], v[112:115], v[148:151], v[64:79]
  ds_read_b64_tr_b16 v[152:153], v40 offset:36864
  ds_read_b64_tr_b16 v[154:155], v40 offset:37888
  s_waitcnt lgkmcnt(5)
  v_mfma_f32_32x32x16_bf16 v[80:95], v[116:119], v[144:147], v[80:95]
  ds_read_b128 v[124:127], v20 offset:32768
  v_mfma_f32_32x32x16_bf16 v[96:111], v[116:119], v[148:151], v[96:111]
  s_waitcnt lgkmcnt(3)
  v_mfma_f32_32x32x16_bf16 v[48:63], v[120:123], v[128:131], v[48:63]
  ds_read_b128 v[112:115], v17 offset:32768
  ds_read_b64_tr_b16 v[132:133], v39 offset:40960
  ds_read_b64_tr_b16 v[134:135], v39 offset:41984
  s_waitcnt lgkmcnt(4)
  v_mfma_f32_32x32x16_bf16 v[64:79], v[120:123], v[152:155], v[64:79]
  ds_read_b64_tr_b16 v[148:149], v40 offset:40960
  ds_read_b64_tr_b16 v[150:151], v40 offset:41984
  s_waitcnt lgkmcnt(5)
  v_mfma_f32_32x32x16_bf16 v[80:95], v[124:127], v[128:131], v[80:95]
  ds_read_b128 v[116:119], v21 offset:32768
  v_mfma_f32_32x32x16_bf16 v[96:111], v[124:127], v[152:155], v[96:111]
  s_waitcnt lgkmcnt(3)
  v_mfma_f32_32x32x16_bf16 v[48:63], v[112:115], v[132:135], v[48:63]
  ds_read_b128 v[120:123], v18 offset:32768
  ds_read_b64_tr_b16 v[136:137], v39 offset:45056
  ds_read_b64_tr_b16 v[138:139], v39 offset:46080
  s_waitcnt lgkmcnt(4)
  v_mfma_f32_32x32x16_bf16 v[64:79], v[112:115], v[148:151], v[64:79]
  ds_read_b64_tr_b16 v[152:153], v40 offset:45056
  ds_read_b64_tr_b16 v[154:155], v40 offset:46080
  s_waitcnt lgkmcnt(5)
  v_mfma_f32_32x32x16_bf16 v[80:95], v[116:119], v[132:135], v[80:95]
  ds_read_b128 v[124:127], v22 offset:32768
  v_mfma_f32_32x32x16_bf16 v[96:111], v[116:119], v[148:151], v[96:111]
  s_waitcnt lgkmcnt(3)
  v_mfma_f32_32x32x16_bf16 v[48:63], v[120:123], v[136:139], v[48:63]
  s_barrier
  ds_read_b128 v[112:115], v23 offset:0
  ds_read_b64_tr_b16 v[140:141], v41 offset:0
  ds_read_b64_tr_b16 v[142:143], v41 offset:1024
  s_waitcnt lgkmcnt(4)
  v_mfma_f32_32x32x16_bf16 v[64:79], v[120:123], v[152:155], v[64:79]
  ds_read_b64_tr_b16 v[148:149], v42 offset:0
  ds_read_b64_tr_b16 v[150:151], v42 offset:1024
  s_waitcnt lgkmcnt(5)
  v_mfma_f32_32x32x16_bf16 v[80:95], v[124:127], v[136:139], v[80:95]
  ds_read_b128 v[116:119], v27 offset:0
  v_mfma_f32_32x32x16_bf16 v[96:111], v[124:127], v[152:155], v[96:111]
  v_dot2_f32_bf16 v158, v144, s34, v158
  v_dot2_f32_bf16 v156, v145, s34, v156
  v_dot2_f32_bf16 v158, v146, s34, v158
  v_dot2_f32_bf16 v156, v147, s34, v156
  v_dot2_f32_bf16 v158, v128, s34, v158
  v_dot2_f32_bf16 v156, v129, s34, v156
  v_dot2_f32_bf16 v158, v130, s34, v158
  v_dot2_f32_bf16 v156, v131, s34, v156
  v_dot2_f32_bf16 v158, v132, s34, v158
  v_dot2_f32_bf16 v156, v133, s34, v156
  v_dot2_f32_bf16 v158, v134, s34, v158
  v_dot2_f32_bf16 v156, v135, s34, v156
  v_dot2_f32_bf16 v158, v136, s34, v158
  v_dot2_f32_bf16 v156, v137, s34, v156
  v_dot2_f32_bf16 v158, v138, s34, v158
  v_dot2_f32_bf16 v156, v139, s34, v156
  s_waitcnt lgkmcnt(3)
  v_mfma_f32_32x32x16_bf16 v[48:63], v[112:115], v[140:143], v[48:63]
  ds_read_b128 v[120:123], v24 offset:0
  ds_read_b64_tr_b16 v[144:145], v41 offset:4096
  ds_read_b64_tr_b16 v[146:147], v41 offset:5120
  s_waitcnt lgkmcnt(4)
  v_mfma_f32_32x32x16_bf16 v[64:79], v[112:115], v[148:151], v[64:79]
  ds_read_b64_tr_b16 v[152:153], v42 offset:4096
  ds_read_b64_tr_b16 v[154:155], v42 offset:5120
  s_waitcnt lgkmcnt(5)
  v_mfma_f32_32x32x16_bf16 v[80:95], v[116:119], v[140:143], v[80:95]
  ds_read_b128 v[124:127], v28 offset:0
  v_mfma_f32_32x32x16_bf16 v[96:111], v[116:119], v[148:151], v[96:111]
  s_waitcnt lgkmcnt(3)
  v_mfma_f32_32x32x16_bf16 v[48:63], v[120:123], v[144:147], v[48:63]
  ds_read_b128 v[112:115], v25 offset:0
  ds_read_b64_tr_b16 v[128:129], v41 offset:8192
  ds_read_b64_tr_b16 v[130:131], v41 offset:9216
  s_waitcnt lgkmcnt(4)
  v_mfma_f32_32x32x16_bf16 v[64:79], v[120:123], v[152:155], v[64:79]
  ds_read_b64_tr_b16 v[148:149], v42 offset:8192
  ds_read_b64_tr_b16 v[150:151], v42 offset:9216
  s_waitcnt lgkmcnt(5)
  v_mfma_f32_32x32x16_bf16 v[80:95], v[124:127], v[144:147], v[80:95]
  ds_read_b128 v[116:119], v29 offset:0
  v_mfma_f32_32x32x16_bf16 v[96:111], v[124:127], v[152:155], v[96:111]
  s_waitcnt lgkmcnt(3)
  v_mfma_f32_32x32x16_bf16 v[48:63], v[112:115], v[128:131], v[48:63]
  ds_read_b128 v[120:123], v26 offset:0
  ds_read_b64_tr_b16 v[132:133], v41 offset:12288
  ds_read_b64_tr_b16 v[134:135], v41 offset:13312
  s_waitcnt lgkmcnt(4)
  v_mfma_f32_32x32x16_bf16 v[64:79], v[112:115], v[148:151], v[64:79]
  ds_read_b64_tr_b16 v[152:153], v42 offset:12288
  ds_read_b64_tr_b16 v[154:155], v42 offset:13312
  s_waitcnt lgkmcnt(5)
  v_mfma_f32_32x32x16_bf16 v[80:95], v[116:119], v[128:131], v[80:95]
  ds_read_b128 v[124:127], v30 offset:0
  v_mfma_f32_32x32x16_bf16 v[96:111], v[116:119], v[148:151], v[96:111]
  s_waitcnt lgkmcnt(3)
  v_mfma_f32_32x32x16_bf16 v[48:63], v[120:123], v[132:135], v[48:63]
  s_barrier
  ds_read_b128 v[112:115], v23 offset:32768
  ds_read_b64_tr_b16 v[136:137], v41 offset:32768
  ds_read_b64_tr_b16 v[138:139], v41 offset:33792
  s_waitcnt lgkmcnt(4)
  v_mfma_f32_32x32x16_bf16 v[64:79], v[120:123], v[152:155], v[64:79]
  ds_read_b64_tr_b16 v[148:149], v42 offset:32768
  ds_read_b64_tr_b16 v[150:151], v42 offset:33792
  s_waitcnt lgkmcnt(5)
  v_mfma_f32_32x32x16_bf16 v[80:95], v[124:127], v[132:135], v[80:95]
  ds_read_b128 v[116:119], v27 offset:32768
  v_mfma_f32_32x32x16_bf16 v[96:111], v[124:127], v[152:155], v[96:111]
  v_dot2_f32_bf16 v158, v140, s34, v158
  v_dot2_f32_bf16 v156, v141, s34, v156
  v_dot2_f32_bf16 v158, v142, s34, v158
  v_dot2_f32_bf16 v156, v143, s34, v156
  v_dot2_f32_bf16 v158, v144, s34, v158
  v_dot2_f32_bf16 v156, v145, s34, v156
  v_dot2_f32_bf16 v158, v146, s34, v158
  v_dot2_f32_bf16 v156, v147, s34, v156
  v_dot2_f32_bf16 v158, v128, s34, v158
  v_dot2_f32_bf16 v156, v129, s34, v156
  v_dot2_f32_bf16 v158, v130, s34, v158
  v_dot2_f32_bf16 v156, v131, s34, v156
  v_dot2_f32_bf16 v158, v132, s34, v158
  v_dot2_f32_bf16 v156, v133, s34, v156
  v_dot2_f32_bf16 v158, v134, s34, v158
  v_dot2_f32_bf16 v156, v135, s34, v156
  s_waitcnt lgkmcnt(3)
  v_mfma_f32_32x32x16_bf16 v[48:63], v[112:115], v[136:139], v[48:63]
  ds_read_b128 v[120:123], v24 offset:32768
  ds_read_b64_tr_b16 v[140:141], v41 offset:36864
  ds_read_b64_tr_b16 v[142:143], v41 offset:37888
  s_waitcnt lgkmcnt(4)
  v_mfma_f32_32x32x16_bf16 v[64:79], v[112:115], v[148:151], v[64:79]
  ds_read_b64_tr_b16 v[152:153], v42 offset:36864
  ds_read_b64_tr_b16 v[154:155], v42 offset:37888
  s_waitcnt lgkmcnt(5)
  v_mfma_f32_32x32x16_bf16 v[80:95], v[116:119], v[136:139], v[80:95]
  ds_read_b128 v[124:127], v28 offset:32768
  v_mfma_f32_32x32x16_bf16 v[96:111], v[116:119], v[148:151], v[96:111]
  s_waitcnt lgkmcnt(3)
  v_mfma_f32_32x32x16_bf16 v[48:63], v[120:123], v[140:143], v[48:63]
  ds_read_b128 v[112:115], v25 offset:32768
  ds_read_b64_tr_b16 v[144:145], v41 offset:40960
  ds_read_b64_tr_b16 v[146:147], v41 offset:41984
  s_waitcnt lgkmcnt(4)
  v_mfma_f32_32x32x16_bf16 v[64:79], v[120:123], v[152:155], v[64:79]
  ds_read_b64_tr_b16 v[148:149], v42 offset:40960
  ds_read_b64_tr_b16 v[150:151], v42 offset:41984
  s_waitcnt lgkmcnt(5)
  v_mfma_f32_32x32x16_bf16 v[80:95], v[124:127], v[140:143], v[80:95]
  ds_read_b128 v[116:119], v29 offset:32768
  v_mfma_f32_32x32x16_bf16 v[96:111], v[124:127], v[152:155], v[96:111]
  s_waitcnt lgkmcnt(3)
  v_mfma_f32_32x32x16_bf16 v[48:63], v[112:115], v[144:147], v[48:63]
  ds_read_b128 v[120:123], v26 offset:32768
  ds_read_b64_tr_b16 v[128:129], v41 offset:45056
  ds_read_b64_tr_b16 v[130:131], v41 offset:46080
  s_waitcnt lgkmcnt(4)
  v_mfma_f32_32x32x16_bf16 v[64:79], v[112:115], v[148:151], v[64:79]
  ds_read_b64_tr_b16 v[152:153], v42 offset:45056
  ds_read_b64_tr_b16 v[154:155], v42 offset:46080
  s_waitcnt lgkmcnt(5)
  v_mfma_f32_32x32x16_bf16 v[80:95], v[116:119], v[144:147], v[80:95]
  ds_read_b128 v[124:127], v30 offset:32768
  v_mfma_f32_32x32x16_bf16 v[96:111], v[116:119], v[148:151], v[96:111]
  s_waitcnt lgkmcnt(3)
  v_mfma_f32_32x32x16_bf16 v[48:63], v[120:123], v[128:131], v[48:63]
  s_barrier
  ds_read_b128 v[112:115], v31 offset:0
  ds_read_b64_tr_b16 v[132:133], v43 offset:0
  ds_read_b64_tr_b16 v[134:135], v43 offset:1024
  s_waitcnt lgkmcnt(4)
  v_mfma_f32_32x32x16_bf16 v[64:79], v[120:123], v[152:155], v[64:79]
  ds_read_b64_tr_b16 v[148:149], v44 offset:0
  ds_read_b64_tr_b16 v[150:151], v44 offset:1024
  s_waitcnt lgkmcnt(5)
  v_mfma_f32_32x32x16_bf16 v[80:95], v[124:127], v[128:131], v[80:95]
  ds_read_b128 v[116:119], v35 offset:0
  v_mfma_f32_32x32x16_bf16 v[96:111], v[124:127], v[152:155], v[96:111]
  v_dot2_f32_bf16 v158, v136, s34, v158
  v_dot2_f32_bf16 v156, v137, s34, v156
  v_dot2_f32_bf16 v158, v138, s34, v158
  v_dot2_f32_bf16 v156, v139, s34, v156
  v_dot2_f32_bf16 v158, v140, s34, v158
  v_dot2_f32_bf16 v156, v141, s34, v156
  v_dot2_f32_bf16 v158, v142, s34, v158
  v_dot2_f32_bf16 v156, v143, s34, v156
  v_dot2_f32_bf16 v158, v144, s34, v158
  v_dot2_f32_bf16 v156, v145, s34, v156
  v_dot2_f32_bf16 v158, v146, s34, v158
  v_dot2_f32_bf16 v156, v147, s34, v156
  v_dot2_f32_bf16 v158, v128, s34, v158
  v_dot2_f32_bf16 v156, v129, s34, v156
  v_dot2_f32_bf16 v158, v130, s34, v158
  v_dot2_f32_bf16 v156, v131, s34, v156
  s_waitcnt lgkmcnt(3)
  v_mfma_f32_32x32x16_bf16 v[48:63], v[112:115], v[132:135], v[48:63]
  ds_read_b128 v[120:123], v32 offset:0
  ds_read_b64_tr_b16 v[136:137], v43 offset:4096
  ds_read_b64_tr_b16 v[138:139], v43 offset:5120
  s_waitcnt lgkmcnt(4)
  v_mfma_f32_32x32x16_bf16 v[64:79], v[112:115], v[148:151], v[64:79]
  ds_read_b64_tr_b16 v[152:153], v44 offset:4096
  ds_read_b64_tr_b16 v[154:155], v44 offset:5120
  s_waitcnt lgkmcnt(5)
  v_mfma_f32_32x32x16_bf16 v[80:95], v[116:119], v[132:135], v[80:95]
  ds_read_b128 v[124:127], v36 offset:0
  v_mfma_f32_32x32x16_bf16 v[96:111], v[116:119], v[148:151], v[96:111]
  s_waitcnt lgkmcnt(3)
  v_mfma_f32_32x32x16_bf16 v[48:63], v[120:123], v[136:139], v[48:63]
  ds_read_b128 v[112:115], v33 offset:0
  ds_read_b64_tr_b16 v[140:141], v43 offset:8192
  ds_read_b64_tr_b16 v[142:143], v43 offset:9216
  s_waitcnt lgkmcnt(4)
  v_mfma_f32_32x32x16_bf16 v[64:79], v[120:123], v[152:155], v[64:79]
  ds_read_b64_tr_b16 v[148:149], v44 offset:8192
  ds_read_b64_tr_b16 v[150:151], v44 offset:9216
  s_waitcnt lgkmcnt(5)
  v_mfma_f32_32x32x16_bf16 v[80:95], v[124:127], v[136:139], v[80:95]
  ds_read_b128 v[116:119], v37 offset:0
  v_mfma_f32_32x32x16_bf16 v[96:111], v[124:127], v[152:155], v[96:111]
  s_waitcnt lgkmcnt(3)
  v_mfma_f32_32x32x16_bf16 v[48:63], v[112:115], v[140:143], v[48:63]
  ds_read_b128 v[120:123], v34 offset:0
  ds_read_b64_tr_b16 v[144:145], v43 offset:12288
  ds_read_b64_tr_b16 v[146:147], v43 offset:13312
  s_waitcnt lgkmcnt(4)
  v_mfma_f32_32x32x16_bf16 v[64:79], v[112:115], v[148:151], v[64:79]
  ds_read_b64_tr_b16 v[152:153], v44 offset:12288
  ds_read_b64_tr_b16 v[154:155], v44 offset:13312
  s_waitcnt lgkmcnt(5)
  v_mfma_f32_32x32x16_bf16 v[80:95], v[116:119], v[140:143], v[80:95]
  ds_read_b128 v[124:127], v38 offset:0
  v_mfma_f32_32x32x16_bf16 v[96:111], v[116:119], v[148:151], v[96:111]
  s_waitcnt lgkmcnt(3)
  v_mfma_f32_32x32x16_bf16 v[48:63], v[120:123], v[144:147], v[48:63]
  s_barrier
  ds_read_b128 v[112:115], v15 offset:0
  ds_read_b64_tr_b16 v[128:129], v39 offset:0
  ds_read_b64_tr_b16 v[130:131], v39 offset:1024
  s_waitcnt lgkmcnt(4)
  v_mfma_f32_32x32x16_bf16 v[64:79], v[120:123], v[152:155], v[64:79]
  ds_read_b64_tr_b16 v[148:149], v40 offset:0
  ds_read_b64_tr_b16 v[150:151], v40 offset:1024
  s_waitcnt lgkmcnt(5)
  v_mfma_f32_32x32x16_bf16 v[80:95], v[124:127], v[144:147], v[80:95]
  ds_read_b128 v[116:119], v19 offset:0
  v_mfma_f32_32x32x16_bf16 v[96:111], v[124:127], v[152:155], v[96:111]
  v_dot2_f32_bf16 v158, v132, s34, v158
  v_dot2_f32_bf16 v156, v133, s34, v156
  v_dot2_f32_bf16 v158, v134, s34, v158
  v_dot2_f32_bf16 v156, v135, s34, v156
  v_dot2_f32_bf16 v158, v136, s34, v158
  v_dot2_f32_bf16 v156, v137, s34, v156
  v_dot2_f32_bf16 v158, v138, s34, v158
  v_dot2_f32_bf16 v156, v139, s34, v156
  v_dot2_f32_bf16 v158, v140, s34, v158
  v_dot2_f32_bf16 v156, v141, s34, v156
  v_dot2_f32_bf16 v158, v142, s34, v158
  v_dot2_f32_bf16 v156, v143, s34, v156
  v_dot2_f32_bf16 v158, v144, s34, v158
  v_dot2_f32_bf16 v156, v145, s34, v156
  v_dot2_f32_bf16 v158, v146, s34, v158
  v_dot2_f32_bf16 v156, v147, s34, v156
  s_waitcnt lgkmcnt(3)
  v_mfma_f32_32x32x16_bf16 v[48:63], v[112:115], v[128:131], v[48:63]
  ds_read_b128 v[120:123], v16 offset:0
  ds_read_b64_tr_b16 v[132:133], v39 offset:4096
  ds_read_b64_tr_b16 v[134:135], v39 offset:5120
  s_waitcnt lgkmcnt(4)
  v_mfma_f32_32x32x16_bf16 v[64:79], v[112:115], v[148:151], v[64:79]
  ds_read_b64_tr_b16 v[152:153], v40 offset:4096
  ds_read_b64_tr_b16 v[154:155], v40 offset:5120
  s_waitcnt lgkmcnt(5)
  v_mfma_f32_32x32x16_bf16 v[80:95], v[116:119], v[128:131], v[80:95]
  ds_read_b128 v[124:127], v20 offset:0
  v_mfma_f32_32x32x16_bf16 v[96:111], v[116:119], v[148:151], v[96:111]
  s_waitcnt lgkmcnt(3)
  v_mfma_f32_32x32x16_bf16 v[48:63], v[120:123], v[132:135], v[48:63]
  ds_read_b128 v[112:115], v17 offset:0
  ds_read_b64_tr_b16 v[136:137], v39 offset:8192
  ds_read_b64_tr_b16 v[138:139], v39 offset:9216
  s_waitcnt lgkmcnt(4)
  v_mfma_f32_32x32x16_bf16 v[64:79], v[120:123], v[152:155], v[64:79]
  ds_read_b64_tr_b16 v[148:149], v40 offset:8192
  ds_read_b64_tr_b16 v[150:151], v40 offset:9216
  s_waitcnt lgkmcnt(5)
  v_mfma_f32_32x32x16_bf16 v[80:95], v[124:127], v[132:135], v[80:95]
  ds_read_b128 v[116:119], v21 offset:0
  v_mfma_f32_32x32x16_bf16 v[96:111], v[124:127], v[152:155], v[96:111]
  s_waitcnt lgkmcnt(3)
  v_mfma_f32_32x32x16_bf16 v[48:63], v[112:115], v[136:139], v[48:63]
  ds_read_b128 v[120:123], v18 offset:0
  ds_read_b64_tr_b16 v[140:141], v39 offset:12288
  ds_read_b64_tr_b16 v[142:143], v39 offset:13312
  s_waitcnt lgkmcnt(4)
  v_mfma_f32_32x32x16_bf16 v[64:79], v[112:115], v[148:151], v[64:79]
  ds_read_b64_tr_b16 v[152:153], v40 offset:12288
  ds_read_b64_tr_b16 v[154:155], v40 offset:13312
  s_waitcnt lgkmcnt(5)
  v_mfma_f32_32x32x16_bf16 v[80:95], v[116:119], v[136:139], v[80:95]
  ds_read_b128 v[124:127], v22 offset:0
  v_mfma_f32_32x32x16_bf16 v[96:111], v[116:119], v[148:151], v[96:111]
  s_waitcnt lgkmcnt(3)
  v_mfma_f32_32x32x16_bf16 v[48:63], v[120:123], v[140:143], v[48:63]
  s_barrier
  ds_read_b128 v[112:115], v15 offset:32768
  ds_read_b64_tr_b16 v[144:145], v39 offset:32768
  ds_read_b64_tr_b16 v[146:147], v39 offset:33792
  s_waitcnt lgkmcnt(4)
  v_mfma_f32_32x32x16_bf16 v[64:79], v[120:123], v[152:155], v[64:79]
  ds_read_b64_tr_b16 v[148:149], v40 offset:32768
  ds_read_b64_tr_b16 v[150:151], v40 offset:33792
  s_waitcnt lgkmcnt(5)
  v_mfma_f32_32x32x16_bf16 v[80:95], v[124:127], v[140:143], v[80:95]
  ds_read_b128 v[116:119], v19 offset:32768
  v_mfma_f32_32x32x16_bf16 v[96:111], v[124:127], v[152:155], v[96:111]
  v_dot2_f32_bf16 v158, v128, s34, v158
  v_dot2_f32_bf16 v156, v129, s34, v156
  v_dot2_f32_bf16 v158, v130, s34, v158
  v_dot2_f32_bf16 v156, v131, s34, v156
  v_dot2_f32_bf16 v158, v132, s34, v158
  v_dot2_f32_bf16 v156, v133, s34, v156
  v_dot2_f32_bf16 v158, v134, s34, v158
  v_dot2_f32_bf16 v156, v135, s34, v156
  v_dot2_f32_bf16 v158, v136, s34, v158
  v_dot2_f32_bf16 v156, v137, s34, v156
  v_dot2_f32_bf16 v158, v138, s34, v158
  v_dot2_f32_bf16 v156, v139, s34, v156
  v_dot2_f32_bf16 v158, v140, s34, v158
  v_dot2_f32_bf16 v156, v141, s34, v156
  v_dot2_f32_bf16 v158, v142, s34, v158
  v_dot2_f32_bf16 v156, v143, s34, v156
  s_waitcnt lgkmcnt(3)
  v_mfma_f32_32x32x16_bf16 v[48:63], v[112:115], v[144:147], v[48:63]
  ds_read_b128 v[120:123], v16 offset:32768
  ds_read_b64_tr_b16 v[128:129], v39 offset:36864
  ds_read_b64_tr_b16 v[130:131], v39 offset:37888
  s_waitcnt lgkmcnt(4)
  v_mfma_f32_32x32x16_bf16 v[64:79], v[112:115], v[148:151], v[64:79]
  ds_read_b64_tr_b16 v[152:153], v40 offset:36864
  ds_read_b64_tr_b16 v[154:155], v40 offset:37888
  s_waitcnt lgkmcnt(5)
  v_mfma_f32_32x32x16_bf16 v[80:95], v[116:119], v[144:147], v[80:95]
  ds_read_b128 v[124:127], v20 offset:32768
  v_mfma_f32_32x32x16_bf16 v[96:111], v[116:119], v[148:151], v[96:111]
  s_waitcnt lgkmcnt(3)
  v_mfma_f32_32x32x16_bf16 v[48:63], v[120:123], v[128:131], v[48:63]
  ds_read_b128 v[112:115], v17 offset:32768
  ds_read_b64_tr_b16 v[132:133], v39 offset:40960
  ds_read_b64_tr_b16 v[134:135], v39 offset:41984
  s_waitcnt lgkmcnt(4)
  v_mfma_f32_32x32x16_bf16 v[64:79], v[120:123], v[152:155], v[64:79]
  ds_read_b64_tr_b16 v[148:149], v40 offset:40960
  ds_read_b64_tr_b16 v[150:151], v40 offset:41984
  s_waitcnt lgkmcnt(5)
  v_mfma_f32_32x32x16_bf16 v[80:95], v[124:127], v[128:131], v[80:95]
  ds_read_b128 v[116:119], v21 offset:32768
  v_mfma_f32_32x32x16_bf16 v[96:111], v[124:127], v[152:155], v[96:111]
  s_waitcnt lgkmcnt(3)
  v_mfma_f32_32x32x16_bf16 v[48:63], v[112:115], v[132:135], v[48:63]
  ds_read_b128 v[120:123], v18 offset:32768
  ds_read_b64_tr_b16 v[136:137], v39 offset:45056
  ds_read_b64_tr_b16 v[138:139], v39 offset:46080
  s_waitcnt lgkmcnt(4)
  v_mfma_f32_32x32x16_bf16 v[64:79], v[112:115], v[148:151], v[64:79]
  ds_read_b64_tr_b16 v[152:153], v40 offset:45056
  ds_read_b64_tr_b16 v[154:155], v40 offset:46080
  s_waitcnt lgkmcnt(5)
  v_mfma_f32_32x32x16_bf16 v[80:95], v[116:119], v[132:135], v[80:95]
  ds_read_b128 v[124:127], v22 offset:32768
  v_mfma_f32_32x32x16_bf16 v[96:111], v[116:119], v[148:151], v[96:111]
  s_waitcnt lgkmcnt(3)
  v_mfma_f32_32x32x16_bf16 v[48:63], v[120:123], v[136:139], v[48:63]
  s_barrier
  ds_read_b128 v[112:115], v23 offset:0
  ds_read_b64_tr_b16 v[140:141], v41 offset:0
  ds_read_b64_tr_b16 v[142:143], v41 offset:1024
  s_waitcnt lgkmcnt(4)
  v_mfma_f32_32x32x16_bf16 v[64:79], v[120:123], v[152:155], v[64:79]
  ds_read_b64_tr_b16 v[148:149], v42 offset:0
  ds_read_b64_tr_b16 v[150:151], v42 offset:1024
  s_waitcnt lgkmcnt(5)
  v_mfma_f32_32x32x16_bf16 v[80:95], v[124:127], v[136:139], v[80:95]
  ds_read_b128 v[116:119], v27 offset:0
  v_mfma_f32_32x32x16_bf16 v[96:111], v[124:127], v[152:155], v[96:111]
  v_dot2_f32_bf16 v158, v144, s34, v158
  v_dot2_f32_bf16 v156, v145, s34, v156
  v_dot2_f32_bf16 v158, v146, s34, v158
  v_dot2_f32_bf16 v156, v147, s34, v156
  v_dot2_f32_bf16 v158, v128, s34, v158
  v_dot2_f32_bf16 v156, v129, s34, v156
  v_dot2_f32_bf16 v158, v130, s34, v158
  v_dot2_f32_bf16 v156, v131, s34, v156
  v_dot2_f32_bf16 v158, v132, s34, v158
  v_dot2_f32_bf16 v156, v133, s34, v156
  v_dot2_f32_bf16 v158, v134, s34, v158
  v_dot2_f32_bf16 v156, v135, s34, v156
  v_dot2_f32_bf16 v158, v136, s34, v158
  v_dot2_f32_bf16 v156, v137, s34, v156
  v_dot2_f32_bf16 v158, v138, s34, v158
  v_dot2_f32_bf16 v156, v139, s34, v156
  s_waitcnt lgkmcnt(3)
  v_mfma_f32_32x32x16_bf16 v[48:63], v[112:115], v[140:143], v[48:63]
  ds_read_b128 v[120:123], v24 offset:0
  ds_read_b64_tr_b16 v[144:145], v41 offset:4096
  ds_read_b64_tr_b16 v[146:147], v41 offset:5120
  s_waitcnt lgkmcnt(4)
  v_mfma_f32_32x32x16_bf16 v[64:79], v[112:115], v[148:151], v[64:79]
  ds_read_b64_tr_b16 v[152:153], v42 offset:4096
  ds_read_b64_tr_b16 v[154:155], v42 offset:5120
  s_waitcnt lgkmcnt(5)
  v_mfma_f32_32x32x16_bf16 v[80:95], v[116:119], v[140:143], v[80:95]
  ds_read_b128 v[124:127], v28 offset:0
  v_mfma_f32_32x32x16_bf16 v[96:111], v[116:119], v[148:151], v[96:111]
  s_waitcnt lgkmcnt(3)
  v_mfma_f32_32x32x16_bf16 v[48:63], v[120:123], v[144:147], v[48:63]
  ds_read_b128 v[112:115], v25 offset:0
  ds_read_b64_tr_b16 v[128:129], v41 offset:8192
  ds_read_b64_tr_b16 v[130:131], v41 offset:9216
  s_waitcnt lgkmcnt(4)
  v_mfma_f32_32x32x16_bf16 v[64:79], v[120:123], v[152:155], v[64:79]
  ds_read_b64_tr_b16 v[148:149], v42 offset:8192
  ds_read_b64_tr_b16 v[150:151], v42 offset:9216
  s_waitcnt lgkmcnt(5)
  v_mfma_f32_32x32x16_bf16 v[80:95], v[124:127], v[144:147], v[80:95]
  ds_read_b128 v[116:119], v29 offset:0
  v_mfma_f32_32x32x16_bf16 v[96:111], v[124:127], v[152:155], v[96:111]
  global_load_dword v157, v159, s[50:51] sc1
  s_waitcnt lgkmcnt(3)
  v_mfma_f32_32x32x16_bf16 v[48:63], v[112:115], v[128:131], v[48:63]
  ds_read_b128 v[120:123], v26 offset:0
  ds_read_b64_tr_b16 v[132:133], v41 offset:12288
  ds_read_b64_tr_b16 v[134:135], v41 offset:13312
  s_waitcnt lgkmcnt(4)
  v_mfma_f32_32x32x16_bf16 v[64:79], v[112:115], v[148:151], v[64:79]
  ds_read_b64_tr_b16 v[152:153], v42 offset:12288
  ds_read_b64_tr_b16 v[154:155], v42 offset:13312
  s_waitcnt lgkmcnt(5)
  v_mfma_f32_32x32x16_bf16 v[80:95], v[116:119], v[128:131], v[80:95]
  ds_read_b128 v[124:127], v30 offset:0
  v_mfma_f32_32x32x16_bf16 v[96:111], v[116:119], v[148:151], v[96:111]
  s_waitcnt lgkmcnt(3)
  v_mfma_f32_32x32x16_bf16 v[48:63], v[120:123], v[132:135], v[48:63]
  s_barrier
  ds_read_b128 v[112:115], v23 offset:32768
  ds_read_b64_tr_b16 v[136:137], v41 offset:32768
  ds_read_b64_tr_b16 v[138:139], v41 offset:33792
  s_waitcnt lgkmcnt(4)
  v_mfma_f32_32x32x16_bf16 v[64:79], v[120:123], v[152:155], v[64:79]
  ds_read_b64_tr_b16 v[148:149], v42 offset:32768
  ds_read_b64_tr_b16 v[150:151], v42 offset:33792
  s_waitcnt lgkmcnt(5)
  v_mfma_f32_32x32x16_bf16 v[80:95], v[124:127], v[132:135], v[80:95]
  ds_read_b128 v[116:119], v27 offset:32768
  v_mfma_f32_32x32x16_bf16 v[96:111], v[124:127], v[152:155], v[96:111]
  v_dot2_f32_bf16 v158, v140, s34, v158
  v_dot2_f32_bf16 v156, v141, s34, v156
  v_dot2_f32_bf16 v158, v142, s34, v158
  v_dot2_f32_bf16 v156, v143, s34, v156
  v_dot2_f32_bf16 v158, v144, s34, v158
  v_dot2_f32_bf16 v156, v145, s34, v156
  v_dot2_f32_bf16 v158, v146, s34, v158
  v_dot2_f32_bf16 v156, v147, s34, v156
  v_dot2_f32_bf16 v158, v128, s34, v158
  v_dot2_f32_bf16 v156, v129, s34, v156
  v_dot2_f32_bf16 v158, v130, s34, v158
  v_dot2_f32_bf16 v156, v131, s34, v156
  v_dot2_f32_bf16 v158, v132, s34, v158
  v_dot2_f32_bf16 v156, v133, s34, v156
  v_dot2_f32_bf16 v158, v134, s34, v158
  v_dot2_f32_bf16 v156, v135, s34, v156
  s_waitcnt lgkmcnt(3)
  v_mfma_f32_32x32x16_bf16 v[48:63], v[112:115], v[136:139], v[48:63]
  ds_read_b128 v[120:123], v24 offset:32768
  ds_read_b64_tr_b16 v[140:141], v41 offset:36864
  ds_read_b64_tr_b16 v[142:143], v41 offset:37888
  s_waitcnt lgkmcnt(4)
  v_mfma_f32_32x32x16_bf16 v[64:79], v[112:115], v[148:151], v[64:79]
  ds_read_b64_tr_b16 v[152:153], v42 offset:36864
  ds_read_b64_tr_b16 v[154:155], v42 offset:37888
  s_waitcnt lgkmcnt(5)
  v_mfma_f32_32x32x16_bf16 v[80:95], v[116:119], v[136:139], v[80:95]
  ds_read_b128 v[124:127], v28 offset:32768
  v_mfma_f32_32x32x16_bf16 v[96:111], v[116:119], v[148:151], v[96:111]
  s_waitcnt lgkmcnt(3)
  v_mfma_f32_32x32x16_bf16 v[48:63], v[120:123], v[140:143], v[48:63]
  ds_read_b128 v[112:115], v25 offset:32768
  ds_read_b64_tr_b16 v[144:145], v41 offset:40960
  ds_read_b64_tr_b16 v[146:147], v41 offset:41984
  s_waitcnt lgkmcnt(4)
  v_mfma_f32_32x32x16_bf16 v[64:79], v[120:123], v[152:155], v[64:79]
  ds_read_b64_tr_b16 v[148:149], v42 offset:40960
  ds_read_b64_tr_b16 v[150:151], v42 offset:41984
  s_waitcnt lgkmcnt(5)
  v_mfma_f32_32x32x16_bf16 v[80:95], v[124:127], v[140:143], v[80:95]
  ds_read_b128 v[116:119], v29 offset:32768
  v_mfma_f32_32x32x16_bf16 v[96:111], v[124:127], v[152:155], v[96:111]
  s_waitcnt lgkmcnt(3)
  v_mfma_f32_32x32x16_bf16 v[48:63], v[112:115], v[144:147], v[48:63]
  ds_read_b128 v[120:123], v26 offset:32768
  ds_read_b64_tr_b16 v[128:129], v41 offset:45056
  ds_read_b64_tr_b16 v[130:131], v41 offset:46080
  s_waitcnt lgkmcnt(4)
  v_mfma_f32_32x32x16_bf16 v[64:79], v[112:115], v[148:151], v[64:79]
  ds_read_b64_tr_b16 v[152:153], v42 offset:45056
  ds_read_b64_tr_b16 v[154:155], v42 offset:46080
  s_waitcnt lgkmcnt(5)
  v_mfma_f32_32x32x16_bf16 v[80:95], v[116:119], v[144:147], v[80:95]
  ds_read_b128 v[124:127], v30 offset:32768
  v_mfma_f32_32x32x16_bf16 v[96:111], v[116:119], v[148:151], v[96:111]
  s_waitcnt lgkmcnt(3)
  v_mfma_f32_32x32x16_bf16 v[48:63], v[120:123], v[128:131], v[48:63]
  s_barrier
  ds_read_b128 v[112:115], v31 offset:0
  ds_read_b64_tr_b16 v[132:133], v43 offset:0
  ds_read_b64_tr_b16 v[134:135], v43 offset:1024
  s_waitcnt lgkmcnt(4)
  v_mfma_f32_32x32x16_bf16 v[64:79], v[120:123], v[152:155], v[64:79]
  ds_read_b64_tr_b16 v[148:149], v44 offset:0
  ds_read_b64_tr_b16 v[150:151], v44 offset:1024
  s_waitcnt lgkmcnt(5)
  v_mfma_f32_32x32x16_bf16 v[80:95], v[124:127], v[128:131], v[80:95]
  ds_read_b128 v[116:119], v35 offset:0
  v_mfma_f32_32x32x16_bf16 v[96:111], v[124:127], v[152:155], v[96:111]
  v_dot2_f32_bf16 v158, v136, s34, v158
  v_dot2_f32_bf16 v156, v137, s34, v156
  v_dot2_f32_bf16 v158, v138, s34, v158
  v_dot2_f32_bf16 v156, v139, s34, v156
  v_dot2_f32_bf16 v158, v140, s34, v158
  v_dot2_f32_bf16 v156, v141, s34, v156
  v_dot2_f32_bf16 v158, v142, s34, v158
  v_dot2_f32_bf16 v156, v143, s34, v156
  v_dot2_f32_bf16 v158, v144, s34, v158
  v_dot2_f32_bf16 v156, v145, s34, v156
  v_dot2_f32_bf16 v158, v146, s34, v158
  v_dot2_f32_bf16 v156, v147, s34, v156
  v_dot2_f32_bf16 v158, v128, s34, v158
  v_dot2_f32_bf16 v156, v129, s34, v156
  v_dot2_f32_bf16 v158, v130, s34, v158
  v_dot2_f32_bf16 v156, v131, s34, v156
  s_waitcnt vmcnt(0)
  v_cmp_eq_u32 vcc, 0, v157
  s_cbranch_vccnz k1_slowv
k1_sokv:
  s_lshl_b32 s27, s24, 7
  s_xor_b32 s28, s27, 128
  v_lshl_add_u32 v1, v46, 4, s27
  v_lshl_add_u32 v2, v46, 4, s28
  buffer_load_dwordx4 v[172:175], v1, s[52:55], s43 offen offset:0 sc1
  buffer_load_dwordx4 v[176:179], v1, s[52:55], s41 offen offset:0 sc1
  buffer_load_dwordx4 v[180:183], v1, s[52:55], s43 offen offset:32 sc1
  buffer_load_dwordx4 v[184:187], v1, s[52:55], s41 offen offset:32 sc1
  buffer_load_dwordx4 v[188:191], v1, s[52:55], s43 offen offset:64 sc1
  buffer_load_dwordx4 v[192:195], v1, s[52:55], s41 offen offset:64 sc1
  buffer_load_dwordx4 v[196:199], v1, s[52:55], s43 offen offset:96 sc1
  buffer_load_dwordx4 v[200:203], v1, s[52:55], s41 offen offset:96 sc1
  buffer_load_dwordx4 v[204:207], v2, s[52:55], s43 offen offset:0 sc1
  buffer_load_dwordx4 v[208:211], v2, s[52:55], s41 offen offset:0 sc1
  buffer_load_dwordx4 v[212:215], v2, s[52:55], s43 offen offset:32 sc1
  buffer_load_dwordx4 v[216:219], v2, s[52:55], s41 offen offset:32 sc1
  buffer_load_dwordx4 v[220:223], v2, s[52:55], s43 offen offset:64 sc1
  buffer_load_dwordx4 v[224:227], v2, s[52:55], s41 offen offset:64 sc1
  buffer_load_dwordx4 v[228:231], v2, s[52:55], s43 offen offset:96 sc1
  buffer_load_dwordx4 v[232:235], v2, s[52:55], s41 offen offset:96 sc1
  s_waitcnt lgkmcnt(3)
  v_mfma_f32_32x32x16_bf16 v[48:63], v[112:115], v[132:135], v[48:63]
  ds_read_b128 v[120:123], v32 offset:0
  ds_read_b64_tr_b16 v[136:137], v43 offset:4096
  ds_read_b64_tr_b16 v[138:139], v43 offset:5120
  s_waitcnt lgkmcnt(4)
  v_mfma_f32_32x32x16_bf16 v[64:79], v[112:115], v[148:151], v[64:79]
  ds_read_b64_tr_b16 v[152:153], v44 offset:4096
  ds_read_b64_tr_b16 v[154:155], v44 offset:5120
  s_waitcnt lgkmcnt(5)
  v_mfma_f32_32x32x16_bf16 v[80:95], v[116:119], v[132:135], v[80:95]
  ds_read_b128 v[124:127], v36 offset:0
  v_mfma_f32_32x32x16_bf16 v[96:111], v[116:119], v[148:151], v[96:111]
  s_waitcnt lgkmcnt(3)
  v_mfma_f32_32x32x16_bf16 v[48:63], v[120:123], v[136:139], v[48:63]
  ds_read_b128 v[112:115], v33 offset:0
  ds_read_b64_tr_b16 v[140:141], v43 offset:8192
  ds_read_b64_tr_b16 v[142:143], v43 offset:9216
  s_waitcnt lgkmcnt(4)
  v_mfma_f32_32x32x16_bf16 v[64:79], v[120:123], v[152:155], v[64:79]
  ds_read_b64_tr_b16 v[148:149], v44 offset:8192
  ds_read_b64_tr_b16 v[150:151], v44 offset:9216
  s_waitcnt lgkmcnt(5)
  v_mfma_f32_32x32x16_bf16 v[80:95], v[124:127], v[136:139], v[80:95]
  ds_read_b128 v[116:119], v37 offset:0
  v_mfma_f32_32x32x16_bf16 v[96:111], v[124:127], v[152:155], v[96:111]
  s_waitcnt lgkmcnt(3)
  v_mfma_f32_32x32x16_bf16 v[48:63], v[112:115], v[140:143], v[48:63]
  ds_read_b128 v[120:123], v34 offset:0
  ds_read_b64_tr_b16 v[144:145], v43 offset:12288
  ds_read_b64_tr_b16 v[146:147], v43 offset:13312
  s_waitcnt lgkmcnt(4)
  v_mfma_f32_32x32x16_bf16 v[64:79], v[112:115], v[148:151], v[64:79]
  ds_read_b64_tr_b16 v[152:153], v44 offset:12288
  ds_read_b64_tr_b16 v[154:155], v44 offset:13312
  s_waitcnt lgkmcnt(5)
  v_mfma_f32_32x32x16_bf16 v[80:95], v[116:119], v[140:143], v[80:95]
  ds_read_b128 v[124:127], v38 offset:0
  v_mfma_f32_32x32x16_bf16 v[96:111], v[116:119], v[148:151], v[96:111]
  s_waitcnt lgkmcnt(3)
  v_mfma_f32_32x32x16_bf16 v[48:63], v[120:123], v[144:147], v[48:63]
  s_waitcnt lgkmcnt(1)
  v_mfma_f32_32x32x16_bf16 v[64:79], v[120:123], v[152:155], v[64:79]
  s_waitcnt lgkmcnt(0)
  v_mfma_f32_32x32x16_bf16 v[80:95], v[124:127], v[144:147], v[80:95]
  v_mfma_f32_32x32x16_bf16 v[96:111], v[124:127], v[152:155], v[96:111]
  v_dot2_f32_bf16 v158, v132, s34, v158
  v_dot2_f32_bf16 v156, v133, s34, v156
  v_dot2_f32_bf16 v158, v134, s34, v158
  v_dot2_f32_bf16 v156, v135, s34, v156
  v_dot2_f32_bf16 v158, v136, s34, v158
  v_dot2_f32_bf16 v156, v137, s34, v156
  v_dot2_f32_bf16 v158, v138, s34, v158
  v_dot2_f32_bf16 v156, v139, s34, v156
  v_dot2_f32_bf16 v158, v140, s34, v158
  v_dot2_f32_bf16 v156, v141, s34, v156
  v_dot2_f32_bf16 v158, v142, s34, v158
  v_dot2_f32_bf16 v156, v143, s34, v156
  v_dot2_f32_bf16 v158, v144, s34, v158
  v_dot2_f32_bf16 v156, v145, s34, v156
  v_dot2_f32_bf16 v158, v146, s34, v158
  v_dot2_f32_bf16 v156, v147, s34, v156
  s_nop 2
  v_add_f32 v158, v158, v156
  v_mov_b32 v1, v158
  s_nop 1
  v_permlane32_swap_b32 v158, v1
  v_add_f32 v158, v158, v1
  s_lshl_b32 s27, s40, 7
  v_lshl_add_u32 v4, v45, 2, s27
  ds_write_b32 v4, v158 offset:1024
  s_waitcnt lgkmcnt(0)
  s_barrier
  s_lshl_b32 s27, s40, 7
  s_xor_b32 s28, s27, 128
  v_lshl_add_u32 v1, v45, 2, s27
  v_lshl_add_u32 v2, v45, 2, s28
  ds_read_b32 v168, v1 offset:1024
  ds_read_b32 v170, v2 offset:1024
  ds_read_b32 v169, v1 offset:1024
  ds_read_b32 v171, v2 offset:1024
  s_waitcnt vmcnt(0)
  s_lshl_b32 s27, s25, 2
  s_add_u32 s27, s27, s24
  s_xor_b32 s28, s27, 1
  s_mul_i32 s27, s27, 2560
  s_mul_i32 s28, s28, 2560
  s_waitcnt lgkmcnt(0)
  v_pk_mul_f32 v[112:113], v[48:49], v[172:173]
  v_pk_mul_f32 v[114:115], v[50:51], v[174:175]
  v_pk_mul_f32 v[116:117], v[52:53], v[180:181]
  v_pk_mul_f32 v[118:119], v[54:55], v[182:183]
  v_pk_fma_f32 v[112:113], v[176:177], v[168:169], v[112:113]
  v_pk_fma_f32 v[114:115], v[178:179], v[168:169], v[114:115]
  v_pk_fma_f32 v[116:117], v[184:185], v[168:169], v[116:117]
  v_pk_fma_f32 v[118:119], v[186:187], v[168:169], v[118:119]
  v_cvt_pk_bf16_f32 v236, v112, v113
  v_cvt_pk_bf16_f32 v237, v114, v115
  v_cvt_pk_bf16_f32 v238, v116, v117
  v_cvt_pk_bf16_f32 v239, v118, v119
  buffer_store_dwordx4 v[236:239], v160, s[16:19], s27 offen offset:1280 sc1
  v_pk_mul_f32 v[112:113], v[56:57], v[188:189]
  v_pk_mul_f32 v[114:115], v[58:59], v[190:191]
  v_pk_mul_f32 v[116:117], v[60:61], v[196:197]
  v_pk_mul_f32 v[118:119], v[62:63], v[198:199]
  v_pk_fma_f32 v[112:113], v[192:193], v[168:169], v[112:113]
  v_pk_fma_f32 v[114:115], v[194:195], v[168:169], v[114:115]
  v_pk_fma_f32 v[116:117], v[200:201], v[168:169], v[116:117]
  v_pk_fma_f32 v[118:119], v[202:203], v[168:169], v[118:119]
  v_cvt_pk_bf16_f32 v240, v112, v113
  v_cvt_pk_bf16_f32 v241, v114, v115
  v_cvt_pk_bf16_f32 v242, v116, v117
  v_cvt_pk_bf16_f32 v243, v118, v119
  buffer_store_dwordx4 v[240:243], v160, s[16:19], s27 offen offset:1920 sc1
  v_pk_mul_f32 v[112:113], v[64:65], v[172:173]
  v_pk_mul_f32 v[114:115], v[66:67], v[174:175]
  v_pk_mul_f32 v[116:117], v[68:69], v[180:181]
  v_pk_mul_f32 v[118:119], v[70:71], v[182:183]
  v_pk_fma_f32 v[112:113], v[176:177], v[170:171], v[112:113]
  v_pk_fma_f32 v[114:115], v[178:179], v[170:171], v[114:115]
  v_pk_fma_f32 v[116:117], v[184:185], v[170:171], v[116:117]
  v_pk_fma_f32 v[118:119], v[186:187], v[170:171], v[118:119]
  v_cvt_pk_bf16_f32 v236, v112, v113
  v_cvt_pk_bf16_f32 v237, v114, v115
  v_cvt_pk_bf16_f32 v238, v116, v117
  v_cvt_pk_bf16_f32 v239, v118, v119
  buffer_store_dwordx4 v[236:239], v161, s[16:19], s27 offen offset:1280 sc1
  v_pk_mul_f32 v[112:113], v[72:73], v[188:189]
  v_pk_mul_f32 v[114:115], v[74:75], v[190:191]
  v_pk_mul_f32 v[116:117], v[76:77], v[196:197]
  v_pk_mul_f32 v[118:119], v[78:79], v[198:199]
  v_pk_fma_f32 v[112:113], v[192:193], v[170:171], v[112:113]
  v_pk_fma_f32 v[114:115], v[194:195], v[170:171], v[114:115]
  v_pk_fma_f32 v[116:117], v[200:201], v[170:171], v[116:117]
  v_pk_fma_f32 v[118:119], v[202:203], v[170:171], v[118:119]
  v_cvt_pk_bf16_f32 v240, v112, v113
  v_cvt_pk_bf16_f32 v241, v114, v115
  v_cvt_pk_bf16_f32 v242, v116, v117
  v_cvt_pk_bf16_f32 v243, v118, v119
  buffer_store_dwordx4 v[240:243], v161, s[16:19], s27 offen offset:1920 sc1
  v_pk_mul_f32 v[112:113], v[80:81], v[204:205]
  v_pk_mul_f32 v[114:115], v[82:83], v[206:207]
  v_pk_mul_f32 v[116:117], v[84:85], v[212:213]
  v_pk_mul_f32 v[118:119], v[86:87], v[214:215]
  v_pk_fma_f32 v[112:113], v[208:209], v[168:169], v[112:113]
  v_pk_fma_f32 v[114:115], v[210:211], v[168:169], v[114:115]
  v_pk_fma_f32 v[116:117], v[216:217], v[168:169], v[116:117]
  v_pk_fma_f32 v[118:119], v[218:219], v[168:169], v[118:119]
  v_cvt_pk_bf16_f32 v236, v112, v113
  v_cvt_pk_bf16_f32 v237, v114, v115
  v_cvt_pk_bf16_f32 v238, v116, v117
  v_cvt_pk_bf16_f32 v239, v118, v119
  buffer_store_dwordx4 v[236:239], v160, s[16:19], s28 offen offset:1280 sc1
  v_pk_mul_f32 v[112:113], v[88:89], v[220:221]
  v_pk_mul_f32 v[114:115], v[90:91], v[222:223]
  v_pk_mul_f32 v[116:117], v[92:93], v[228:229]
  v_pk_mul_f32 v[118:119], v[94:95], v[230:231]
  v_pk_fma_f32 v[112:113], v[224:225], v[168:169], v[112:113]
  v_pk_fma_f32 v[114:115], v[226:227], v[168:169], v[114:115]
  v_pk_fma_f32 v[116:117], v[232:233], v[168:169], v[116:117]
  v_pk_fma_f32 v[118:119], v[234:235], v[168:169], v[118:119]
  v_cvt_pk_bf16_f32 v240, v112, v113
  v_cvt_pk_bf16_f32 v241, v114, v115
  v_cvt_pk_bf16_f32 v242, v116, v117
  v_cvt_pk_bf16_f32 v243, v118, v119
  buffer_store_dwordx4 v[240:243], v160, s[16:19], s28 offen offset:1920 sc1
  v_pk_mul_f32 v[112:113], v[96:97], v[204:205]
  v_pk_mul_f32 v[114:115], v[98:99], v[206:207]
  v_pk_mul_f32 v[116:117], v[100:101], v[212:213]
  v_pk_mul_f32 v[118:119], v[102:103], v[214:215]
  v_pk_fma_f32 v[112:113], v[208:209], v[170:171], v[112:113]
  v_pk_fma_f32 v[114:115], v[210:211], v[170:171], v[114:115]
  v_pk_fma_f32 v[116:117], v[216:217], v[170:171], v[116:117]
  v_pk_fma_f32 v[118:119], v[218:219], v[170:171], v[118:119]
  v_cvt_pk_bf16_f32 v236, v112, v113
  v_cvt_pk_bf16_f32 v237, v114, v115
  v_cvt_pk_bf16_f32 v238, v116, v117
  v_cvt_pk_bf16_f32 v239, v118, v119
  buffer_store_dwordx4 v[236:239], v161, s[16:19], s28 offen offset:1280 sc1
  v_pk_mul_f32 v[112:113], v[104:105], v[220:221]
  v_pk_mul_f32 v[114:115], v[106:107], v[222:223]
  v_pk_mul_f32 v[116:117], v[108:109], v[228:229]
  v_pk_mul_f32 v[118:119], v[110:111], v[230:231]
  v_pk_fma_f32 v[112:113], v[224:225], v[170:171], v[112:113]
  v_pk_fma_f32 v[114:115], v[226:227], v[170:171], v[114:115]
  v_pk_fma_f32 v[116:117], v[232:233], v[170:171], v[116:117]
  v_pk_fma_f32 v[118:119], v[234:235], v[170:171], v[118:119]
  v_cvt_pk_bf16_f32 v240, v112, v113
  v_cvt_pk_bf16_f32 v241, v114, v115
  v_cvt_pk_bf16_f32 v242, v116, v117
  v_cvt_pk_bf16_f32 v243, v118, v119
  buffer_store_dwordx4 v[240:243], v161, s[16:19], s28 offen offset:1920 sc1
  s_branch k1_qdone
k1_slowq:
  global_load_dword v157, v159, s[50:51] sc1
  s_sub_u32 s42, s42, 1
  s_cbranch_scc1 k1_end
  s_waitcnt vmcnt(0)
  v_cmp_eq_u32 vcc, 0, v157
  s_cbranch_vccnz k1_slowq
  s_branch k1_sokq
k1_slowv:
  global_load_dword v157, v159, s[50:51] sc1
  s_sub_u32 s42, s42, 1
  s_cbranch_scc1 k1_end
  s_waitcnt vmcnt(0)
  v_cmp_eq_u32 vcc, 0, v157
  s_cbranch_vccnz k1_slowv
  s_branch k1_sokv
k1_aux:
  s_load_dwordx2 s[52:53], s[0:1], 72
  v_lshrrev_b32 v2, 2, v0
  v_and_b32 v3, 3, v0
  v_mul_u32_u24 v4, 1280, v2
  v_lshl_add_u32 v4, v3, 4, v4
  s_lshl_b32 s27, s25, 3
  s_add_u32 s27, s27, s66
  s_mul_i32 s28, s27, 20480
  s_mov_b32 s34, 0x3f803f80
  s_waitcnt lgkmcnt(0)
  s_mov_b32 s8, s44
  s_mov_b32 s9, s45
  s_mov_b32 s10, 0x280000
  s_mov_b32 s11, 0x00020000
  buffer_load_dwordx4 v[16:19], v4, s[8:11], s28 offen offset:0
  buffer_load_dwordx4 v[20:23], v4, s[8:11], s28 offen offset:64
  buffer_load_dwordx4 v[24:27], v4, s[8:11], s28 offen offset:128
  buffer_load_dwordx4 v[28:31], v4, s[8:11], s28 offen offset:192
  buffer_load_dwordx4 v[32:35], v4, s[8:11], s28 offen offset:256
  buffer_load_dwordx4 v[36:39], v4, s[8:11], s28 offen offset:320
  buffer_load_dwordx4 v[40:43], v4, s[8:11], s28 offen offset:384
  buffer_load_dwordx4 v[44:47], v4, s[8:11], s28 offen offset:448
  buffer_load_dwordx4 v[48:51], v4, s[8:11], s28 offen offset:512
  buffer_load_dwordx4 v[52:55], v4, s[8:11], s28 offen offset:576
  buffer_load_dwordx4 v[56:59], v4, s[8:11], s28 offen offset:640
  buffer_load_dwordx4 v[60:63], v4, s[8:11], s28 offen offset:704
  buffer_load_dwordx4 v[64:67], v4, s[8:11], s28 offen offset:768
  buffer_load_dwordx4 v[68:71], v4, s[8:11], s28 offen offset:832
  buffer_load_dwordx4 v[72:75], v4, s[8:11], s28 offen offset:896
  buffer_load_dwordx4 v[76:79], v4, s[8:11], s28 offen offset:960
  buffer_load_dwordx4 v[80:83], v4, s[8:11], s28 offen offset:1024
  buffer_load_dwordx4 v[84:87], v4, s[8:11], s28 offen offset:1088
  buffer_load_dwordx4 v[88:91], v4, s[8:11], s28 offen offset:1152
  buffer_load_dwordx4 v[92:95], v4, s[8:11], s28 offen offset:1216
  s_add_u32 s16, s6, 0x25b0000
  s_addc_u32 s17, s7, 0
  s_mov_b32 s18, 0x4000
  s_mov_b32 s19, 0x00020000
  s_add_u32 s20, s6, 0x2540000
  s_addc_u32 s21, s7, 0
  s_mov_b32 s22, 0x40000
  s_mov_b32 s23, 0x00020000
  v_mov_b32 v8, 0
  v_mov_b32 v9, 0
  v_mov_b32 v10, 0
  v_mov_b32 v11, 0
  v_mov_b32 v12, 0
  v_mov_b32 v13, 0
  v_mov_b32 v14, 0
  v_mov_b32 v15, 0
  v_lshlrev_b32 v5, 4, v0
  s_lshl_b32 s29, s27, 11
  v_mov_b32 v100, 0
  v_mov_b32 v101, 0
  v_mov_b32 v102, 0
  v_mov_b32 v103, 0
  s_waitcnt vmcnt(19)
  v_dot2_f32_bf16 v10, v16, s34, v10
  v_dot2_f32_bf16 v12, v16, v16, v12
  v_dot2_f32_bf16 v11, v17, s34, v11
  v_dot2_f32_bf16 v13, v17, v17, v13
  v_dot2_f32_bf16 v10, v18, s34, v10
  v_dot2_f32_bf16 v12, v18, v18, v12
  v_dot2_f32_bf16 v11, v19, s34, v11
  v_dot2_f32_bf16 v13, v19, v19, v13
  s_waitcnt vmcnt(18)
  v_dot2_f32_bf16 v10, v20, s34, v10
  v_dot2_f32_bf16 v12, v20, v20, v12
  v_dot2_f32_bf16 v11, v21, s34, v11
  v_dot2_f32_bf16 v13, v21, v21, v13
  v_dot2_f32_bf16 v10, v22, s34, v10
  v_dot2_f32_bf16 v12, v22, v22, v12
  v_dot2_f32_bf16 v11, v23, s34, v11
  v_dot2_f32_bf16 v13, v23, v23, v13
  s_waitcnt vmcnt(17)
  v_dot2_f32_bf16 v10, v24, s34, v10
  v_dot2_f32_bf16 v12, v24, v24, v12
  v_dot2_f32_bf16 v11, v25, s34, v11
  v_dot2_f32_bf16 v13, v25, v25, v13
  v_dot2_f32_bf16 v10, v26, s34, v10
  v_dot2_f32_bf16 v12, v26, v26, v12
  v_dot2_f32_bf16 v11, v27, s34, v11
  v_dot2_f32_bf16 v13, v27, v27, v13
  s_waitcnt vmcnt(16)
  v_dot2_f32_bf16 v10, v28, s34, v10
  v_dot2_f32_bf16 v12, v28, v28, v12
  v_dot2_f32_bf16 v11, v29, s34, v11
  v_dot2_f32_bf16 v13, v29, v29, v13
  v_dot2_f32_bf16 v10, v30, s34, v10
  v_dot2_f32_bf16 v12, v30, v30, v12
  v_dot2_f32_bf16 v11, v31, s34, v11
  v_dot2_f32_bf16 v13, v31, v31, v13
  s_waitcnt vmcnt(15)
  v_dot2_f32_bf16 v10, v32, s34, v10
  v_dot2_f32_bf16 v12, v32, v32, v12
  v_dot2_f32_bf16 v11, v33, s34, v11
  v_dot2_f32_bf16 v13, v33, v33, v13
  v_dot2_f32_bf16 v10, v34, s34, v10
  v_dot2_f32_bf16 v12, v34, v34, v12
  v_dot2_f32_bf16 v11, v35, s34, v11
  v_dot2_f32_bf16 v13, v35, v35, v13
  s_waitcnt vmcnt(14)
  v_dot2_f32_bf16 v10, v36, s34, v10
  v_dot2_f32_bf16 v12, v36, v36, v12
  v_dot2_f32_bf16 v11, v37, s34, v11
  v_dot2_f32_bf16 v13, v37, v37, v13
  v_dot2_f32_bf16 v10, v38, s34, v10
  v_dot2_f32_bf16 v12, v38, v38, v12
  v_dot2_f32_bf16 v11, v39, s34, v11
  v_dot2_f32_bf16 v13, v39, v39, v13
  s_waitcnt vmcnt(13)
  v_dot2_f32_bf16 v10, v40, s34, v10
  v_dot2_f32_bf16 v12, v40, v40, v12
  v_dot2_f32_bf16 v11, v41, s34, v11
  v_dot2_f32_bf16 v13, v41, v41, v13
  v_dot2_f32_bf16 v10, v42, s34, v10
  v_dot2_f32_bf16 v12, v42, v42, v12
  v_dot2_f32_bf16 v11, v43, s34, v11
  v_dot2_f32_bf16 v13, v43, v43, v13
  s_waitcnt vmcnt(12)
  v_dot2_f32_bf16 v10, v44, s34, v10
  v_dot2_f32_bf16 v12, v44, v44, v12
  v_dot2_f32_bf16 v11, v45, s34, v11
  v_dot2_f32_bf16 v13, v45, v45, v13
  v_dot2_f32_bf16 v10, v46, s34, v10
  v_dot2_f32_bf16 v12, v46, v46, v12
  v_dot2_f32_bf16 v11, v47, s34, v11
  v_dot2_f32_bf16 v13, v47, v47, v13
  s_waitcnt vmcnt(11)
  v_dot2_f32_bf16 v10, v48, s34, v10
  v_dot2_f32_bf16 v12, v48, v48, v12
  v_dot2_f32_bf16 v11, v49, s34, v11
  v_dot2_f32_bf16 v13, v49, v49, v13
  v_dot2_f32_bf16 v10, v50, s34, v10
  v_dot2_f32_bf16 v12, v50, v50, v12
  v_dot2_f32_bf16 v11, v51, s34, v11
  v_dot2_f32_bf16 v13, v51, v51, v13
  s_waitcnt vmcnt(10)
  v_dot2_f32_bf16 v10, v52, s34, v10
  v_dot2_f32_bf16 v12, v52, v52, v12
  v_dot2_f32_bf16 v11, v53, s34, v11
  v_dot2_f32_bf16 v13, v53, v53, v13
  v_dot2_f32_bf16 v10, v54, s34, v10
  v_dot2_f32_bf16 v12, v54, v54, v12
  v_dot2_f32_bf16 v11, v55, s34, v11
  v_dot2_f32_bf16 v13, v55, v55, v13
  s_waitcnt vmcnt(9)
  v_dot2_f32_bf16 v10, v56, s34, v10
  v_dot2_f32_bf16 v12, v56, v56, v12
  v_dot2_f32_bf16 v11, v57, s34, v11
  v_dot2_f32_bf16 v13, v57, v57, v13
  v_dot2_f32_bf16 v10, v58, s34, v10
  v_dot2_f32_bf16 v12, v58, v58, v12
  v_dot2_f32_bf16 v11, v59, s34, v11
  v_dot2_f32_bf16 v13, v59, v59, v13
  s_waitcnt vmcnt(8)
  v_dot2_f32_bf16 v10, v60, s34, v10
  v_dot2_f32_bf16 v12, v60, v60, v12
  v_dot2_f32_bf16 v11, v61, s34, v11
  v_dot2_f32_bf16 v13, v61, v61, v13
  v_dot2_f32_bf16 v10, v62, s34, v10
  v_dot2_f32_bf16 v12, v62, v62, v12
  v_dot2_f32_bf16 v11, v63, s34, v11
  v_dot2_f32_bf16 v13, v63, v63, v13
  s_waitcnt vmcnt(7)
  v_dot2_f32_bf16 v10, v64, s34, v10
  v_dot2_f32_bf16 v12, v64, v64, v12
  v_dot2_f32_bf16 v11, v65, s34, v11
  v_dot2_f32_bf16 v13, v65, v65, v13
  v_dot2_f32_bf16 v10, v66, s34, v10
  v_dot2_f32_bf16 v12, v66, v66, v12
  v_dot2_f32_bf16 v11, v67, s34, v11
  v_dot2_f32_bf16 v13, v67, v67, v13
  s_waitcnt vmcnt(6)
  v_dot2_f32_bf16 v10, v68, s34, v10
  v_dot2_f32_bf16 v12, v68, v68, v12
  v_dot2_f32_bf16 v11, v69, s34, v11
  v_dot2_f32_bf16 v13, v69, v69, v13
  v_dot2_f32_bf16 v10, v70, s34, v10
  v_dot2_f32_bf16 v12, v70, v70, v12
  v_dot2_f32_bf16 v11, v71, s34, v11
  v_dot2_f32_bf16 v13, v71, v71, v13
  s_waitcnt vmcnt(5)
  v_dot2_f32_bf16 v10, v72, s34, v10
  v_dot2_f32_bf16 v12, v72, v72, v12
  v_dot2_f32_bf16 v11, v73, s34, v11
  v_dot2_f32_bf16 v13, v73, v73, v13
  v_dot2_f32_bf16 v10, v74, s34, v10
  v_dot2_f32_bf16 v12, v74, v74, v12
  v_dot2_f32_bf16 v11, v75, s34, v11
  v_dot2_f32_bf16 v13, v75, v75, v13
  s_waitcnt vmcnt(4)
  v_dot2_f32_bf16 v10, v76, s34, v10
  v_dot2_f32_bf16 v12, v76, v76, v12
  v_dot2_f32_bf16 v11, v77, s34, v11
  v_dot2_f32_bf16 v13, v77, v77, v13
  v_dot2_f32_bf16 v10, v78, s34, v10
  v_dot2_f32_bf16 v12, v78, v78, v12
  v_dot2_f32_bf16 v11, v79, s34, v11
  v_dot2_f32_bf16 v13, v79, v79, v13
  s_waitcnt vmcnt(3)
  v_dot2_f32_bf16 v10, v80, s34, v10
  v_dot2_f32_bf16 v12, v80, v80, v12
  v_dot2_f32_bf16 v11, v81, s34, v11
  v_dot2_f32_bf16 v13, v81, v81, v13
  v_dot2_f32_bf16 v10, v82, s34, v10
  v_dot2_f32_bf16 v12, v82, v82, v12
  v_dot2_f32_bf16 v11, v83, s34, v11
  v_dot2_f32_bf16 v13, v83, v83, v13
  s_waitcnt vmcnt(2)
  v_dot2_f32_bf16 v10, v84, s34, v10
  v_dot2_f32_bf16 v12, v84, v84, v12
  v_dot2_f32_bf16 v11, v85, s34, v11
  v_dot2_f32_bf16 v13, v85, v85, v13
  v_dot2_f32_bf16 v10, v86, s34, v10
  v_dot2_f32_bf16 v12, v86, v86, v12
  v_dot2_f32_bf16 v11, v87, s34, v11
  v_dot2_f32_bf16 v13, v87, v87, v13
  s_waitcnt vmcnt(1)
  v_dot2_f32_bf16 v10, v88, s34, v10
  v_dot2_f32_bf16 v12, v88, v88, v12
  v_dot2_f32_bf16 v11, v89, s34, v11
  v_dot2_f32_bf16 v13, v89, v89, v13
  v_dot2_f32_bf16 v10, v90, s34, v10
  v_dot2_f32_bf16 v12, v90, v90, v12
  v_dot2_f32_bf16 v11, v91, s34, v11
  v_dot2_f32_bf16 v13, v91, v91, v13
  s_waitcnt vmcnt(0)
  v_dot2_f32_bf16 v10, v92, s34, v10
  v_dot2_f32_bf16 v12, v92, v92, v12
  v_dot2_f32_bf16 v11, v93, s34, v11
  v_dot2_f32_bf16 v13, v93, v93, v13
  v_dot2_f32_bf16 v10, v94, s34, v10
  v_dot2_f32_bf16 v12, v94, v94, v12
  v_dot2_f32_bf16 v11, v95, s34, v11
  v_dot2_f32_bf16 v13, v95, v95, v13
  buffer_store_dwordx4 v[100:103], v5, s[20:23], s29 offen offset:1024 sc1
  buffer_store_dwordx4 v[100:103], v5, s[20:23], s29 offen sc1
  v_add_f32 v10, v10, v11
  v_add_f32 v12, v12, v13
  s_nop 0
  v_add_f32_dpp v10, v10, v10 quad_perm:[1,0,3,2] row_mask:0xf bank_mask:0xf
  v_add_f32_dpp v12, v12, v12 quad_perm:[1,0,3,2] row_mask:0xf bank_mask:0xf
  s_nop 0
  v_add_f32_dpp v10, v10, v10 quad_perm:[2,3,0,1] row_mask:0xf bank_mask:0xf
  v_add_f32_dpp v12, v12, v12 quad_perm:[2,3,0,1] row_mask:0xf bank_mask:0xf
  v_mul_f32 v10, 0x3acccccd, v10
  v_mul_f32 v12, 0x3acccccd, v12
  v_fma_f32 v12, -v10, v10, v12
  v_max_f32 v12, 0, v12
  v_add_f32 v12, 0x3727c5ac, v12
  v_rsq_f32 v14, v12
  v_lshlrev_b32 v5, 2, v2
  s_lshl_b32 s29, s27, 6
  s_add_u32 s28, s29, 8192
  v_mul_f32_e64 v15, -v10, v14
  buffer_store_dword v14, v5, s[16:19], s29 offen sc1
  buffer_store_dword v15, v5, s[16:19], s28 offen sc1
  s_waitcnt vmcnt(0)
  s_barrier
  s_cmp_lg_u32 s66, 0
  s_cbranch_scc1 k1_auxdone
  s_lshl_b32 s27, s25, 4
  v_mov_b32 v6, s27
  v_mov_b32 v7, 1
  s_mov_b64 exec, 1
  global_store_dword v6, v7, s[52:53] sc1
  s_mov_b64 exec, -1
k1_auxdone:
  s_mov_b64 exec, -1
  s_cmp_ge_u32 s66, 4
  s_cbranch_scc1 k1_auxfin
  s_load_dwordx16 s[68:83], s[0:1], 0
  s_branch k1_dec
k1_auxfin:
  s_lshl_b32 s67, s26, 11
  s_lshl_b32 s28, s25, 7
  s_add_u32 s67, s67, s28
  s_add_u32 s67, s67, 65536
  s_mov_b64 exec, -1
  s_mov_b32 s48, s6
  s_mov_b32 s49, s7
  s_mov_b32 s50, 0x0
  s_mov_b32 s51, 0x00020000
  s_mov_b32 s52, s6
  s_mov_b32 s53, s7
  s_mov_b32 s54, 0x0
  s_mov_b32 s55, 0x00020000
  v_mov_b32 v140, 0
  v_mov_b32 v141, 0
  v_mov_b32 v142, 0
  v_mov_b32 v143, 0
  s_setprio 0
  s_branch k2_entry
k1_end:
  s_endpgm
k2_entry:
  s_load_dwordx2 s[4:5], s[0:1], 72
  s_mov_b32 s3, s2
  s_and_b32 s70, s2, 7
  s_lshr_b32 s71, s2, 3
  s_lshl_b32 s68, s70, 2
  s_and_b32 s72, s71, 3
  s_add_u32 s68, s68, s72
  s_lshr_b32 s69, s71, 2
  v_lshlrev_b32 v9, 4, v0
  v_and_b32 v10, 31, v0
  v_lshrrev_b32 v11, 5, v0
  v_lshlrev_b32 v13, 3, v10
  v_mov_b32 v12, v9
  v_mul_u32_u24 v14, 320, v11
  v_lshl_add_u32 v14, v10, 4, v14
  s_lshl_b32 s75, s69, 3
  s_add_u32 s75, s75, s66
  s_mul_i32 s76, s66, 3072
  s_mov_b32 m0, s76
  s_mul_i32 s74, s75, 1280
  s_mul_i32 s70, s68, 163840
  s_mul_i32 s71, s68, 81920
  s_add_u32 s70, s70, 2621440
  s_add_u32 s12, s6, s71
  s_addc_u32 s13, s7, 0
  s_mov_b32 s14, 81920
  s_mov_b32 s15, 0x00020000
  s_add_u32 s8, s6, s70
  s_addc_u32 s9, s7, 0
  s_mov_b32 s10, 163840
  s_mov_b32 s11, 0x00020000
  s_mov_b32 s80, 0x000fffff
  s_mov_b32 s81, 0x000fffff
  v_mov_b32 v3, 0x3f803f80
  v_cmp_eq_u32 vcc, 20, v10
  s_nop 1
  v_cndmask_b32 v3, 0, v3, vcc
  v_mov_b32 v116, v3
  v_mov_b32 v117, v3
  v_mov_b32 v118, v3
  v_mov_b32 v119, v3
  v_mov_b32 v120, v3
  v_mov_b32 v121, v3
  v_mov_b32 v122, v3
  v_mov_b32 v123, v3
  v_mov_b32 v124, v3
  v_mov_b32 v125, v3
  v_mov_b32 v126, v3
  v_mov_b32 v127, v3
  v_mov_b32 v128, v3
  v_mov_b32 v129, v3
  v_mov_b32 v130, v3
  v_mov_b32 v131, v3
  s_add_u32 s16, s6, 0x800000
  s_addc_u32 s17, s7, 0
  s_mov_b32 s18, 0x280000
  s_mov_b32 s19, 0x00020000
  s_add_u32 s28, s6, 0x2540000
  s_addc_u32 s29, s7, 0
  s_mov_b32 s30, 0x40000
  s_mov_b32 s31, 0x00020000
  s_add_u32 s20, s6, 0x1c00000
  s_addc_u32 s21, s7, 0
  s_mov_b32 s22, 0x6c0000
  s_mov_b32 s23, 0x00020000
  s_lshl_b32 s77, s69, 7
  s_lshl_b32 s70, s68, 2
  s_add_u32 s77, s77, s70
  s_add_u32 s77, s77, 32768
  s_mul_i32 s75, s75, 40960
  s_and_b32 s78, s3, 1
  s_mul_i32 s78, s78, 3538944
  s_lshr_b32 s71, s3, 6
  s_mul_i32 s79, s71, 276480
  s_add_u32 s79, s79, s78
  s_and_b32 s70, s66, 3
  s_mul_i32 s70, s70, 5120
  s_add_u32 s79, s79, s70
  s_mul_i32 s71, s71, 102400
  s_add_u32 s78, s78, s71
  s_add_u32 s78, s78, s70
  v_lshrrev_b32 v5, 4, v10
  v_mul_u32_u24 v5, 20480, v5
  v_and_b32 v6, 15, v10
  s_lshl_b32 s70, s68, 9
  v_lshl_add_u32 v133, v6, 4, v5
  v_lshl_add_u32 v133, v11, 8, v133
  v_add_u32 v133, s70, v133
  s_lshl_b32 s70, s68, 7
  s_add_u32 s70, s70, 16384
  v_lshl_add_u32 v134, v6, 3, v5
  v_add_u32 v134, s70, v134
  s_mov_b32 s72, 400000
  v_and_b32 v4, 15, v0
  v_lshlrev_b32 v4, 2, v4
  v_lshlrev_b32 v8, 2, v4
  s_mul_i32 s70, s68, 20
  v_mul_u32_u24 v5, 19, v11
  v_add_u32 v5, s70, v5
  v_lshrrev_b32 v5, 7, v5
  v_lshlrev_b32 v5, 11, v5
  v_bfe_u32 v6, v0, 4, 1
  v_mul_u32_u24 v6, 10240, v6
  v_lshl_add_u32 v7, v4, 5, v6
  v_add_u32 v7, v7, v5
  v_and_b32 v6, 1, v0
  v_lshl_add_u32 v2, v6, 7, v5
  s_add_u32 s71, s70, 19
  s_xor_b32 s71, s71, s70
  s_cmp_lt_u32 s71, 128
  s_cselect_b32 s83, 0, -1
  s_mov_b32 s82, -1
  s_lshl_b32 s71, s69, 8
  s_add_u32 s71, s71, 65536
  s_mov_b32 s70, 75776
  v_mov_b32 v22, 1
  v_mov_b32 v23, 1
  s_waitcnt lgkmcnt(0)
  s_cmp_lt_u32 s66, 4
  s_cbranch_scc1 k2_pub
k2_zpoll:
  global_load_dword v5, v8, s[4:5] sc1
  s_sub_u32 s72, s72, 1
  s_cbranch_scc1 kp_end
  s_waitcnt vmcnt(0)
  v_cmp_eq_u32 vcc, 0, v5
  s_cbranch_vccnz k2_zpoll
k2_pub:
  s_barrier
  s_cmp_lg_u32 s66, 4
  s_cbranch_scc1 k2_ready
  ds_read_b32 v5, v4 offset:2048
  s_waitcnt lgkmcnt(0)
  v_max_u32_dpp v5, v5, v5 row_ror:8 row_mask:0xf bank_mask:0xf
  s_nop 1
  v_max_u32_dpp v5, v5, v5 row_ror:4 row_mask:0xf bank_mask:0xf
  s_nop 1
  v_max_u32_dpp v5, v5, v5 row_ror:2 row_mask:0xf bank_mask:0xf
  s_nop 1
  v_max_u32_dpp v5, v5, v5 row_ror:1 row_mask:0xf bank_mask:0xf
  v_or_b32 v5, 1, v5
  s_mov_b64 exec, 1
  buffer_store_dword v5, off, s[28:31], s67 sc1
k2_qpoll:
  s_mov_b64 exec, s[82:83]
  buffer_load_dword v22, v7, s[28:31], s70 offen sc1
  s_and_b32 exec_lo, s82, 3
  s_and_b32 exec_hi, s83, 3
  buffer_load_dword v23, v2, s[28:31], s71 offen sc1
  s_mov_b64 exec, -1
  s_sub_u32 s72, s72, 1
  s_cbranch_scc1 kp_end
  s_waitcnt vmcnt(0)
  v_min_u32 v5, v22, v23
  v_cmp_eq_u32 vcc, 0, v5
  s_cbranch_vccnz k2_qpoll
  v_mov_b32 v5, v22
  s_nop 1
  v_permlane32_swap_b32 v5, v22
  v_max_u32 v5, v5, v22
  s_nop 1
  v_max_u32_dpp v5, v5, v5 row_ror:8 row_mask:0xf bank_mask:0xf
  s_nop 1
  v_max_u32_dpp v5, v5, v5 row_ror:4 row_mask:0xf bank_mask:0xf
  s_nop 1
  v_max_u32_dpp v5, v5, v5 row_ror:2 row_mask:0xf bank_mask:0xf
  s_nop 1
  v_max_u32_dpp v5, v5, v5 row_ror:1 row_mask:0xf bank_mask:0xf
  v_lshlrev_b32 v6, 2, v0
  v_sqrt_f32 v5, v5
  s_nop 0
  v_mul_f32 v5, 0xbf8020c5, v5
  ds_write_b32 v6, v5 offset:65000
  s_waitcnt lgkmcnt(0)
k2_ready:
  s_barrier
  buffer_load_dwordx4 v[16:19], v9, s[12:15], s74 offen sc1
  buffer_load_dwordx2 v[20:21], v13, s[12:15], s74 offen offset:1024 sc1
  buffer_load_dwordx4 v9, s[8:11], s76 offen offset:0 lds
  buffer_load_dwordx4 v9, s[8:11], s76 offen offset:1024 lds
  buffer_load_dwordx4 v9, s[8:11], s76 offen offset:2048 lds
  v_mov_b32 v6, 0
  ds_read_b32 v132, v6 offset:65000
  s_lshl_b32 s76, s66, 12
  s_add_u32 s76, s76, 24576
  v_cmp_eq_u32 vcc, 0, v11
  s_waitcnt vmcnt(3)
  s_nop 0
  v_cndmask_b32 v20, 0, v20, vcc
  v_cndmask_b32 v21, 0, v21, vcc
  v_dot2_f32_bf16 v72, v16, v16, 0
  v_dot2_f32_bf16 v73, v18, v18, 0
  v_dot2_f32_bf16 v74, v20, v20, 0
  v_dot2_f32_bf16 v72, v17, v17, v72
  v_dot2_f32_bf16 v73, v19, v19, v73
  v_dot2_f32_bf16 v74, v21, v21, v74
  s_nop 0
  v_sqrt_f32 v72, v72
  v_sqrt_f32 v73, v73
  v_sqrt_f32 v74, v74
  v_add_f32 v72, v72, v73
  v_add_f32 v72, v72, v74
  v_mov_b32 v75, v72
  s_nop 1
  v_permlane32_swap_b32 v72, v75
  v_add_f32 v72, v72, v75
  s_waitcnt lgkmcnt(0)
  v_fmaak_f32 v24, v72, v132, 0x41f00000
  v_mov_b32 v25, v24
  v_mov_b32 v26, v24
  v_mov_b32 v27, v24
  v_mov_b32 v28, v24
  v_mov_b32 v29, v24
  v_mov_b32 v30, v24
  v_mov_b32 v31, v24
  v_mov_b32 v32, v24
  v_mov_b32 v33, v24
  v_mov_b32 v34, v24
  v_mov_b32 v35, v24
  v_mov_b32 v36, v24
  v_mov_b32 v37, v24
  v_mov_b32 v38, v24
  v_mov_b32 v39, v24
  s_waitcnt vmcnt(0)
  s_mov_b32 m0, s76
  s_barrier
  ds_read_b128 v[104:107], v12 offset:0
  ds_read_b64 v[112:113], v13 offset:1024
  ds_read_b128 v[108:111], v12 offset:2560
  ds_read_b64 v[114:115], v13 offset:3584
  s_waitcnt lgkmcnt(2)
  v_mfma_f32_32x32x8_bf16 v[56:71], v[112:113], v[20:21], v[24:39]
  v_mfma_f32_32x32x16_bf16 v[56:71], v[104:107], v[16:19], v[56:71]
  ds_read_b128 v[104:107], v12 offset:5120
  ds_read_b64 v[112:113], v13 offset:6144
  s_mov_b64 exec, s[80:81]
  ds_read_b128 v[116:119], v14 offset:1280
  ds_read_b128 v[120:123], v14 offset:1920
  s_mov_b64 exec, -1
  s_setprio 1
  s_waitcnt lgkmcnt(4)
  v_mfma_f32_32x32x8_bf16 v[72:87], v[114:115], v[20:21], v[24:39]
  buffer_load_dwordx4 v9, s[8:11], s76 offen offset:0 lds
  s_nop 1
  v_exp_f32 v56, v56
  v_exp_f32 v57, v57
  v_exp_f32 v58, v58
  v_exp_f32 v59, v59
  v_cvt_pk_bf16_f32 v88, v56, v57
  v_cvt_pk_bf16_f32 v89, v58, v59
  v_mfma_f32_32x32x16_bf16 v[72:87], v[108:111], v[16:19], v[72:87]
  buffer_load_dwordx4 v9, s[8:11], s76 offen offset:1024 lds
  v_exp_f32 v60, v60
  v_exp_f32 v61, v61
  v_exp_f32 v62, v62
  v_exp_f32 v63, v63
  v_cvt_pk_bf16_f32 v90, v60, v61
  v_cvt_pk_bf16_f32 v91, v62, v63
  ds_read_b128 v[108:111], v12 offset:7680
  ds_read_b64 v[114:115], v13 offset:8704
  buffer_load_dwordx4 v9, s[8:11], s76 offen offset:2048 lds
  v_exp_f32 v64, v64
  v_exp_f32 v65, v65
  v_exp_f32 v66, v66
  v_exp_f32 v67, v67
  v_cvt_pk_bf16_f32 v92, v64, v65
  v_cvt_pk_bf16_f32 v93, v66, v67
  buffer_load_dwordx4 v9, s[8:11], s76 offen offset:3072 lds
  v_exp_f32 v68, v68
  v_exp_f32 v69, v69
  v_exp_f32 v70, v70
  v_exp_f32 v71, v71
  s_mov_b64 exec, s[80:81]
  ds_read_b128 v[124:127], v14 offset:3840
  ds_read_b128 v[128:131], v14 offset:4480
  s_mov_b64 exec, -1
  v_cvt_pk_bf16_f32 v94, v68, v69
  v_cvt_pk_bf16_f32 v95, v70, v71
  s_waitcnt lgkmcnt(4)
  v_mfma_f32_32x32x8_bf16 v[56:71], v[112:113], v[20:21], v[24:39]
  v_exp_f32 v72, v72
  v_exp_f32 v73, v73
  v_exp_f32 v74, v74
  v_exp_f32 v75, v75
  v_cvt_pk_bf16_f32 v96, v72, v73
  v_cvt_pk_bf16_f32 v97, v74, v75
  v_mfma_f32_32x32x16_bf16 v[56:71], v[104:107], v[16:19], v[56:71]
  v_exp_f32 v76, v76
  v_exp_f32 v77, v77
  v_exp_f32 v78, v78
  v_exp_f32 v79, v79
  v_cvt_pk_bf16_f32 v98, v76, v77
  v_cvt_pk_bf16_f32 v99, v78, v79
  v_mfma_f32_32x32x16_bf16 v[40:55], v[116:119], v[88:91], 0
  ds_read_b128 v[104:107], v12 offset:10240
  ds_read_b64 v[112:113], v13 offset:11264
  s_mul_i32 s76, s66, 13312
  s_add_u32 s76, s76, 57344
  s_mov_b32 m0, s76
  s_nop 0
  buffer_load_dwordx4 v9, s[8:11], s76 offen offset:0 lds
  v_exp_f32 v80, v80
  v_exp_f32 v81, v81
  v_exp_f32 v82, v82
  v_exp_f32 v83, v83
  v_cvt_pk_bf16_f32 v100, v80, v81
  v_cvt_pk_bf16_f32 v101, v82, v83
  v_mfma_f32_32x32x16_bf16 v[40:55], v[120:123], v[92:95], v[40:55]
  v_exp_f32 v84, v84
  v_exp_f32 v85, v85
  v_exp_f32 v86, v86
  v_exp_f32 v87, v87
  s_mov_b64 exec, s[80:81]
  ds_read_b128 v[116:119], v14 offset:6400
  ds_read_b128 v[120:123], v14 offset:7040
  s_mov_b64 exec, -1
  v_cvt_pk_bf16_f32 v102, v84, v85
  v_cvt_pk_bf16_f32 v103, v86, v87
  s_setprio 0
  s_waitcnt lgkmcnt(4)
  v_mfma_f32_32x32x8_bf16 v[72:87], v[114:115], v[20:21], v[24:39]
  v_exp_f32 v56, v56
  v_exp_f32 v57, v57
  v_exp_f32 v58, v58
  v_exp_f32 v59, v59
  v_cvt_pk_bf16_f32 v88, v56, v57
  v_cvt_pk_bf16_f32 v89, v58, v59
  v_mfma_f32_32x32x16_bf16 v[72:87], v[108:111], v[16:19], v[72:87]
  buffer_load_dwordx4 v9, s[8:11], s76 offen offset:1024 lds
  v_exp_f32 v60, v60
  v_exp_f32 v61, v61
  v_exp_f32 v62, v62
  v_exp_f32 v63, v63
  v_cvt_pk_bf16_f32 v90, v60, v61
  v_cvt_pk_bf16_f32 v91, v62, v63
  v_mfma_f32_32x32x16_bf16 v[40:55], v[124:127], v[96:99], v[40:55]
  ds_read_b128 v[108:111], v12 offset:12800
  ds_read_b64 v[114:115], v13 offset:13824
  v_exp_f32 v64, v64
  v_exp_f32 v65, v65
  v_exp_f32 v66, v66
  v_exp_f32 v67, v67
  v_cvt_pk_bf16_f32 v92, v64, v65
  v_cvt_pk_bf16_f32 v93, v66, v67
  v_mfma_f32_32x32x16_bf16 v[40:55], v[128:131], v[100:103], v[40:55]
  v_exp_f32 v68, v68
  v_exp_f32 v69, v69
  v_exp_f32 v70, v70
  v_exp_f32 v71, v71
  s_mov_b64 exec, s[80:81]
  ds_read_b128 v[124:127], v14 offset:8960
  ds_read_b128 v[128:131], v14 offset:9600
  s_mov_b64 exec, -1
  v_cvt_pk_bf16_f32 v94, v68, v69
  v_cvt_pk_bf16_f32 v95, v70, v71
  s_waitcnt lgkmcnt(4)
  v_mfma_f32_32x32x8_bf16 v[56:71], v[112:113], v[20:21], v[24:39]
  buffer_load_dwordx4 v9, s[8:11], s76 offen offset:2048 lds
  v_exp_f32 v72, v72
  v_exp_f32 v73, v73
  v_exp_f32 v74, v74
  v_exp_f32 v75, v75
  v_cvt_pk_bf16_f32 v96, v72, v73
  v_cvt_pk_bf16_f32 v97, v74, v75
  v_mfma_f32_32x32x16_bf16 v[56:71], v[104:107], v[16:19], v[56:71]
  v_exp_f32 v76, v76
  v_exp_f32 v77, v77
  v_exp_f32 v78, v78
  v_exp_f32 v79, v79
  v_cvt_pk_bf16_f32 v98, v76, v77
  v_cvt_pk_bf16_f32 v99, v78, v79
  v_mfma_f32_32x32x16_bf16 v[40:55], v[116:119], v[88:91], v[40:55]
  ds_read_b128 v[104:107], v12 offset:15360
  ds_read_b64 v[112:113], v13 offset:16384
  v_exp_f32 v80, v80
  v_exp_f32 v81, v81
  v_exp_f32 v82, v82
  v_exp_f32 v83, v83
  v_cvt_pk_bf16_f32 v100, v80, v81
  v_cvt_pk_bf16_f32 v101, v82, v83
  v_mfma_f32_32x32x16_bf16 v[40:55], v[120:123], v[92:95], v[40:55]
  buffer_load_dwordx4 v9, s[8:11], s76 offen offset:3072 lds
  v_exp_f32 v84, v84
  v_exp_f32 v85, v85
  v_exp_f32 v86, v86
  v_exp_f32 v87, v87
  s_mov_b64 exec, s[80:81]
  ds_read_b128 v[116:119], v14 offset:11520
  ds_read_b128 v[120:123], v14 offset:12160
  s_mov_b64 exec, -1
  v_cvt_pk_bf16_f32 v102, v84, v85
  v_cvt_pk_bf16_f32 v103, v86, v87
  s_waitcnt vmcnt(4)
  s_barrier
  s_setprio 3
  s_waitcnt lgkmcnt(4)
  v_mfma_f32_32x32x8_bf16 v[72:87], v[114:115], v[20:21], v[24:39]
  v_exp_f32 v56, v56
  v_exp_f32 v57, v57
  v_exp_f32 v58, v58
  v_exp_f32 v59, v59
  v_cvt_pk_bf16_f32 v88, v56, v57
  v_cvt_pk_bf16_f32 v89, v58, v59
  v_mfma_f32_32x32x16_bf16 v[72:87], v[108:111], v[16:19], v[72:87]
  v_exp_f32 v60, v60
  v_exp_f32 v61, v61
  v_exp_f32 v62, v62
  v_exp_f32 v63, v63
  v_cvt_pk_bf16_f32 v90, v60, v61
  v_cvt_pk_bf16_f32 v91, v62, v63
  v_mfma_f32_32x32x16_bf16 v[40:55], v[124:127], v[96:99], v[40:55]
  ds_read_b128 v[108:111], v12 offset:17920
  ds_read_b64 v[114:115], v13 offset:18944
  s_add_u32 s76, s76, 4096
  s_mov_b32 m0, s76
  s_nop 0
  buffer_load_dwordx4 v9, s[8:11], s76 offen offset:0 lds
  v_exp_f32 v64, v64
  v_exp_f32 v65, v65
  v_exp_f32 v66, v66
  v_exp_f32 v67, v67
  v_cvt_pk_bf16_f32 v92, v64, v65
  v_cvt_pk_bf16_f32 v93, v66, v67
  v_mfma_f32_32x32x16_bf16 v[40:55], v[128:131], v[100:103], v[40:55]
  v_exp_f32 v68, v68
  v_exp_f32 v69, v69
  v_exp_f32 v70, v70
  v_exp_f32 v71, v71
  s_mov_b64 exec, s[80:81]
  ds_read_b128 v[124:127], v14 offset:14080
  ds_read_b128 v[128:131], v14 offset:14720
  s_mov_b64 exec, -1
  v_cvt_pk_bf16_f32 v94, v68, v69
  v_cvt_pk_bf16_f32 v95, v70, v71
  s_waitcnt lgkmcnt(4)
  v_mfma_f32_32x32x8_bf16 v[56:71], v[112:113], v[20:21], v[24:39]
  v_exp_f32 v72, v72
  v_exp_f32 v73, v73
  v_exp_f32 v74, v74
  v_exp_f32 v75, v75
  v_cvt_pk_bf16_f32 v96, v72, v73
  v_cvt_pk_bf16_f32 v97, v74, v75
  v_mfma_f32_32x32x16_bf16 v[56:71], v[104:107], v[16:19], v[56:71]
  buffer_load_dwordx4 v9, s[8:11], s76 offen offset:1024 lds
  v_exp_f32 v76, v76
  v_exp_f32 v77, v77
  v_exp_f32 v78, v78
  v_exp_f32 v79, v79
  v_cvt_pk_bf16_f32 v98, v76, v77
  v_cvt_pk_bf16_f32 v99, v78, v79
  v_mfma_f32_32x32x16_bf16 v[40:55], v[116:119], v[88:91], v[40:55]
  ds_read_b128 v[104:107], v12 offset:20480
  ds_read_b64 v[112:113], v13 offset:21504
  v_exp_f32 v80, v80
  v_exp_f32 v81, v81
  v_exp_f32 v82, v82
  v_exp_f32 v83, v83
  v_cvt_pk_bf16_f32 v100, v80, v81
  v_cvt_pk_bf16_f32 v101, v82, v83
  v_mfma_f32_32x32x16_bf16 v[40:55], v[120:123], v[92:95], v[40:55]
  v_exp_f32 v84, v84
  v_exp_f32 v85, v85
  v_exp_f32 v86, v86
  v_exp_f32 v87, v87
  s_mov_b64 exec, s[80:81]
  ds_read_b128 v[116:119], v14 offset:16640
  ds_read_b128 v[120:123], v14 offset:17280
  s_mov_b64 exec, -1
  v_cvt_pk_bf16_f32 v102, v84, v85
  v_cvt_pk_bf16_f32 v103, v86, v87
  s_setprio 3
  s_waitcnt lgkmcnt(4)
  v_mfma_f32_32x32x8_bf16 v[72:87], v[114:115], v[20:21], v[24:39]
  buffer_load_dwordx4 v9, s[8:11], s76 offen offset:2048 lds
  v_exp_f32 v56, v56
  v_exp_f32 v57, v57
  v_exp_f32 v58, v58
  v_exp_f32 v59, v59
  v_cvt_pk_bf16_f32 v88, v56, v57
  v_cvt_pk_bf16_f32 v89, v58, v59
  v_mfma_f32_32x32x16_bf16 v[72:87], v[108:111], v[16:19], v[72:87]
  v_exp_f32 v60, v60
  v_exp_f32 v61, v61
  v_exp_f32 v62, v62
  v_exp_f32 v63, v63
  v_cvt_pk_bf16_f32 v90, v60, v61
  v_cvt_pk_bf16_f32 v91, v62, v63
  v_mfma_f32_32x32x16_bf16 v[40:55], v[124:127], v[96:99], v[40:55]
  ds_read_b128 v[108:111], v12 offset:23040
  ds_read_b64 v[114:115], v13 offset:24064
  v_exp_f32 v64, v64
  v_exp_f32 v65, v65
  v_exp_f32 v66, v66
  v_exp_f32 v67, v67
  v_cvt_pk_bf16_f32 v92, v64, v65
  v_cvt_pk_bf16_f32 v93, v66, v67
  v_mfma_f32_32x32x16_bf16 v[40:55], v[128:131], v[100:103], v[40:55]
  buffer_load_dwordx4 v9, s[8:11], s76 offen offset:3072 lds
  v_exp_f32 v68, v68
  v_exp_f32 v69, v69
  v_exp_f32 v70, v70
  v_exp_f32 v71, v71
  s_mov_b64 exec, s[80:81]
  ds_read_b128 v[124:127], v14 offset:19200
  ds_read_b128 v[128:131], v14 offset:19840
  s_mov_b64 exec, -1
  v_cvt_pk_bf16_f32 v94, v68, v69
  v_cvt_pk_bf16_f32 v95, v70, v71
  s_waitcnt lgkmcnt(4)
  v_mfma_f32_32x32x8_bf16 v[56:71], v[112:113], v[20:21], v[24:39]
  v_exp_f32 v72, v72
  v_exp_f32 v73, v73
  v_exp_f32 v74, v74
  v_exp_f32 v75, v75
  v_cvt_pk_bf16_f32 v96, v72, v73
  v_cvt_pk_bf16_f32 v97, v74, v75
  v_mfma_f32_32x32x16_bf16 v[56:71], v[104:107], v[16:19], v[56:71]
  v_exp_f32 v76, v76
  v_exp_f32 v77, v77
  v_exp_f32 v78, v78
  v_exp_f32 v79, v79
  v_cvt_pk_bf16_f32 v98, v76, v77
  v_cvt_pk_bf16_f32 v99, v78, v79
  v_mfma_f32_32x32x16_bf16 v[40:55], v[116:119], v[88:91], v[40:55]
  ds_read_b128 v[104:107], v12 offset:25600
  ds_read_b64 v[112:113], v13 offset:26624
  s_add_u32 s76, s76, 4096
  s_mov_b32 m0, s76
  s_nop 0
  buffer_load_dwordx4 v9, s[8:11], s76 offen offset:0 lds
  v_exp_f32 v80, v80
  v_exp_f32 v81, v81
  v_exp_f32 v82, v82
  v_exp_f32 v83, v83
  v_cvt_pk_bf16_f32 v100, v80, v81
  v_cvt_pk_bf16_f32 v101, v82, v83
  v_mfma_f32_32x32x16_bf16 v[40:55], v[120:123], v[92:95], v[40:55]
  v_exp_f32 v84, v84
  v_exp_f32 v85, v85
  v_exp_f32 v86, v86
  v_exp_f32 v87, v87
  s_mov_b64 exec, s[80:81]
  ds_read_b128 v[116:119], v14 offset:21760
  ds_read_b128 v[120:123], v14 offset:22400
  s_mov_b64 exec, -1
  v_cvt_pk_bf16_f32 v102, v84, v85
  v_cvt_pk_bf16_f32 v103, v86, v87
  s_setprio 2
  s_waitcnt lgkmcnt(4)
  v_mfma_f32_32x32x8_bf16 v[72:87], v[114:115], v[20:21], v[24:39]
  v_exp_f32 v56, v56
  v_exp_f32 v57, v57
  v_exp_f32 v58, v58
  v_exp_f32 v59, v59
  v_cvt_pk_bf16_f32 v88, v56, v57
  v_cvt_pk_bf16_f32 v89, v58, v59
  v_mfma_f32_32x32x16_bf16 v[72:87], v[108:111], v[16:19], v[72:87]
  buffer_load_dwordx4 v9, s[8:11], s76 offen offset:1024 lds
  v_exp_f32 v60, v60
  v_exp_f32 v61, v61
  v_exp_f32 v62, v62
  v_exp_f32 v63, v63
  v_cvt_pk_bf16_f32 v90, v60, v61
  v_cvt_pk_bf16_f32 v91, v62, v63
  v_mfma_f32_32x32x16_bf16 v[40:55], v[124:127], v[96:99], v[40:55]
  ds_read_b128 v[108:111], v12 offset:28160
  ds_read_b64 v[114:115], v13 offset:29184
  v_exp_f32 v64, v64
  v_exp_f32 v65, v65
  v_exp_f32 v66, v66
  v_exp_f32 v67, v67
  v_cvt_pk_bf16_f32 v92, v64, v65
  v_cvt_pk_bf16_f32 v93, v66, v67
  v_mfma_f32_32x32x16_bf16 v[40:55], v[128:131], v[100:103], v[40:55]
  v_exp_f32 v68, v68
  v_exp_f32 v69, v69
  v_exp_f32 v70, v70
  v_exp_f32 v71, v71
  s_mov_b64 exec, s[80:81]
  ds_read_b128 v[124:127], v14 offset:24320
  ds_read_b128 v[128:131], v14 offset:24960
  s_mov_b64 exec, -1
  v_cvt_pk_bf16_f32 v94, v68, v69
  v_cvt_pk_bf16_f32 v95, v70, v71
  s_waitcnt lgkmcnt(4)
  v_mfma_f32_32x32x8_bf16 v[56:71], v[112:113], v[20:21], v[24:39]
  buffer_load_dwordx4 v9, s[8:11], s76 offen offset:2048 lds
  v_exp_f32 v72, v72
  v_exp_f32 v73, v73
  v_exp_f32 v74, v74
  v_exp_f32 v75, v75
  v_cvt_pk_bf16_f32 v96, v72, v73
  v_cvt_pk_bf16_f32 v97, v74, v75
  v_mfma_f32_32x32x16_bf16 v[56:71], v[104:107], v[16:19], v[56:71]
  v_exp_f32 v76, v76
  v_exp_f32 v77, v77
  v_exp_f32 v78, v78
  v_exp_f32 v79, v79
  v_cvt_pk_bf16_f32 v98, v76, v77
  v_cvt_pk_bf16_f32 v99, v78, v79
  v_mfma_f32_32x32x16_bf16 v[40:55], v[116:119], v[88:91], v[40:55]
  ds_read_b128 v[104:107], v12 offset:30720
  ds_read_b64 v[112:113], v13 offset:31744
  v_exp_f32 v80, v80
  v_exp_f32 v81, v81
  v_exp_f32 v82, v82
  v_exp_f32 v83, v83
  v_cvt_pk_bf16_f32 v100, v80, v81
  v_cvt_pk_bf16_f32 v101, v82, v83
  v_mfma_f32_32x32x16_bf16 v[40:55], v[120:123], v[92:95], v[40:55]
  buffer_load_dwordx4 v9, s[8:11], s76 offen offset:3072 lds
  v_exp_f32 v84, v84
  v_exp_f32 v85, v85
  v_exp_f32 v86, v86
  v_exp_f32 v87, v87
  s_mov_b64 exec, s[80:81]
  ds_read_b128 v[116:119], v14 offset:26880
  ds_read_b128 v[120:123], v14 offset:27520
  s_mov_b64 exec, -1
  v_cvt_pk_bf16_f32 v102, v84, v85
  v_cvt_pk_bf16_f32 v103, v86, v87
  s_setprio 2
  s_waitcnt lgkmcnt(4)
  v_mfma_f32_32x32x8_bf16 v[72:87], v[114:115], v[20:21], v[24:39]
  v_exp_f32 v56, v56
  v_exp_f32 v57, v57
  v_exp_f32 v58, v58
  v_exp_f32 v59, v59
  v_cvt_pk_bf16_f32 v88, v56, v57
  v_cvt_pk_bf16_f32 v89, v58, v59
  v_mfma_f32_32x32x16_bf16 v[72:87], v[108:111], v[16:19], v[72:87]
  v_exp_f32 v60, v60
  v_exp_f32 v61, v61
  v_exp_f32 v62, v62
  v_exp_f32 v63, v63
  v_cvt_pk_bf16_f32 v90, v60, v61
  v_cvt_pk_bf16_f32 v91, v62, v63
  v_mfma_f32_32x32x16_bf16 v[40:55], v[124:127], v[96:99], v[40:55]
  ds_read_b128 v[108:111], v12 offset:33280
  ds_read_b64 v[114:115], v13 offset:34304
  s_add_u32 s76, s76, 4096
  s_mov_b32 m0, s76
  s_nop 0
  buffer_load_dwordx4 v9, s[8:11], s76 offen offset:0 lds
  v_exp_f32 v64, v64
  v_exp_f32 v65, v65
  v_exp_f32 v66, v66
  v_exp_f32 v67, v67
  v_cvt_pk_bf16_f32 v92, v64, v65
  v_cvt_pk_bf16_f32 v93, v66, v67
  v_mfma_f32_32x32x16_bf16 v[40:55], v[128:131], v[100:103], v[40:55]
  v_exp_f32 v68, v68
  v_exp_f32 v69, v69
  v_exp_f32 v70, v70
  v_exp_f32 v71, v71
  s_mov_b64 exec, s[80:81]
  ds_read_b128 v[124:127], v14 offset:29440
  ds_read_b128 v[128:131], v14 offset:30080
  s_mov_b64 exec, -1
  v_cvt_pk_bf16_f32 v94, v68, v69
  v_cvt_pk_bf16_f32 v95, v70, v71
  s_waitcnt lgkmcnt(4)
  v_mfma_f32_32x32x8_bf16 v[56:71], v[112:113], v[20:21], v[24:39]
  v_exp_f32 v72, v72
  v_exp_f32 v73, v73
  v_exp_f32 v74, v74
  v_exp_f32 v75, v75
  v_cvt_pk_bf16_f32 v96, v72, v73
  v_cvt_pk_bf16_f32 v97, v74, v75
  v_mfma_f32_32x32x16_bf16 v[56:71], v[104:107], v[16:19], v[56:71]
  v_exp_f32 v76, v76
  v_exp_f32 v77, v77
  v_exp_f32 v78, v78
  v_exp_f32 v79, v79
  v_cvt_pk_bf16_f32 v98, v76, v77
  v_cvt_pk_bf16_f32 v99, v78, v79
  v_mfma_f32_32x32x16_bf16 v[40:55], v[116:119], v[88:91], v[40:55]
  ds_read_b128 v[104:107], v12 offset:35840
  ds_read_b64 v[112:113], v13 offset:36864
  v_exp_f32 v80, v80
  v_exp_f32 v81, v81
  v_exp_f32 v82, v82
  v_exp_f32 v83, v83
  v_cvt_pk_bf16_f32 v100, v80, v81
  v_cvt_pk_bf16_f32 v101, v82, v83
  v_mfma_f32_32x32x16_bf16 v[40:55], v[120:123], v[92:95], v[40:55]
  v_exp_f32 v84, v84
  v_exp_f32 v85, v85
  v_exp_f32 v86, v86
  v_exp_f32 v87, v87
  s_mov_b64 exec, s[80:81]
  ds_read_b128 v[116:119], v14 offset:32000
  ds_read_b128 v[120:123], v14 offset:32640
  s_mov_b64 exec, -1
  v_cvt_pk_bf16_f32 v102, v84, v85
  v_cvt_pk_bf16_f32 v103, v86, v87
  s_setprio 1
  s_waitcnt lgkmcnt(4)
  v_mfma_f32_32x32x8_bf16 v[72:87], v[114:115], v[20:21], v[24:39]
  v_exp_f32 v56, v56
  v_exp_f32 v57, v57
  v_exp_f32 v58, v58
  v_exp_f32 v59, v59
  v_cvt_pk_bf16_f32 v88, v56, v57
  v_cvt_pk_bf16_f32 v89, v58, v59
  v_mfma_f32_32x32x16_bf16 v[72:87], v[108:111], v[16:19], v[72:87]
  v_exp_f32 v60, v60
  v_exp_f32 v61, v61
  v_exp_f32 v62, v62
  v_exp_f32 v63, v63
  v_cvt_pk_bf16_f32 v90, v60, v61
  v_cvt_pk_bf16_f32 v91, v62, v63
  v_mfma_f32_32x32x16_bf16 v[40:55], v[124:127], v[96:99], v[40:55]
  ds_read_b128 v[108:111], v12 offset:38400
  ds_read_b64 v[114:115], v13 offset:39424
  v_exp_f32 v64, v64
  v_exp_f32 v65, v65
  v_exp_f32 v66, v66
  v_exp_f32 v67, v67
  v_cvt_pk_bf16_f32 v92, v64, v65
  v_cvt_pk_bf16_f32 v93, v66, v67
  v_mfma_f32_32x32x16_bf16 v[40:55], v[128:131], v[100:103], v[40:55]
  v_exp_f32 v68, v68
  v_exp_f32 v69, v69
  v_exp_f32 v70, v70
  v_exp_f32 v71, v71
  s_mov_b64 exec, s[80:81]
  ds_read_b128 v[124:127], v14 offset:34560
  ds_read_b128 v[128:131], v14 offset:35200
  s_mov_b64 exec, -1
  v_cvt_pk_bf16_f32 v94, v68, v69
  v_cvt_pk_bf16_f32 v95, v70, v71
  s_waitcnt lgkmcnt(4)
  v_mfma_f32_32x32x8_bf16 v[56:71], v[112:113], v[20:21], v[24:39]
  v_exp_f32 v72, v72
  v_exp_f32 v73, v73
  v_exp_f32 v74, v74
  v_exp_f32 v75, v75
  v_cvt_pk_bf16_f32 v96, v72, v73
  v_cvt_pk_bf16_f32 v97, v74, v75
  v_mfma_f32_32x32x16_bf16 v[56:71], v[104:107], v[16:19], v[56:71]
  v_exp_f32 v76, v76
  v_exp_f32 v77, v77
  v_exp_f32 v78, v78
  v_exp_f32 v79, v79
  v_cvt_pk_bf16_f32 v98, v76, v77
  v_cvt_pk_bf16_f32 v99, v78, v79
  v_mfma_f32_32x32x16_bf16 v[40:55], v[116:119], v[88:91], v[40:55]
  ds_read_b128 v[104:107], v12 offset:40960
  ds_read_b64 v[112:113], v13 offset:41984
  v_exp_f32 v80, v80
  v_exp_f32 v81, v81
  v_exp_f32 v82, v82
  v_exp_f32 v83, v83
  v_cvt_pk_bf16_f32 v100, v80, v81
  v_cvt_pk_bf16_f32 v101, v82, v83
  v_mfma_f32_32x32x16_bf16 v[40:55], v[120:123], v[92:95], v[40:55]
  v_exp_f32 v84, v84
  v_exp_f32 v85, v85
  v_exp_f32 v86, v86
  v_exp_f32 v87, v87
  s_mov_b64 exec, s[80:81]
  ds_read_b128 v[116:119], v14 offset:37120
  ds_read_b128 v[120:123], v14 offset:37760
  s_mov_b64 exec, -1
  v_cvt_pk_bf16_f32 v102, v84, v85
  v_cvt_pk_bf16_f32 v103, v86, v87
  s_setprio 0
  s_waitcnt lgkmcnt(4)
  v_mfma_f32_32x32x8_bf16 v[72:87], v[114:115], v[20:21], v[24:39]
  v_exp_f32 v56, v56
  v_exp_f32 v57, v57
  v_exp_f32 v58, v58
  v_exp_f32 v59, v59
  v_cvt_pk_bf16_f32 v88, v56, v57
  v_cvt_pk_bf16_f32 v89, v58, v59
  v_mfma_f32_32x32x16_bf16 v[72:87], v[108:111], v[16:19], v[72:87]
  v_exp_f32 v60, v60
  v_exp_f32 v61, v61
  v_exp_f32 v62, v62
  v_exp_f32 v63, v63
  v_cvt_pk_bf16_f32 v90, v60, v61
  v_cvt_pk_bf16_f32 v91, v62, v63
  v_mfma_f32_32x32x16_bf16 v[40:55], v[124:127], v[96:99], v[40:55]
  ds_read_b128 v[108:111], v12 offset:43520
  ds_read_b64 v[114:115], v13 offset:44544
  v_exp_f32 v64, v64
  v_exp_f32 v65, v65
  v_exp_f32 v66, v66
  v_exp_f32 v67, v67
  v_cvt_pk_bf16_f32 v92, v64, v65
  v_cvt_pk_bf16_f32 v93, v66, v67
  v_mfma_f32_32x32x16_bf16 v[40:55], v[128:131], v[100:103], v[40:55]
  v_exp_f32 v68, v68
  v_exp_f32 v69, v69
  v_exp_f32 v70, v70
  v_exp_f32 v71, v71
  s_mov_b64 exec, s[80:81]
  ds_read_b128 v[124:127], v14 offset:39680
  ds_read_b128 v[128:131], v14 offset:40320
  s_mov_b64 exec, -1
  v_cvt_pk_bf16_f32 v94, v68, v69
  v_cvt_pk_bf16_f32 v95, v70, v71
  s_waitcnt lgkmcnt(4)
  v_mfma_f32_32x32x8_bf16 v[56:71], v[112:113], v[20:21], v[24:39]
  v_exp_f32 v72, v72
  v_exp_f32 v73, v73
  v_exp_f32 v74, v74
  v_exp_f32 v75, v75
  v_cvt_pk_bf16_f32 v96, v72, v73
  v_cvt_pk_bf16_f32 v97, v74, v75
  v_mfma_f32_32x32x16_bf16 v[56:71], v[104:107], v[16:19], v[56:71]
  v_exp_f32 v76, v76
  v_exp_f32 v77, v77
  v_exp_f32 v78, v78
  v_exp_f32 v79, v79
  v_cvt_pk_bf16_f32 v98, v76, v77
  v_cvt_pk_bf16_f32 v99, v78, v79
  v_mfma_f32_32x32x16_bf16 v[40:55], v[116:119], v[88:91], v[40:55]
  ds_read_b128 v[104:107], v12 offset:46080
  ds_read_b64 v[112:113], v13 offset:47104
  v_exp_f32 v80, v80
  v_exp_f32 v81, v81
  v_exp_f32 v82, v82
  v_exp_f32 v83, v83
  v_cvt_pk_bf16_f32 v100, v80, v81
  v_cvt_pk_bf16_f32 v101, v82, v83
  v_mfma_f32_32x32x16_bf16 v[40:55], v[120:123], v[92:95], v[40:55]
  v_exp_f32 v84, v84
  v_exp_f32 v85, v85
  v_exp_f32 v86, v86
  v_exp_f32 v87, v87
  s_mov_b64 exec, s[80:81]
  ds_read_b128 v[116:119], v14 offset:42240
  ds_read_b128 v[120:123], v14 offset:42880
  s_mov_b64 exec, -1
  v_cvt_pk_bf16_f32 v102, v84, v85
  v_cvt_pk_bf16_f32 v103, v86, v87
  v_add_u32 v12, 40960, v12
  v_add_u32 v13, 40960, v13
  v_add_u32 v14, 40960, v14
  s_sub_u32 s73, s73, 1
  s_add_u32 s12, s6, 0x800000
  s_addc_u32 s13, s7, 0
  s_mov_b32 s14, 0xa40000
  s_mov_b32 s15, 0x00020000
  v_mov_b32 v136, -1
  v_mov_b32 v137, -1
  v_mov_b32 v138, -1
  v_mov_b32 v139, -1
  s_lshl_b32 s79, s2, 2
  s_add_u32 s79, s79, s66
  s_sub_u32 s79, s79, 4
  s_lshl_b32 s79, s79, 10
  s_cmp_lt_u32 s66, 4
  s_cselect_b32 s79, 0x70000000, s79
  s_mov_b32 s74, 0
  s_mov_b32 s73, 3
  s_waitcnt vmcnt(0)
  s_barrier
  s_setprio 3
  s_cmp_ge_u32 s66, 4
  s_cbranch_scc1 k2_fillu
  s_add_u32 m0, s35, 0
  s_nop 0
  buffer_load_dwordx4 v140, s[48:51], s36 offen offset:0 lds
  s_add_u32 s36, s36, s38
  buffer_load_dwordx4 v140, s[48:51], s36 offen offset:1024 lds
  s_add_u32 s36, s36, s33
  buffer_load_dwordx4 v140, s[48:51], s36 offen offset:2048 lds
  s_add_u32 s36, s36, s38
  buffer_load_dwordx4 v140, s[48:51], s36 offen offset:3072 lds
  s_add_u32 m0, s35, 4096
  s_nop 0
  buffer_load_dwordx4 v141, s[52:55], s37 offen offset:0 lds
  s_add_u32 s37, s37, s39
  buffer_load_dwordx4 v141, s[52:55], s37 offen offset:1024 lds
  s_add_u32 s37, s37, s34
  buffer_load_dwordx4 v141, s[52:55], s37 offen offset:2048 lds
  s_add_u32 s37, s37, s39
  buffer_load_dwordx4 v141, s[52:55], s37 offen offset:3072 lds
  s_branch k2_loop
k2_fillu:
  s_add_u32 s24, s6, 0x1240000
  s_addc_u32 s25, s7, 0
  s_mov_b32 s26, 0x6c0000
  s_mov_b32 s27, 0x00020000
  s_mul_i32 s70, s2, 55296
  s_lshl_b32 s71, s66, 10
  s_add_u32 s70, s70, s71
  s_sub_u32 s70, s70, 4096
  buffer_store_dwordx4 v[136:139], v9, s[24:27], s70 offen sc1
.p2align 6
k2_loop:
  s_waitcnt lgkmcnt(4)
  s_cmp_ge_u32 s79, s14
  s_cbranch_scc1 k2_nf0
  buffer_store_dwordx4 v[136:139], v9, s[12:15], s79 offen sc1
  s_add_u32 s79, s79, 1048576
k2_nf0:
  v_mfma_f32_32x32x8_bf16 v[72:87], v[114:115], v[20:21], v[24:39]
  v_exp_f32 v56, v56
  v_exp_f32 v57, v57
  v_exp_f32 v58, v58
  v_exp_f32 v59, v59
  v_cvt_pk_bf16_f32 v88, v56, v57
  v_cvt_pk_bf16_f32 v89, v58, v59
  v_mfma_f32_32x32x16_bf16 v[72:87], v[108:111], v[16:19], v[72:87]
  v_exp_f32 v60, v60
  v_exp_f32 v61, v61
  v_exp_f32 v62, v62
  v_exp_f32 v63, v63
  v_cvt_pk_bf16_f32 v90, v60, v61
  v_cvt_pk_bf16_f32 v91, v62, v63
  v_mfma_f32_32x32x16_bf16 v[40:55], v[124:127], v[96:99], v[40:55]
  ds_read_b128 v[108:111], v12 offset:7680
  ds_read_b64 v[114:115], v13 offset:8704
  v_exp_f32 v64, v64
  v_exp_f32 v65, v65
  v_exp_f32 v66, v66
  v_exp_f32 v67, v67
  v_cvt_pk_bf16_f32 v92, v64, v65
  v_cvt_pk_bf16_f32 v93, v66, v67
  v_mfma_f32_32x32x16_bf16 v[40:55], v[128:131], v[100:103], v[40:55]
  v_exp_f32 v68, v68
  v_exp_f32 v69, v69
  v_exp_f32 v70, v70
  v_exp_f32 v71, v71
  s_mov_b64 exec, s[80:81]
  ds_read_b128 v[124:127], v14 offset:3840
  ds_read_b128 v[128:131], v14 offset:4480
  s_mov_b64 exec, -1
  v_cvt_pk_bf16_f32 v94, v68, v69
  v_cvt_pk_bf16_f32 v95, v70, v71
  s_waitcnt lgkmcnt(4)
  v_mfma_f32_32x32x8_bf16 v[56:71], v[112:113], v[20:21], v[24:39]
  v_exp_f32 v72, v72
  v_exp_f32 v73, v73
  v_exp_f32 v74, v74
  v_exp_f32 v75, v75
  v_cvt_pk_bf16_f32 v96, v72, v73
  v_cvt_pk_bf16_f32 v97, v74, v75
  v_mfma_f32_32x32x16_bf16 v[56:71], v[104:107], v[16:19], v[56:71]
  v_exp_f32 v76, v76
  v_exp_f32 v77, v77
  v_exp_f32 v78, v78
  v_exp_f32 v79, v79
  v_cvt_pk_bf16_f32 v98, v76, v77
  v_cvt_pk_bf16_f32 v99, v78, v79
  v_mfma_f32_32x32x16_bf16 v[40:55], v[116:119], v[88:91], v[40:55]
  ds_read_b128 v[104:107], v12 offset:10240
  ds_read_b64 v[112:113], v13 offset:11264
  v_exp_f32 v80, v80
  v_exp_f32 v81, v81
  v_exp_f32 v82, v82
  v_exp_f32 v83, v83
  v_cvt_pk_bf16_f32 v100, v80, v81
  v_cvt_pk_bf16_f32 v101, v82, v83
  v_mfma_f32_32x32x16_bf16 v[40:55], v[120:123], v[92:95], v[40:55]
  v_exp_f32 v84, v84
  v_exp_f32 v85, v85
  v_exp_f32 v86, v86
  v_exp_f32 v87, v87
  s_mov_b64 exec, s[80:81]
  ds_read_b128 v[116:119], v14 offset:6400
  ds_read_b128 v[120:123], v14 offset:7040
  s_mov_b64 exec, -1
  v_cvt_pk_bf16_f32 v102, v84, v85
  v_cvt_pk_bf16_f32 v103, v86, v87
  s_waitcnt lgkmcnt(4)
  s_cmp_ge_u32 s79, s14
  s_cbranch_scc1 k2_nf2
  buffer_store_dwordx4 v[136:139], v9, s[12:15], s79 offen sc1
  s_add_u32 s79, s79, 1048576
k2_nf2:
  v_mfma_f32_32x32x8_bf16 v[72:87], v[114:115], v[20:21], v[24:39]
  v_exp_f32 v56, v56
  v_exp_f32 v57, v57
  v_exp_f32 v58, v58
  v_exp_f32 v59, v59
  v_cvt_pk_bf16_f32 v88, v56, v57
  v_cvt_pk_bf16_f32 v89, v58, v59
  v_mfma_f32_32x32x16_bf16 v[72:87], v[108:111], v[16:19], v[72:87]
  v_exp_f32 v60, v60
  v_exp_f32 v61, v61
  v_exp_f32 v62, v62
  v_exp_f32 v63, v63
  v_cvt_pk_bf16_f32 v90, v60, v61
  v_cvt_pk_bf16_f32 v91, v62, v63
  v_mfma_f32_32x32x16_bf16 v[40:55], v[124:127], v[96:99], v[40:55]
  ds_read_b128 v[108:111], v12 offset:12800
  ds_read_b64 v[114:115], v13 offset:13824
  v_exp_f32 v64, v64
  v_exp_f32 v65, v65
  v_exp_f32 v66, v66
  v_exp_f32 v67, v67
  v_cvt_pk_bf16_f32 v92, v64, v65
  v_cvt_pk_bf16_f32 v93, v66, v67
  v_mfma_f32_32x32x16_bf16 v[40:55], v[128:131], v[100:103], v[40:55]
  v_exp_f32 v68, v68
  v_exp_f32 v69, v69
  v_exp_f32 v70, v70
  v_exp_f32 v71, v71
  s_mov_b64 exec, s[80:81]
  ds_read_b128 v[124:127], v14 offset:8960
  ds_read_b128 v[128:131], v14 offset:9600
  s_mov_b64 exec, -1
  v_cvt_pk_bf16_f32 v94, v68, v69
  v_cvt_pk_bf16_f32 v95, v70, v71
  s_waitcnt lgkmcnt(4)
  v_mfma_f32_32x32x8_bf16 v[56:71], v[112:113], v[20:21], v[24:39]
  v_exp_f32 v72, v72
  v_exp_f32 v73, v73
  v_exp_f32 v74, v74
  v_exp_f32 v75, v75
  v_cvt_pk_bf16_f32 v96, v72, v73
  v_cvt_pk_bf16_f32 v97, v74, v75
  v_mfma_f32_32x32x16_bf16 v[56:71], v[104:107], v[16:19], v[56:71]
  v_exp_f32 v76, v76
  v_exp_f32 v77, v77
  v_exp_f32 v78, v78
  v_exp_f32 v79, v79
  v_cvt_pk_bf16_f32 v98, v76, v77
  v_cvt_pk_bf16_f32 v99, v78, v79
  v_mfma_f32_32x32x16_bf16 v[40:55], v[116:119], v[88:91], v[40:55]
  ds_read_b128 v[104:107], v12 offset:15360
  ds_read_b64 v[112:113], v13 offset:16384
  v_exp_f32 v80, v80
  v_exp_f32 v81, v81
  v_exp_f32 v82, v82
  v_exp_f32 v83, v83
  v_cvt_pk_bf16_f32 v100, v80, v81
  v_cvt_pk_bf16_f32 v101, v82, v83
  v_mfma_f32_32x32x16_bf16 v[40:55], v[120:123], v[92:95], v[40:55]
  v_exp_f32 v84, v84
  v_exp_f32 v85, v85
  v_exp_f32 v86, v86
  v_exp_f32 v87, v87
  s_mov_b64 exec, s[80:81]
  ds_read_b128 v[116:119], v14 offset:11520
  ds_read_b128 v[120:123], v14 offset:12160
  s_mov_b64 exec, -1
  v_cvt_pk_bf16_f32 v102, v84, v85
  v_cvt_pk_bf16_f32 v103, v86, v87
  v_add_u32 v12, 10240, v12
  v_add_u32 v13, 10240, v13
  v_add_u32 v14, 10240, v14
  s_sub_u32 s73, s73, 1
  s_cmp_lg_u32 s73, 0
  s_cbranch_scc1 k2_loop
  s_add_u32 s74, s74, 1
  s_cmp_eq_u32 s74, 1
  s_cbranch_scc1 k2_hook1
  s_cmp_eq_u32 s74, 2
  s_cbranch_scc1 k2_hook2
  s_cmp_eq_u32 s74, 3
  s_cbranch_scc1 k2_hook3
  s_cmp_eq_u32 s74, 4
  s_cbranch_scc1 k2_hook4
  s_cmp_lg_u32 s66, 0
  s_cbranch_scc1 k2_jdone
  s_mov_b32 s70, 49152
  v_lshlrev_b32 v2, 7, v0
  s_mov_b32 s72, 400000
k2_jpoll:
  buffer_load_dword v1, v2, s[28:31], s70 offen sc1
  s_sub_u32 s72, s72, 1
  s_cbranch_scc1 kp_end
  s_waitcnt vmcnt(0)
  v_cmp_gt_u32 vcc, 16, v1
  s_cbranch_vccnz k2_jpoll
k2_jdone:
  s_barrier
  s_and_b32 s72, s66, 3
  s_mul_i32 s72, s72, 5120
  s_cmp_ge_u32 s66, 4
  s_cselect_b32 s36, 20480, 0
  s_cselect_b32 s42, 0, 102400
  s_mov_b32 s37, 40960
  s_cselect_b32 s37, 61440, s37
  s_mov_b32 s43, 20480
  s_cselect_b32 s43, 40960, s43
  s_mov_b32 s38, 81920
  s_cselect_b32 s38, 409600, s38
  s_mov_b32 s39, 61440
  s_cselect_b32 s39, 81920, s39
  s_setprio 3
  s_waitcnt lgkmcnt(4)
  v_mfma_f32_32x32x8_bf16 v[72:87], v[114:115], v[20:21], v[24:39]
  s_add_u32 s71, s72, s42
  s_mov_b32 m0, s71
  s_add_u32 s70, s78, s36
  buffer_load_dwordx4 v9, s[20:23], s70 offen offset:0 lds
  v_exp_f32 v56, v56
  v_exp_f32 v57, v57
  v_exp_f32 v58, v58
  v_exp_f32 v59, v59
  v_cvt_pk_bf16_f32 v88, v56, v57
  v_cvt_pk_bf16_f32 v89, v58, v59
  v_mfma_f32_32x32x16_bf16 v[72:87], v[108:111], v[16:19], v[72:87]
  v_exp_f32 v60, v60
  v_exp_f32 v61, v61
  v_exp_f32 v62, v62
  v_exp_f32 v63, v63
  v_cvt_pk_bf16_f32 v90, v60, v61
  v_cvt_pk_bf16_f32 v91, v62, v63
  v_mfma_f32_32x32x16_bf16 v[40:55], v[124:127], v[96:99], v[40:55]
  ds_read_b128 v[108:111], v12 offset:7680
  ds_read_b64 v[114:115], v13 offset:8704
  buffer_load_dwordx4 v9, s[20:23], s70 offen offset:1024 lds
  v_exp_f32 v64, v64
  v_exp_f32 v65, v65
  v_exp_f32 v66, v66
  v_exp_f32 v67, v67
  v_cvt_pk_bf16_f32 v92, v64, v65
  v_cvt_pk_bf16_f32 v93, v66, v67
  v_mfma_f32_32x32x16_bf16 v[40:55], v[128:131], v[100:103], v[40:55]
  v_exp_f32 v68, v68
  v_exp_f32 v69, v69
  v_exp_f32 v70, v70
  v_exp_f32 v71, v71
  s_mov_b64 exec, s[80:81]
  ds_read_b128 v[124:127], v14 offset:3840
  ds_read_b128 v[128:131], v14 offset:4480
  s_mov_b64 exec, -1
  v_cvt_pk_bf16_f32 v94, v68, v69
  v_cvt_pk_bf16_f32 v95, v70, v71
  s_waitcnt lgkmcnt(4)
  v_mfma_f32_32x32x8_bf16 v[56:71], v[112:113], v[20:21], v[24:39]
  buffer_load_dwordx4 v9, s[20:23], s70 offen offset:2048 lds
  v_exp_f32 v72, v72
  v_exp_f32 v73, v73
  v_exp_f32 v74, v74
  v_exp_f32 v75, v75
  v_cvt_pk_bf16_f32 v96, v72, v73
  v_cvt_pk_bf16_f32 v97, v74, v75
  v_mfma_f32_32x32x16_bf16 v[56:71], v[104:107], v[16:19], v[56:71]
  v_exp_f32 v76, v76
  v_exp_f32 v77, v77
  v_exp_f32 v78, v78
  v_exp_f32 v79, v79
  v_cvt_pk_bf16_f32 v98, v76, v77
  v_cvt_pk_bf16_f32 v99, v78, v79
  v_mfma_f32_32x32x16_bf16 v[40:55], v[116:119], v[88:91], v[40:55]
  ds_read_b128 v[104:107], v12 offset:10240
  ds_read_b64 v[112:113], v13 offset:11264
  buffer_load_dwordx4 v9, s[20:23], s70 offen offset:3072 lds
  v_exp_f32 v80, v80
  v_exp_f32 v81, v81
  v_exp_f32 v82, v82
  v_exp_f32 v83, v83
  v_cvt_pk_bf16_f32 v100, v80, v81
  v_cvt_pk_bf16_f32 v101, v82, v83
  v_mfma_f32_32x32x16_bf16 v[40:55], v[120:123], v[92:95], v[40:55]
  v_exp_f32 v84, v84
  v_exp_f32 v85, v85
  v_exp_f32 v86, v86
  v_exp_f32 v87, v87
  s_mov_b64 exec, s[80:81]
  ds_read_b128 v[116:119], v14 offset:6400
  ds_read_b128 v[120:123], v14 offset:7040
  s_mov_b64 exec, -1
  v_cvt_pk_bf16_f32 v102, v84, v85
  v_cvt_pk_bf16_f32 v103, v86, v87
  s_setprio 3
  s_waitcnt lgkmcnt(4)
  v_mfma_f32_32x32x8_bf16 v[72:87], v[114:115], v[20:21], v[24:39]
  s_add_u32 m0, s71, 4096
  s_add_u32 s70, s70, 4096
  buffer_load_dwordx4 v9, s[20:23], s70 offen offset:0 lds
  v_exp_f32 v56, v56
  v_exp_f32 v57, v57
  v_exp_f32 v58, v58
  v_exp_f32 v59, v59
  v_cvt_pk_bf16_f32 v88, v56, v57
  v_cvt_pk_bf16_f32 v89, v58, v59
  v_mfma_f32_32x32x16_bf16 v[72:87], v[108:111], v[16:19], v[72:87]
  v_exp_f32 v60, v60
  v_exp_f32 v61, v61
  v_exp_f32 v62, v62
  v_exp_f32 v63, v63
  v_cvt_pk_bf16_f32 v90, v60, v61
  v_cvt_pk_bf16_f32 v91, v62, v63
  v_mfma_f32_32x32x16_bf16 v[40:55], v[124:127], v[96:99], v[40:55]
  ds_read_b128 v[108:111], v12 offset:12800
  ds_read_b64 v[114:115], v13 offset:13824
  s_add_u32 s71, s72, s43
  s_mov_b32 m0, s71
  s_add_u32 s70, s78, s37
  buffer_load_dwordx4 v9, s[20:23], s70 offen offset:0 lds
  v_exp_f32 v64, v64
  v_exp_f32 v65, v65
  v_exp_f32 v66, v66
  v_exp_f32 v67, v67
  v_cvt_pk_bf16_f32 v92, v64, v65
  v_cvt_pk_bf16_f32 v93, v66, v67
  v_mfma_f32_32x32x16_bf16 v[40:55], v[128:131], v[100:103], v[40:55]
  v_exp_f32 v68, v68
  v_exp_f32 v69, v69
  v_exp_f32 v70, v70
  v_exp_f32 v71, v71
  s_mov_b64 exec, s[80:81]
  ds_read_b128 v[124:127], v14 offset:8960
  ds_read_b128 v[128:131], v14 offset:9600
  s_mov_b64 exec, -1
  v_cvt_pk_bf16_f32 v94, v68, v69
  v_cvt_pk_bf16_f32 v95, v70, v71
  s_waitcnt lgkmcnt(4)
  v_mfma_f32_32x32x8_bf16 v[56:71], v[112:113], v[20:21], v[24:39]
  buffer_load_dwordx4 v9, s[20:23], s70 offen offset:1024 lds
  v_exp_f32 v72, v72
  v_exp_f32 v73, v73
  v_exp_f32 v74, v74
  v_exp_f32 v75, v75
  v_cvt_pk_bf16_f32 v96, v72, v73
  v_cvt_pk_bf16_f32 v97, v74, v75
  v_mfma_f32_32x32x16_bf16 v[56:71], v[104:107], v[16:19], v[56:71]
  v_exp_f32 v76, v76
  v_exp_f32 v77, v77
  v_exp_f32 v78, v78
  v_exp_f32 v79, v79
  v_cvt_pk_bf16_f32 v98, v76, v77
  v_cvt_pk_bf16_f32 v99, v78, v79
  v_mfma_f32_32x32x16_bf16 v[40:55], v[116:119], v[88:91], v[40:55]
  ds_read_b128 v[104:107], v12 offset:15360
  ds_read_b64 v[112:113], v13 offset:16384
  buffer_load_dwordx4 v9, s[20:23], s70 offen offset:2048 lds
  v_exp_f32 v80, v80
  v_exp_f32 v81, v81
  v_exp_f32 v82, v82
  v_exp_f32 v83, v83
  v_cvt_pk_bf16_f32 v100, v80, v81
  v_cvt_pk_bf16_f32 v101, v82, v83
  v_mfma_f32_32x32x16_bf16 v[40:55], v[120:123], v[92:95], v[40:55]
  v_exp_f32 v84, v84
  v_exp_f32 v85, v85
  v_exp_f32 v86, v86
  v_exp_f32 v87, v87
  s_mov_b64 exec, s[80:81]
  ds_read_b128 v[116:119], v14 offset:11520
  ds_read_b128 v[120:123], v14 offset:12160
  s_mov_b64 exec, -1
  v_cvt_pk_bf16_f32 v102, v84, v85
  v_cvt_pk_bf16_f32 v103, v86, v87
  s_setprio 2
  s_waitcnt lgkmcnt(4)
  v_mfma_f32_32x32x8_bf16 v[72:87], v[114:115], v[20:21], v[24:39]
  buffer_load_dwordx4 v9, s[20:23], s70 offen offset:3072 lds
  v_exp_f32 v56, v56
  v_exp_f32 v57, v57
  v_exp_f32 v58, v58
  v_exp_f32 v59, v59
  v_cvt_pk_bf16_f32 v88, v56, v57
  v_cvt_pk_bf16_f32 v89, v58, v59
  v_mfma_f32_32x32x16_bf16 v[72:87], v[108:111], v[16:19], v[72:87]
  v_exp_f32 v60, v60
  v_exp_f32 v61, v61
  v_exp_f32 v62, v62
  v_exp_f32 v63, v63
  v_cvt_pk_bf16_f32 v90, v60, v61
  v_cvt_pk_bf16_f32 v91, v62, v63
  v_mfma_f32_32x32x16_bf16 v[40:55], v[124:127], v[96:99], v[40:55]
  ds_read_b128 v[108:111], v12 offset:17920
  ds_read_b64 v[114:115], v13 offset:18944
  s_add_u32 m0, s71, 4096
  s_add_u32 s70, s70, 4096
  buffer_load_dwordx4 v9, s[20:23], s70 offen offset:0 lds
  v_exp_f32 v64, v64
  v_exp_f32 v65, v65
  v_exp_f32 v66, v66
  v_exp_f32 v67, v67
  v_cvt_pk_bf16_f32 v92, v64, v65
  v_cvt_pk_bf16_f32 v93, v66, v67
  v_mfma_f32_32x32x16_bf16 v[40:55], v[128:131], v[100:103], v[40:55]
  v_exp_f32 v68, v68
  v_exp_f32 v69, v69
  v_exp_f32 v70, v70
  v_exp_f32 v71, v71
  s_mov_b64 exec, s[80:81]
  ds_read_b128 v[124:127], v14 offset:14080
  ds_read_b128 v[128:131], v14 offset:14720
  s_mov_b64 exec, -1
  v_cvt_pk_bf16_f32 v94, v68, v69
  v_cvt_pk_bf16_f32 v95, v70, v71
  s_waitcnt lgkmcnt(4)
  v_mfma_f32_32x32x8_bf16 v[56:71], v[112:113], v[20:21], v[24:39]
  s_add_u32 s71, s72, s39
  s_mov_b32 m0, s71
  s_add_u32 s70, s78, s38
  buffer_load_dwordx4 v9, s[20:23], s70 offen offset:0 lds
  v_exp_f32 v72, v72
  v_exp_f32 v73, v73
  v_exp_f32 v74, v74
  v_exp_f32 v75, v75
  v_cvt_pk_bf16_f32 v96, v72, v73
  v_cvt_pk_bf16_f32 v97, v74, v75
  v_mfma_f32_32x32x16_bf16 v[56:71], v[104:107], v[16:19], v[56:71]
  v_exp_f32 v76, v76
  v_exp_f32 v77, v77
  v_exp_f32 v78, v78
  v_exp_f32 v79, v79
  v_cvt_pk_bf16_f32 v98, v76, v77
  v_cvt_pk_bf16_f32 v99, v78, v79
  v_mfma_f32_32x32x16_bf16 v[40:55], v[116:119], v[88:91], v[40:55]
  ds_read_b128 v[104:107], v12 offset:20480
  ds_read_b64 v[112:113], v13 offset:21504
  buffer_load_dwordx4 v9, s[20:23], s70 offen offset:1024 lds
  v_exp_f32 v80, v80
  v_exp_f32 v81, v81
  v_exp_f32 v82, v82
  v_exp_f32 v83, v83
  v_cvt_pk_bf16_f32 v100, v80, v81
  v_cvt_pk_bf16_f32 v101, v82, v83
  v_mfma_f32_32x32x16_bf16 v[40:55], v[120:123], v[92:95], v[40:55]
  v_exp_f32 v84, v84
  v_exp_f32 v85, v85
  v_exp_f32 v86, v86
  v_exp_f32 v87, v87
  s_mov_b64 exec, s[80:81]
  ds_read_b128 v[116:119], v14 offset:16640
  ds_read_b128 v[120:123], v14 offset:17280
  s_mov_b64 exec, -1
  v_cvt_pk_bf16_f32 v102, v84, v85
  v_cvt_pk_bf16_f32 v103, v86, v87
  s_setprio 2
  s_waitcnt lgkmcnt(4)
  v_mfma_f32_32x32x8_bf16 v[72:87], v[114:115], v[20:21], v[24:39]
  buffer_load_dwordx4 v9, s[20:23], s70 offen offset:2048 lds
  v_exp_f32 v56, v56
  v_exp_f32 v57, v57
  v_exp_f32 v58, v58
  v_exp_f32 v59, v59
  v_cvt_pk_bf16_f32 v88, v56, v57
  v_cvt_pk_bf16_f32 v89, v58, v59
  v_mfma_f32_32x32x16_bf16 v[72:87], v[108:111], v[16:19], v[72:87]
  v_exp_f32 v60, v60
  v_exp_f32 v61, v61
  v_exp_f32 v62, v62
  v_exp_f32 v63, v63
  v_cvt_pk_bf16_f32 v90, v60, v61
  v_cvt_pk_bf16_f32 v91, v62, v63
  v_mfma_f32_32x32x16_bf16 v[40:55], v[124:127], v[96:99], v[40:55]
  ds_read_b128 v[108:111], v12 offset:23040
  ds_read_b64 v[114:115], v13 offset:24064
  buffer_load_dwordx4 v9, s[20:23], s70 offen offset:3072 lds
  v_exp_f32 v64, v64
  v_exp_f32 v65, v65
  v_exp_f32 v66, v66
  v_exp_f32 v67, v67
  v_cvt_pk_bf16_f32 v92, v64, v65
  v_cvt_pk_bf16_f32 v93, v66, v67
  v_mfma_f32_32x32x16_bf16 v[40:55], v[128:131], v[100:103], v[40:55]
  v_exp_f32 v68, v68
  v_exp_f32 v69, v69
  v_exp_f32 v70, v70
  v_exp_f32 v71, v71
  s_mov_b64 exec, s[80:81]
  ds_read_b128 v[124:127], v14 offset:19200
  ds_read_b128 v[128:131], v14 offset:19840
  s_mov_b64 exec, -1
  v_cvt_pk_bf16_f32 v94, v68, v69
  v_cvt_pk_bf16_f32 v95, v70, v71
  s_waitcnt lgkmcnt(4)
  v_mfma_f32_32x32x8_bf16 v[56:71], v[112:113], v[20:21], v[24:39]
  s_add_u32 m0, s71, 4096
  s_add_u32 s70, s70, 4096
  buffer_load_dwordx4 v9, s[20:23], s70 offen offset:0 lds
  v_exp_f32 v72, v72
  v_exp_f32 v73, v73
  v_exp_f32 v74, v74
  v_exp_f32 v75, v75
  v_cvt_pk_bf16_f32 v96, v72, v73
  v_cvt_pk_bf16_f32 v97, v74, v75
  v_mfma_f32_32x32x16_bf16 v[56:71], v[104:107], v[16:19], v[56:71]
  v_exp_f32 v76, v76
  v_exp_f32 v77, v77
  v_exp_f32 v78, v78
  v_exp_f32 v79, v79
  v_cvt_pk_bf16_f32 v98, v76, v77
  v_cvt_pk_bf16_f32 v99, v78, v79
  v_mfma_f32_32x32x16_bf16 v[40:55], v[116:119], v[88:91], v[40:55]
  ds_read_b128 v[104:107], v12 offset:25600
  ds_read_b64 v[112:113], v13 offset:26624
  v_exp_f32 v80, v80
  v_exp_f32 v81, v81
  v_exp_f32 v82, v82
  v_exp_f32 v83, v83
  v_cvt_pk_bf16_f32 v100, v80, v81
  v_cvt_pk_bf16_f32 v101, v82, v83
  v_mfma_f32_32x32x16_bf16 v[40:55], v[120:123], v[92:95], v[40:55]
  v_exp_f32 v84, v84
  v_exp_f32 v85, v85
  v_exp_f32 v86, v86
  v_exp_f32 v87, v87
  s_mov_b64 exec, s[80:81]
  ds_read_b128 v[116:119], v14 offset:21760
  ds_read_b128 v[120:123], v14 offset:22400
  s_mov_b64 exec, -1
  v_cvt_pk_bf16_f32 v102, v84, v85
  v_cvt_pk_bf16_f32 v103, v86, v87
  s_setprio 1
  s_waitcnt lgkmcnt(4)
  v_mfma_f32_32x32x8_bf16 v[72:87], v[114:115], v[20:21], v[24:39]
  v_exp_f32 v56, v56
  v_exp_f32 v57, v57
  v_exp_f32 v58, v58
  v_exp_f32 v59, v59
  v_cvt_pk_bf16_f32 v88, v56, v57
  v_cvt_pk_bf16_f32 v89, v58, v59
  v_mfma_f32_32x32x16_bf16 v[72:87], v[108:111], v[16:19], v[72:87]
  v_exp_f32 v60, v60
  v_exp_f32 v61, v61
  v_exp_f32 v62, v62
  v_exp_f32 v63, v63
  v_cvt_pk_bf16_f32 v90, v60, v61
  v_cvt_pk_bf16_f32 v91, v62, v63
  v_mfma_f32_32x32x16_bf16 v[40:55], v[124:127], v[96:99], v[40:55]
  ds_read_b128 v[108:111], v12 offset:28160
  ds_read_b64 v[114:115], v13 offset:29184
  v_exp_f32 v64, v64
  v_exp_f32 v65, v65
  v_exp_f32 v66, v66
  v_exp_f32 v67, v67
  v_cvt_pk_bf16_f32 v92, v64, v65
  v_cvt_pk_bf16_f32 v93, v66, v67
  v_mfma_f32_32x32x16_bf16 v[40:55], v[128:131], v[100:103], v[40:55]
  v_exp_f32 v68, v68
  v_exp_f32 v69, v69
  v_exp_f32 v70, v70
  v_exp_f32 v71, v71
  s_mov_b64 exec, s[80:81]
  ds_read_b128 v[124:127], v14 offset:24320
  ds_read_b128 v[128:131], v14 offset:24960
  s_mov_b64 exec, -1
  v_cvt_pk_bf16_f32 v94, v68, v69
  v_cvt_pk_bf16_f32 v95, v70, v71
  s_waitcnt lgkmcnt(4)
  v_mfma_f32_32x32x8_bf16 v[56:71], v[112:113], v[20:21], v[24:39]
  v_exp_f32 v72, v72
  v_exp_f32 v73, v73
  v_exp_f32 v74, v74
  v_exp_f32 v75, v75
  v_cvt_pk_bf16_f32 v96, v72, v73
  v_cvt_pk_bf16_f32 v97, v74, v75
  v_mfma_f32_32x32x16_bf16 v[56:71], v[104:107], v[16:19], v[56:71]
  v_exp_f32 v76, v76
  v_exp_f32 v77, v77
  v_exp_f32 v78, v78
  v_exp_f32 v79, v79
  v_cvt_pk_bf16_f32 v98, v76, v77
  v_cvt_pk_bf16_f32 v99, v78, v79
  v_mfma_f32_32x32x16_bf16 v[40:55], v[116:119], v[88:91], v[40:55]
  ds_read_b128 v[104:107], v12 offset:30720
  ds_read_b64 v[112:113], v13 offset:31744
  v_exp_f32 v80, v80
  v_exp_f32 v81, v81
  v_exp_f32 v82, v82
  v_exp_f32 v83, v83
  v_cvt_pk_bf16_f32 v100, v80, v81
  v_cvt_pk_bf16_f32 v101, v82, v83
  v_mfma_f32_32x32x16_bf16 v[40:55], v[120:123], v[92:95], v[40:55]
  v_exp_f32 v84, v84
  v_exp_f32 v85, v85
  v_exp_f32 v86, v86
  v_exp_f32 v87, v87
  s_mov_b64 exec, s[80:81]
  ds_read_b128 v[116:119], v14 offset:26880
  ds_read_b128 v[120:123], v14 offset:27520
  s_mov_b64 exec, -1
  v_cvt_pk_bf16_f32 v102, v84, v85
  v_cvt_pk_bf16_f32 v103, v86, v87
  s_setprio 0
  s_waitcnt lgkmcnt(4)
  v_mfma_f32_32x32x8_bf16 v[72:87], v[114:115], v[20:21], v[24:39]
  v_lshlrev_b32 v23, 7, v0
  v_add_u32 v23, 40960, v23
  buffer_load_dword v22, v23, s[28:31], 0 offen sc1
  v_exp_f32 v56, v56
  v_exp_f32 v57, v57
  v_exp_f32 v58, v58
  v_exp_f32 v59, v59
  v_cvt_pk_bf16_f32 v88, v56, v57
  v_cvt_pk_bf16_f32 v89, v58, v59
  v_mfma_f32_32x32x16_bf16 v[72:87], v[108:111], v[16:19], v[72:87]
  v_exp_f32 v60, v60
  v_exp_f32 v61, v61
  v_exp_f32 v62, v62
  v_exp_f32 v63, v63
  v_cvt_pk_bf16_f32 v90, v60, v61
  v_cvt_pk_bf16_f32 v91, v62, v63
  v_mfma_f32_32x32x16_bf16 v[40:55], v[124:127], v[96:99], v[40:55]
  ds_read_b128 v[108:111], v12 offset:33280
  ds_read_b64 v[114:115], v13 offset:34304
  v_exp_f32 v64, v64
  v_exp_f32 v65, v65
  v_exp_f32 v66, v66
  v_exp_f32 v67, v67
  v_cvt_pk_bf16_f32 v92, v64, v65
  v_cvt_pk_bf16_f32 v93, v66, v67
  v_mfma_f32_32x32x16_bf16 v[40:55], v[128:131], v[100:103], v[40:55]
  v_exp_f32 v68, v68
  v_exp_f32 v69, v69
  v_exp_f32 v70, v70
  v_exp_f32 v71, v71
  s_mov_b64 exec, s[80:81]
  ds_read_b128 v[124:127], v14 offset:29440
  ds_read_b128 v[128:131], v14 offset:30080
  s_mov_b64 exec, -1
  v_cvt_pk_bf16_f32 v94, v68, v69
  v_cvt_pk_bf16_f32 v95, v70, v71
  s_waitcnt lgkmcnt(4)
  v_mfma_f32_32x32x8_bf16 v[56:71], v[112:113], v[20:21], v[24:39]
  v_exp_f32 v72, v72
  v_exp_f32 v73, v73
  v_exp_f32 v74, v74
  v_exp_f32 v75, v75
  v_cvt_pk_bf16_f32 v96, v72, v73
  v_cvt_pk_bf16_f32 v97, v74, v75
  v_mfma_f32_32x32x16_bf16 v[56:71], v[104:107], v[16:19], v[56:71]
  v_exp_f32 v76, v76
  v_exp_f32 v77, v77
  v_exp_f32 v78, v78
  v_exp_f32 v79, v79
  v_cvt_pk_bf16_f32 v98, v76, v77
  v_cvt_pk_bf16_f32 v99, v78, v79
  v_mfma_f32_32x32x16_bf16 v[40:55], v[116:119], v[88:91], v[40:55]
  ds_read_b128 v[104:107], v12 offset:35840
  ds_read_b64 v[112:113], v13 offset:36864
  v_exp_f32 v80, v80
  v_exp_f32 v81, v81
  v_exp_f32 v82, v82
  v_exp_f32 v83, v83
  v_cvt_pk_bf16_f32 v100, v80, v81
  v_cvt_pk_bf16_f32 v101, v82, v83
  v_mfma_f32_32x32x16_bf16 v[40:55], v[120:123], v[92:95], v[40:55]
  v_exp_f32 v84, v84
  v_exp_f32 v85, v85
  v_exp_f32 v86, v86
  v_exp_f32 v87, v87
  s_mov_b64 exec, s[80:81]
  ds_read_b128 v[116:119], v14 offset:32000
  ds_read_b128 v[120:123], v14 offset:32640
  s_mov_b64 exec, -1
  v_cvt_pk_bf16_f32 v102, v84, v85
  v_cvt_pk_bf16_f32 v103, v86, v87
  s_waitcnt lgkmcnt(0)
  v_mfma_f32_32x32x16_bf16 v[40:55], v[124:127], v[96:99], v[40:55]
  v_mfma_f32_32x32x16_bf16 v[40:55], v[128:131], v[100:103], v[40:55]
  s_load_dwordx2 s[4:5], s[0:1], 0
  s_load_dwordx2 s[64:65], s[0:1], 64
  v_mov_b32 v7, 1
  s_nop 8
  v_mov_b32 v3, v48
  v_mov_b32 v4, v48
  s_nop 1
  v_permlane32_swap_b32 v3, v4
  v_cmp_nle_f32 vcc, 0x2b800000, v4
  s_cbranch_vccnz k2_fallback
k2_final:
  v_rcp_f32 v4, v4
  s_nop 0
  v_mul_f32 v40, v40, v4
  v_mul_f32 v41, v41, v4
  v_mul_f32 v42, v42, v4
  v_mul_f32 v43, v43, v4
  v_cvt_pk_bf16_f32 v88, v40, v41
  v_cvt_pk_bf16_f32 v89, v42, v43
  s_waitcnt vmcnt(0)
  v_cmp_gt_u32 vcc, 16, v22
  s_cbranch_vccnz k2_fwait
k2_fok:
  v_min_u32 v88, -2, v88
  v_min_u32 v89, -2, v89
  v_mul_f32 v44, v44, v4
  v_mul_f32 v45, v45, v4
  v_mul_f32 v46, v46, v4
  v_mul_f32 v47, v47, v4
  v_cvt_pk_bf16_f32 v90, v44, v45
  v_cvt_pk_bf16_f32 v91, v46, v47
  v_min_u32 v90, -2, v90
  v_min_u32 v91, -2, v91
  buffer_store_dwordx4 v[88:91], v133, s[16:19], s75 offen sc1
  v_mul_f32 v48, v48, v4
  v_mul_f32 v49, v49, v4
  v_mul_f32 v50, v50, v4
  v_mul_f32 v51, v51, v4
  v_cvt_pk_bf16_f32 v92, v48, v49
  v_cvt_pk_bf16_f32 v93, v50, v51
  v_min_u32 v92, -2, v92
  v_min_u32 v93, -2, v93
  s_mov_b64 exec, 0xffffffff
  buffer_store_dwordx2 v[92:93], v134, s[16:19], s75 offen sc1
  s_mov_b32 s50, s77
  s_waitcnt lgkmcnt(0)
  s_mov_b64 exec, -1
  s_barrier
  s_and_b32 s41, s3, 7
  s_lshr_b32 s42, s3, 3
  s_and_b32 s40, s66, 3
  v_lshlrev_b32 v9, 4, v0
  s_lshr_b32 s47, s42, 3
  s_lshl_b32 s49, s47, 1
  s_and_b32 s45, s42, 1
  s_add_u32 s49, s49, s45
  s_and_b32 s67, s41, 1
  s_lshr_b32 s41, s41, 1
  s_and_b32 s68, s42, 7
  s_add_u32 s68, s68, s47
  s_and_b32 s70, s68, 3
  s_mul_i32 s70, s70, 0
  s_mul_i32 s43, s68, 52
  s_lshr_b32 s43, s43, 8
  s_mul_i32 s43, s43, 5
  s_sub_u32 s68, s68, s43
  s_mul_i32 s68, s68, 0
  s_bfe_u32 s69, s42, 0x20001
  s_add_u32 s69, s69, s49
  s_mul_i32 s43, s69, 52
  s_lshr_b32 s43, s43, 8
  s_mul_i32 s43, s43, 5
  s_sub_u32 s69, s69, s43
  s_mul_i32 s69, s69, 0
  s_cmp_lt_u32 s66, 4
  s_cbranch_scc1 kp_load
  s_lshl_b32 s45, s67, 2
  s_add_u32 s47, s47, s45
  s_lshl_b32 s45, s67, 3
  s_add_u32 s49, s49, s45
  s_lshl_b32 s46, s41, 3
  s_and_b32 s45, s42, 7
  s_add_u32 s46, s46, s45
  s_lshl_b32 s46, s46, 2
  s_add_u32 s46, s46, s40
  s_lshl_b32 s48, s41, 2
  s_bfe_u32 s45, s42, 0x20001
  s_add_u32 s48, s48, s45
  s_lshl_b32 s48, s48, 2
  s_add_u32 s48, s48, s40
  s_lshl_b32 s48, s48, 1
  v_and_b32 v10, 15, v0
  v_lshrrev_b32 v11, 4, v0
  s_add_u32 s8, s6, 0x800000
  s_addc_u32 s9, s7, 0
  s_mov_b32 s10, 0x280000
  s_mov_b32 s11, 0x00020000
  s_mul_i32 s58, s46, 20480
  s_add_u32 s36, s6, 0x2540000
  s_addc_u32 s37, s7, 0
  s_mov_b32 s38, 0x40000
  s_mov_b32 s39, 0x00020000
  v_lshrrev_b32 v1, 1, v11
  v_lshlrev_b32 v12, 8, v1
  v_and_b32 v1, 1, v11
  v_lshl_add_u32 v12, v1, 3, v12
  v_lshl_add_u32 v13, v10, 4, v12
  v_lshlrev_b32 v47, 9, v1
  v_lshrrev_b32 v1, 1, v11
  v_lshl_add_u32 v47, v1, 8, v47
  v_lshl_add_u32 v48, v10, 4, v47
  v_add_u32 v18, 65536, v9
  v_add_u32 v19, 131072, v9
  v_lshlrev_b32 v16, 3, v10
  v_lshl_add_u32 v15, v11, 8, v16
  v_mov_b32 v17, 1
  s_mov_b32 s52, 0x3f803f80
  s_mul_i32 s57, s46, 20480
  s_mul_i32 s44, s47, 160
  s_add_u32 s55, s57, s44
  s_mul_i32 s44, s47, 2560
  s_add_u32 s57, s57, s44
  s_mul_i32 s59, s40, 3072
  s_add_u32 s59, s59, 151552
  v_mul_u32_u24 v14, 160, v10
  v_lshl_add_u32 v14, v11, 3, v14
  v_add_u32 v14, s59, v14
  v_add_u32 v1, 0, v0
  v_mul_u32_u24 v2, 6554, v1
  v_lshrrev_b32 v2, 16, v2
  v_mul_u32_u24 v3, 10, v2
  v_sub_u32 v3, v1, v3
  v_mul_u32_u24 v2, 1280, v2
  v_lshl_add_u32 v20, v3, 4, v2
  v_add_u32 v1, 64, v0
  v_mul_u32_u24 v2, 6554, v1
  v_lshrrev_b32 v2, 16, v2
  v_mul_u32_u24 v3, 10, v2
  v_sub_u32 v3, v1, v3
  v_mul_u32_u24 v2, 1280, v2
  v_lshl_add_u32 v21, v3, 4, v2
  v_add_u32 v1, 128, v0
  v_mul_u32_u24 v2, 6554, v1
  v_lshrrev_b32 v2, 16, v2
  v_mul_u32_u24 v3, 10, v2
  v_sub_u32 v3, v1, v3
  v_mul_u32_u24 v2, 1280, v2
  v_lshl_add_u32 v22, v3, 4, v2
  s_lshr_b32 s43, s46, 4
  s_lshl_b32 s43, s43, 7
  s_add_u32 s43, s43, 32768
  v_and_b32 v1, 31, v0
  v_lshl_add_u32 v45, v1, 2, s43
  s_add_u32 s16, s6, 0xa80000
  s_addc_u32 s17, s7, 0
  s_mov_b32 s18, 0x280000
  s_mov_b32 s19, 0x00020000
  s_add_u32 s32, s6, 0xf80000
  s_addc_u32 s33, s7, 0
  s_mov_b32 s34, 0x20000
  s_mov_b32 s35, 0x00020000
  s_lshl_b32 s53, s46, 10
  s_lshl_b32 s44, s47, 7
  s_add_u32 s53, s53, s44
  s_lshl_b32 s61, s46, 6
  s_lshl_b32 s44, s47, 2
  s_add_u32 s61, s61, s44
  s_add_u32 s61, s61, 0
  s_mov_b32 s20, s4
  s_mov_b32 s21, s5
  s_mov_b32 s22, 0x280000
  s_mov_b32 s23, 0x00020000
  s_add_u32 m0, s59, 0
  s_nop 0
  buffer_load_dwordx4 v20, s[20:23], s55 offen lds
  s_add_u32 m0, s59, 1024
  s_nop 0
  buffer_load_dwordx4 v21, s[20:23], s55 offen lds
  s_add_u32 m0, s59, 2048
  s_nop 0
  buffer_load_dwordx4 v22, s[20:23], s55 offen lds
  v_lshlrev_b32 v44, 6, v0
  v_add_u32 v44, 16384, v44
  s_mov_b32 s60, 400000
  s_waitcnt vmcnt(0)
kp_probe0:
  s_sub_u32 s60, s60, 1
  s_cbranch_scc1 kp_end
  buffer_load_dword v46, v44, s[8:11], s58 offen sc1
  s_lshl_b32 s71, s68, 10
  s_add_u32 s62, s58, s71
  buffer_load_dwordx4 v[52:55], v9, s[8:11], s62 offen offset:0 sc1
  buffer_load_dwordx4 v[56:59], v9, s[8:11], s62 offen offset:1024 sc1
  buffer_load_dwordx4 v[60:63], v9, s[8:11], s62 offen offset:2048 sc1
  buffer_load_dwordx4 v[64:67], v9, s[8:11], s62 offen offset:3072 sc1
  s_waitcnt vmcnt(4)
  v_cmp_eq_u32 vcc, -1, v46
  s_cbranch_vccnz kp_probe0
kp_go0:
  s_add_u32 s71, s71, 4096
  s_cmp_ge_u32 s71, 20480
  s_cselect_b32 s71, 0, s71
  s_add_u32 s62, s58, s71
  buffer_load_dwordx4 v[68:71], v9, s[8:11], s62 offen offset:0 sc1
  buffer_load_dwordx4 v[72:75], v9, s[8:11], s62 offen offset:1024 sc1
  buffer_load_dwordx4 v[76:79], v9, s[8:11], s62 offen offset:2048 sc1
  buffer_load_dwordx4 v[80:83], v9, s[8:11], s62 offen offset:3072 sc1
  s_add_u32 s71, s71, 4096
  s_cmp_ge_u32 s71, 20480
  s_cselect_b32 s71, 0, s71
  s_add_u32 s62, s58, s71
  buffer_load_dwordx4 v[84:87], v9, s[8:11], s62 offen offset:0 sc1
  buffer_load_dwordx4 v[88:91], v9, s[8:11], s62 offen offset:1024 sc1
  buffer_load_dwordx4 v[92:95], v9, s[8:11], s62 offen offset:2048 sc1
  buffer_load_dwordx4 v[96:99], v9, s[8:11], s62 offen offset:3072 sc1
  s_waitcnt vmcnt(8)
  v_max3_u32 v46, v52, v53, v54
  v_max3_u32 v46, v46, v55, v56
  v_max3_u32 v46, v46, v57, v58
  v_max3_u32 v46, v46, v59, v60
  v_max3_u32 v46, v46, v61, v62
  v_max3_u32 v46, v46, v63, v64
  v_max3_u32 v46, v46, v65, v66
  v_max_u32 v46, v46, v67
  v_cmp_eq_u32 vcc, -1, v46
  s_cbranch_vccnz kp_probe0
  s_barrier
  ds_read_b128 v[152:155], v18 offset:36864
  ds_read_b128 v[156:159], v18 offset:37888
  ds_read_b128 v[160:163], v18 offset:38912
  ds_read_b128 v[164:167], v18 offset:39936
  ds_read_b128 v[168:171], v18 offset:40960
  ds_read_b128 v[172:175], v18 offset:41984
  ds_read_b128 v[176:179], v18 offset:43008
  ds_read_b128 v[180:183], v18 offset:44032
  ds_read_b128 v[184:187], v18 offset:45056
  ds_read_b128 v[188:191], v18 offset:46080
  s_waitcnt lgkmcnt(5)
  v_mfma_f32_16x16x32_bf16 v[132:135], v[152:155], v[52:55], 0
  ds_read_b128 v[192:195], v18 offset:47104
  v_mfma_f32_16x16x32_bf16 v[136:139], v[156:159], v[52:55], 0
  s_add_u32 s71, s71, 4096
  s_cmp_ge_u32 s71, 20480
  s_cselect_b32 s71, 0, s71
  s_add_u32 s62, s58, s71
  buffer_load_dwordx4 v[100:103], v9, s[8:11], s62 offen offset:0 sc1
  ds_read_b128 v[196:199], v18 offset:48128
  v_mfma_f32_16x16x32_bf16 v[140:143], v[160:163], v[52:55], 0
  ds_read_b128 v[200:203], v18 offset:49152
  v_mfma_f32_16x16x32_bf16 v[144:147], v[164:167], v[52:55], 0
  buffer_load_dwordx4 v[104:107], v9, s[8:11], s62 offen offset:1024 sc1
  ds_read_b128 v[204:207], v18 offset:50176
  v_mfma_f32_16x16x32_bf16 v[148:151], v[168:171], v[52:55], 0
  ds_read_b128 v[208:211], v18 offset:51200
  s_waitcnt lgkmcnt(5)
  v_mfma_f32_16x16x32_bf16 v[132:135], v[172:175], v[56:59], v[132:135]
  buffer_load_dwordx4 v[108:111], v9, s[8:11], s62 offen offset:2048 sc1
  ds_read_b128 v[152:155], v18 offset:52224
  v_mfma_f32_16x16x32_bf16 v[136:139], v[176:179], v[56:59], v[136:139]
  ds_read_b128 v[156:159], v18 offset:53248
  v_mfma_f32_16x16x32_bf16 v[140:143], v[180:183], v[56:59], v[140:143]
  buffer_load_dwordx4 v[112:115], v9, s[8:11], s62 offen offset:3072 sc1
  ds_read_b128 v[160:163], v18 offset:54272
  v_mfma_f32_16x16x32_bf16 v[144:147], v[184:187], v[56:59], v[144:147]
  ds_read_b128 v[164:167], v18 offset:55296
  v_mfma_f32_16x16x32_bf16 v[148:151], v[188:191], v[56:59], v[148:151]
  s_add_u32 s71, s71, 4096
  s_cmp_ge_u32 s71, 20480
  s_cselect_b32 s71, 0, s71
  s_add_u32 s62, s58, s71
  buffer_load_dwordx2 v[116:117], v15, s[8:11], s62 offen offset:0 sc1
  ds_read_b128 v[168:171], v18 offset:56320
  s_waitcnt lgkmcnt(5)
  v_mfma_f32_16x16x32_bf16 v[132:135], v[192:195], v[60:63], v[132:135]
  ds_read_b128 v[172:175], v9 offset:0
  v_mfma_f32_16x16x32_bf16 v[136:139], v[196:199], v[60:63], v[136:139]
  buffer_load_dwordx2 v[118:119], v15, s[8:11], s62 offen offset:128 sc1
  ds_read_b128 v[176:179], v9 offset:1024
  v_mfma_f32_16x16x32_bf16 v[140:143], v[200:203], v[60:63], v[140:143]
  ds_read_b128 v[180:183], v9 offset:2048
  v_mfma_f32_16x16x32_bf16 v[144:147], v[204:207], v[60:63], v[144:147]
  buffer_load_dwordx2 v[120:121], v15, s[8:11], s62 offen offset:1024 sc1
  ds_read_b128 v[184:187], v9 offset:3072
  v_mfma_f32_16x16x32_bf16 v[148:151], v[208:211], v[60:63], v[148:151]
  ds_read_b128 v[188:191], v9 offset:4096
  s_waitcnt lgkmcnt(5)
  v_mfma_f32_16x16x32_bf16 v[132:135], v[152:155], v[64:67], v[132:135]
  buffer_load_dwordx2 v[122:123], v15, s[8:11], s62 offen offset:1152 sc1
  ds_read_b128 v[192:195], v9 offset:5120
  v_mfma_f32_16x16x32_bf16 v[136:139], v[156:159], v[64:67], v[136:139]
  ds_read_b128 v[196:199], v9 offset:6144
  v_mfma_f32_16x16x32_bf16 v[140:143], v[160:163], v[64:67], v[140:143]
  buffer_load_dwordx2 v[124:125], v15, s[8:11], s62 offen offset:2048 sc1
  ds_read_b128 v[200:203], v9 offset:7168
  v_mfma_f32_16x16x32_bf16 v[144:147], v[164:167], v[64:67], v[144:147]
  ds_read_b128 v[204:207], v9 offset:8192
  v_mfma_f32_16x16x32_bf16 v[148:151], v[168:171], v[64:67], v[148:151]
  buffer_load_dwordx2 v[126:127], v15, s[8:11], s62 offen offset:2176 sc1
  ds_read_b128 v[208:211], v9 offset:9216
  s_waitcnt vmcnt(16)
  s_waitcnt lgkmcnt(5)
  v_mfma_f32_16x16x32_bf16 v[132:135], v[172:175], v[68:71], v[132:135]
  ds_read_b128 v[152:155], v9 offset:10240
  v_mfma_f32_16x16x32_bf16 v[136:139], v[176:179], v[68:71], v[136:139]
  buffer_load_dwordx2 v[128:129], v15, s[8:11], s62 offen offset:3072 sc1
  ds_read_b128 v[156:159], v9 offset:11264
  v_mfma_f32_16x16x32_bf16 v[140:143], v[180:183], v[68:71], v[140:143]
  ds_read_b128 v[160:163], v9 offset:12288
  v_mfma_f32_16x16x32_bf16 v[144:147], v[184:187], v[68:71], v[144:147]
  buffer_load_dwordx2 v[130:131], v15, s[8:11], s62 offen offset:3200 sc1
  ds_read_b128 v[164:167], v9 offset:13312
  v_mfma_f32_16x16x32_bf16 v[148:151], v[188:191], v[68:71], v[148:151]
  ds_read_b128 v[168:171], v9 offset:14336
  s_waitcnt lgkmcnt(5)
  v_mfma_f32_16x16x32_bf16 v[132:135], v[192:195], v[72:75], v[132:135]
  ds_read_b128 v[172:175], v9 offset:15360
  v_mfma_f32_16x16x32_bf16 v[136:139], v[196:199], v[72:75], v[136:139]
  ds_read_b128 v[176:179], v9 offset:16384
  v_mfma_f32_16x16x32_bf16 v[140:143], v[200:203], v[72:75], v[140:143]
  ds_read_b128 v[180:183], v9 offset:17408
  v_mfma_f32_16x16x32_bf16 v[144:147], v[204:207], v[72:75], v[144:147]
  ds_read_b128 v[184:187], v9 offset:18432
  v_mfma_f32_16x16x32_bf16 v[148:151], v[208:211], v[72:75], v[148:151]
  ds_read_b128 v[188:191], v9 offset:19456
  s_waitcnt vmcnt(16)
  s_waitcnt lgkmcnt(5)
  v_mfma_f32_16x16x32_bf16 v[132:135], v[152:155], v[76:79], v[132:135]
  s_barrier
  ds_read_b128 v[192:195], v9 offset:20480
  v_mfma_f32_16x16x32_bf16 v[136:139], v[156:159], v[76:79], v[136:139]
  ds_read_b128 v[196:199], v9 offset:21504
  v_mfma_f32_16x16x32_bf16 v[140:143], v[160:163], v[76:79], v[140:143]
  ds_read_b128 v[200:203], v9 offset:22528
  v_mfma_f32_16x16x32_bf16 v[144:147], v[164:167], v[76:79], v[144:147]
  ds_read_b128 v[204:207], v9 offset:23552
  v_mfma_f32_16x16x32_bf16 v[148:151], v[168:171], v[76:79], v[148:151]
  ds_read_b128 v[208:211], v9 offset:24576
  s_waitcnt lgkmcnt(5)
  v_mfma_f32_16x16x32_bf16 v[132:135], v[172:175], v[80:83], v[132:135]
  ds_read_b128 v[152:155], v9 offset:25600
  v_mfma_f32_16x16x32_bf16 v[136:139], v[176:179], v[80:83], v[136:139]
  ds_read_b128 v[156:159], v9 offset:26624
  v_mfma_f32_16x16x32_bf16 v[140:143], v[180:183], v[80:83], v[140:143]
  ds_read_b128 v[160:163], v9 offset:27648
  v_mfma_f32_16x16x32_bf16 v[144:147], v[184:187], v[80:83], v[144:147]
  ds_read_b128 v[164:167], v9 offset:28672
  v_mfma_f32_16x16x32_bf16 v[148:151], v[188:191], v[80:83], v[148:151]
  ds_read_b128 v[168:171], v9 offset:29696
  s_waitcnt vmcnt(14)
  s_waitcnt lgkmcnt(5)
  v_mfma_f32_16x16x32_bf16 v[132:135], v[192:195], v[84:87], v[132:135]
  ds_read_b128 v[172:175], v9 offset:30720
  v_mfma_f32_16x16x32_bf16 v[136:139], v[196:199], v[84:87], v[136:139]
  ds_read_b128 v[176:179], v9 offset:31744
  v_mfma_f32_16x16x32_bf16 v[140:143], v[200:203], v[84:87], v[140:143]
  ds_read_b128 v[180:183], v9 offset:32768
  v_mfma_f32_16x16x32_bf16 v[144:147], v[204:207], v[84:87], v[144:147]
  ds_read_b128 v[184:187], v9 offset:33792
  v_mfma_f32_16x16x32_bf16 v[148:151], v[208:211], v[84:87], v[148:151]
  ds_read_b128 v[188:191], v9 offset:34816
  s_waitcnt lgkmcnt(5)
  v_mfma_f32_16x16x32_bf16 v[132:135], v[152:155], v[88:91], v[132:135]
  ds_read_b128 v[192:195], v9 offset:35840
  v_mfma_f32_16x16x32_bf16 v[136:139], v[156:159], v[88:91], v[136:139]
  ds_read_b128 v[196:199], v9 offset:36864
  v_mfma_f32_16x16x32_bf16 v[140:143], v[160:163], v[88:91], v[140:143]
  ds_read_b128 v[200:203], v9 offset:37888
  v_mfma_f32_16x16x32_bf16 v[144:147], v[164:167], v[88:91], v[144:147]
  ds_read_b128 v[204:207], v9 offset:38912
  v_mfma_f32_16x16x32_bf16 v[148:151], v[168:171], v[88:91], v[148:151]
  ds_read_b128 v[208:211], v9 offset:39936
  s_waitcnt vmcnt(12)
  s_waitcnt lgkmcnt(5)
  v_mfma_f32_16x16x32_bf16 v[132:135], v[172:175], v[92:95], v[132:135]
  ds_read_b128 v[152:155], v9 offset:40960
  v_mfma_f32_16x16x32_bf16 v[136:139], v[176:179], v[92:95], v[136:139]
  ds_read_b128 v[156:159], v9 offset:41984
  v_mfma_f32_16x16x32_bf16 v[140:143], v[180:183], v[92:95], v[140:143]
  ds_read_b128 v[160:163], v9 offset:43008
  v_mfma_f32_16x16x32_bf16 v[144:147], v[184:187], v[92:95], v[144:147]
  ds_read_b128 v[164:167], v9 offset:44032
  v_mfma_f32_16x16x32_bf16 v[148:151], v[188:191], v[92:95], v[148:151]
  ds_read_b128 v[168:171], v9 offset:45056
  s_waitcnt lgkmcnt(5)
  v_mfma_f32_16x16x32_bf16 v[132:135], v[192:195], v[96:99], v[132:135]
  ds_read_b128 v[172:175], v9 offset:46080
  v_mfma_f32_16x16x32_bf16 v[136:139], v[196:199], v[96:99], v[136:139]
  ds_read_b128 v[176:179], v9 offset:47104
  v_mfma_f32_16x16x32_bf16 v[140:143], v[200:203], v[96:99], v[140:143]
  ds_read_b128 v[180:183], v9 offset:48128
  v_mfma_f32_16x16x32_bf16 v[144:147], v[204:207], v[96:99], v[144:147]
  ds_read_b128 v[184:187], v9 offset:49152
  v_mfma_f32_16x16x32_bf16 v[148:151], v[208:211], v[96:99], v[148:151]
  ds_read_b128 v[188:191], v9 offset:50176
  s_waitcnt vmcnt(10)
  s_waitcnt lgkmcnt(5)
  v_mfma_f32_16x16x32_bf16 v[132:135], v[152:155], v[100:103], v[132:135]
  ds_read_b128 v[192:195], v9 offset:51200
  v_mfma_f32_16x16x32_bf16 v[136:139], v[156:159], v[100:103], v[136:139]
  ds_read_b128 v[196:199], v9 offset:52224
  v_mfma_f32_16x16x32_bf16 v[140:143], v[160:163], v[100:103], v[140:143]
  ds_read_b128 v[200:203], v9 offset:53248
  v_mfma_f32_16x16x32_bf16 v[144:147], v[164:167], v[100:103], v[144:147]
  ds_read_b128 v[204:207], v9 offset:54272
  v_mfma_f32_16x16x32_bf16 v[148:151], v[168:171], v[100:103], v[148:151]
  ds_read_b128 v[208:211], v9 offset:55296
  s_waitcnt lgkmcnt(5)
  v_mfma_f32_16x16x32_bf16 v[132:135], v[172:175], v[104:107], v[132:135]
  ds_read_b128 v[152:155], v9 offset:56320
  v_mfma_f32_16x16x32_bf16 v[136:139], v[176:179], v[104:107], v[136:139]
  ds_read_b128 v[156:159], v9 offset:57344
  v_mfma_f32_16x16x32_bf16 v[140:143], v[180:183], v[104:107], v[140:143]
  ds_read_b128 v[160:163], v9 offset:58368
  v_mfma_f32_16x16x32_bf16 v[144:147], v[184:187], v[104:107], v[144:147]
  ds_read_b128 v[164:167], v9 offset:59392
  v_mfma_f32_16x16x32_bf16 v[148:151], v[188:191], v[104:107], v[148:151]
  ds_read_b128 v[168:171], v9 offset:60416
  s_waitcnt vmcnt(8)
  s_waitcnt lgkmcnt(5)
  v_mfma_f32_16x16x32_bf16 v[132:135], v[192:195], v[108:111], v[132:135]
  s_barrier
  ds_read_b128 v[172:175], v9 offset:61440
  v_mfma_f32_16x16x32_bf16 v[136:139], v[196:199], v[108:111], v[136:139]
  ds_read_b128 v[176:179], v9 offset:62464
  v_mfma_f32_16x16x32_bf16 v[140:143], v[200:203], v[108:111], v[140:143]
  ds_read_b128 v[180:183], v9 offset:63488
  v_mfma_f32_16x16x32_bf16 v[144:147], v[204:207], v[108:111], v[144:147]
  ds_read_b128 v[184:187], v9 offset:64512
  v_mfma_f32_16x16x32_bf16 v[148:151], v[208:211], v[108:111], v[148:151]
  ds_read_b128 v[188:191], v18 offset:0
  s_waitcnt lgkmcnt(5)
  v_mfma_f32_16x16x32_bf16 v[132:135], v[152:155], v[112:115], v[132:135]
  ds_read_b128 v[192:195], v18 offset:1024
  v_mfma_f32_16x16x32_bf16 v[136:139], v[156:159], v[112:115], v[136:139]
  ds_read_b128 v[196:199], v18 offset:2048
  v_mfma_f32_16x16x32_bf16 v[140:143], v[160:163], v[112:115], v[140:143]
  ds_read_b128 v[200:203], v18 offset:3072
  v_mfma_f32_16x16x32_bf16 v[144:147], v[164:167], v[112:115], v[144:147]
  ds_read_b128 v[204:207], v18 offset:4096
  v_mfma_f32_16x16x32_bf16 v[148:151], v[168:171], v[112:115], v[148:151]
  ds_read_b128 v[208:211], v18 offset:5120
  s_waitcnt vmcnt(4)
  s_waitcnt lgkmcnt(5)
  v_mfma_f32_16x16x32_bf16 v[132:135], v[172:175], v[116:119], v[132:135]
  ds_read_b128 v[152:155], v18 offset:6144
  v_mfma_f32_16x16x32_bf16 v[136:139], v[176:179], v[116:119], v[136:139]
  ds_read_b128 v[156:159], v18 offset:7168
  v_mfma_f32_16x16x32_bf16 v[140:143], v[180:183], v[116:119], v[140:143]
  ds_read_b128 v[160:163], v18 offset:8192
  v_mfma_f32_16x16x32_bf16 v[144:147], v[184:187], v[116:119], v[144:147]
  ds_read_b128 v[164:167], v18 offset:9216
  v_mfma_f32_16x16x32_bf16 v[148:151], v[188:191], v[116:119], v[148:151]
  ds_read_b128 v[168:171], v18 offset:10240
  s_waitcnt lgkmcnt(5)
  v_mfma_f32_16x16x32_bf16 v[132:135], v[192:195], v[120:123], v[132:135]
  ds_read_b128 v[172:175], v18 offset:11264
  v_mfma_f32_16x16x32_bf16 v[136:139], v[196:199], v[120:123], v[136:139]
  ds_read_b128 v[176:179], v18 offset:12288
  v_mfma_f32_16x16x32_bf16 v[140:143], v[200:203], v[120:123], v[140:143]
  ds_read_b128 v[180:183], v18 offset:13312
  v_mfma_f32_16x16x32_bf16 v[144:147], v[204:207], v[120:123], v[144:147]
  ds_read_b128 v[184:187], v18 offset:14336
  v_mfma_f32_16x16x32_bf16 v[148:151], v[208:211], v[120:123], v[148:151]
  ds_read_b128 v[188:191], v18 offset:15360
  s_waitcnt vmcnt(0)
  s_waitcnt lgkmcnt(5)
  v_mfma_f32_16x16x32_bf16 v[132:135], v[152:155], v[124:127], v[132:135]
  v_mfma_f32_16x16x32_bf16 v[136:139], v[156:159], v[124:127], v[136:139]
  v_mfma_f32_16x16x32_bf16 v[140:143], v[160:163], v[124:127], v[140:143]
  v_mfma_f32_16x16x32_bf16 v[144:147], v[164:167], v[124:127], v[144:147]
  v_mfma_f32_16x16x32_bf16 v[148:151], v[168:171], v[124:127], v[148:151]
  s_waitcnt lgkmcnt(0)
  v_mfma_f32_16x16x32_bf16 v[132:135], v[172:175], v[128:131], v[132:135]
  ds_read_b64 v[34:35], v14 offset:0
  v_mfma_f32_16x16x32_bf16 v[136:139], v[176:179], v[128:131], v[136:139]
  ds_read_b64 v[36:37], v14 offset:32
  v_mfma_f32_16x16x32_bf16 v[140:143], v[180:183], v[128:131], v[140:143]
  ds_read_b64 v[38:39], v14 offset:64
  v_mfma_f32_16x16x32_bf16 v[144:147], v[184:187], v[128:131], v[144:147]
  ds_read_b64 v[40:41], v14 offset:96
  v_mfma_f32_16x16x32_bf16 v[148:151], v[188:191], v[128:131], v[148:151]
  ds_read_b64 v[42:43], v14 offset:128
  v_cmp_u_f32 vcc, v132, v132
  s_cbranch_vccnz kp_redo0
kp_back0:
  s_waitcnt lgkmcnt(0)
  v_lshlrev_b32 v152, 16, v34
  v_and_b32 v153, 0xffff0000, v34
  v_lshlrev_b32 v154, 16, v35
  v_and_b32 v155, 0xffff0000, v35
  v_pk_add_f32 v[152:153], v[152:153], v[132:133]
  v_pk_add_f32 v[154:155], v[154:155], v[134:135]
  v_cvt_pk_bf16_f32 v24, v152, v153
  v_cvt_pk_bf16_f32 v25, v154, v155
  v_min_u32 v24, -2, v24
  v_min_u32 v25, -2, v25
  v_mov_b32 v52, v24
  v_mov_b32 v53, v25
  v_dot2_f32_bf16 v212, v24, s52, 0
  v_dot2_f32_bf16 v213, v24, v24, 0
  v_dot2_f32_bf16 v212, v25, s52, v212
  v_dot2_f32_bf16 v213, v25, v25, v213
  v_lshlrev_b32 v156, 16, v36
  v_and_b32 v157, 0xffff0000, v36
  v_lshlrev_b32 v158, 16, v37
  v_and_b32 v159, 0xffff0000, v37
  v_pk_add_f32 v[156:157], v[156:157], v[136:137]
  v_pk_add_f32 v[158:159], v[158:159], v[138:139]
  v_cvt_pk_bf16_f32 v26, v156, v157
  v_cvt_pk_bf16_f32 v27, v158, v159
  v_min_u32 v26, -2, v26
  v_min_u32 v27, -2, v27
  v_mov_b32 v54, v26
  v_mov_b32 v55, v27
  s_nop 0
  v_permlane16_swap_b32 v52, v54
  v_permlane16_swap_b32 v53, v55
  buffer_store_dwordx4 v[52:55], v48, s[16:19], s57 offen offset:0 sc1
  v_dot2_f32_bf16 v212, v26, s52, v212
  v_dot2_f32_bf16 v213, v26, v26, v213
  v_dot2_f32_bf16 v212, v27, s52, v212
  v_dot2_f32_bf16 v213, v27, v27, v213
  v_lshlrev_b32 v152, 16, v38
  v_and_b32 v153, 0xffff0000, v38
  v_lshlrev_b32 v154, 16, v39
  v_and_b32 v155, 0xffff0000, v39
  v_pk_add_f32 v[152:153], v[152:153], v[140:141]
  v_pk_add_f32 v[154:155], v[154:155], v[142:143]
  v_cvt_pk_bf16_f32 v28, v152, v153
  v_cvt_pk_bf16_f32 v29, v154, v155
  v_min_u32 v28, -2, v28
  v_min_u32 v29, -2, v29
  v_mov_b32 v56, v28
  v_mov_b32 v57, v29
  v_dot2_f32_bf16 v212, v28, s52, v212
  v_dot2_f32_bf16 v213, v28, v28, v213
  v_dot2_f32_bf16 v212, v29, s52, v212
  v_dot2_f32_bf16 v213, v29, v29, v213
  v_lshlrev_b32 v156, 16, v40
  v_and_b32 v157, 0xffff0000, v40
  v_lshlrev_b32 v158, 16, v41
  v_and_b32 v159, 0xffff0000, v41
  v_pk_add_f32 v[156:157], v[156:157], v[144:145]
  v_pk_add_f32 v[158:159], v[158:159], v[146:147]
  v_cvt_pk_bf16_f32 v30, v156, v157
  v_cvt_pk_bf16_f32 v31, v158, v159
  v_min_u32 v30, -2, v30
  v_min_u32 v31, -2, v31
  v_mov_b32 v58, v30
  v_mov_b32 v59, v31
  s_nop 0
  v_permlane16_swap_b32 v56, v58
  v_permlane16_swap_b32 v57, v59
  buffer_store_dwordx4 v[56:59], v48, s[16:19], s57 offen offset:1024 sc1
  v_dot2_f32_bf16 v212, v30, s52, v212
  v_dot2_f32_bf16 v213, v30, v30, v213
  v_dot2_f32_bf16 v212, v31, s52, v212
  v_dot2_f32_bf16 v213, v31, v31, v213
  v_lshlrev_b32 v152, 16, v42
  v_and_b32 v153, 0xffff0000, v42
  v_lshlrev_b32 v154, 16, v43
  v_and_b32 v155, 0xffff0000, v43
  v_pk_add_f32 v[152:153], v[152:153], v[148:149]
  v_pk_add_f32 v[154:155], v[154:155], v[150:151]
  v_cvt_pk_bf16_f32 v32, v152, v153
  v_cvt_pk_bf16_f32 v33, v154, v155
  v_min_u32 v32, -2, v32
  v_min_u32 v33, -2, v33
  buffer_store_dwordx2 v[32:33], v13, s[16:19], s57 offen offset:2048 sc1
  v_dot2_f32_bf16 v212, v32, s52, v212
  v_dot2_f32_bf16 v213, v32, v32, v213
  v_dot2_f32_bf16 v212, v33, s52, v212
  v_dot2_f32_bf16 v213, v33, v33, v213
  s_nop 1
  v_mov_b32 v1, v212
  v_mov_b32 v2, v213
  s_nop 0
  v_permlane16_swap_b32 v212, v1
  v_permlane16_swap_b32 v213, v2
  v_add_f32 v212, v212, v1
  v_add_f32 v213, v213, v2
  v_mov_b32 v1, v212
  v_mov_b32 v2, v213
  s_nop 0
  v_permlane32_swap_b32 v212, v1
  v_permlane32_swap_b32 v213, v2
  v_add_f32 v212, v212, v1
  v_add_f32 v213, v213, v2
  v_min_u32 v212, -2, v212
  v_min_u32 v213, -2, v213
  s_mov_b64 exec, 0xffff
  buffer_store_dwordx2 v[212:213], v16, s[32:35], s53 offen sc1
  s_mov_b64 exec, -1
  s_barrier
  s_add_u32 s8, s6, 0xa80000
  s_addc_u32 s9, s7, 0
  s_mov_b32 s10, 0x280000
  s_mov_b32 s11, 0x00020000
  s_mul_i32 s58, s46, 20480
  v_and_b32 v1, 7, v0
  s_lshr_b32 s43, s46, 2
  s_lshl_b32 s43, s43, 6
  s_add_u32 s43, s43, 0
  v_lshl_add_u32 v45, v1, 2, s43
  s_add_u32 s24, s6, 0xf80000
  s_addc_u32 s25, s7, 0
  s_mov_b32 s26, 0x20000
  s_mov_b32 s27, 0x00020000
  s_lshl_b32 s51, s46, 10
  v_lshlrev_b32 v216, 4, v11
  v_add_u32 v216, 143360, v216
  s_add_u32 s16, s6, 0xd00000
  s_addc_u32 s17, s7, 0
  s_mov_b32 s18, 0x280000
  s_mov_b32 s19, 0x00020000
  s_lshr_b32 s43, s47, 2
  s_add_u32 s43, s43, 1
  s_sub_u32 s44, 0, s43
  s_bitcmp1_b32 s47, 1
  s_cselect_b32 s43, s44, s43
  s_lshl_b32 s44, s46, 4
  s_add_u32 s44, s44, s43
  v_add_u32 v2, s44, v10
  v_and_b32 v3, 2047, v2
  v_cmp_eq_u32 vcc, v2, v3
  v_lshrrev_b32 v4, 4, v3
  v_mul_u32_u24 v4, 20480, v4
  v_and_b32 v3, 15, v3
  v_lshl_add_u32 v4, v3, 4, v4
  v_add_u32 v248, v4, v12
  v_add_u32 v250, v4, v47
  v_cndmask_b32_e64 v249, 0, -2, vcc
  s_mul_i32 s53, s47, 2560
  s_lshl_b32 s61, s46, 6
  s_lshl_b32 s44, s47, 2
  s_add_u32 s61, s61, s44
  s_add_u32 s61, s61, 8192
  s_mov_b32 s60, 400000
  s_waitcnt vmcnt(0)
kp_probe1:
  s_sub_u32 s60, s60, 1
  s_cbranch_scc1 kp_end
  buffer_load_dwordx2 v[212:213], v15, s[24:27], s51 offen offset:0 sc1
  buffer_load_dwordx2 v[214:215], v15, s[24:27], s51 offen offset:128 sc1
  s_lshl_b32 s71, s68, 10
  s_add_u32 s62, s58, s71
  buffer_load_dwordx4 v[52:55], v9, s[8:11], s62 offen offset:0 sc1
  buffer_load_dwordx4 v[56:59], v9, s[8:11], s62 offen offset:1024 sc1
  buffer_load_dwordx4 v[60:63], v9, s[8:11], s62 offen offset:2048 sc1
  buffer_load_dwordx4 v[64:67], v9, s[8:11], s62 offen offset:3072 sc1
  s_waitcnt vmcnt(4)
  v_max3_u32 v46, v212, v213, v214
  v_max_u32 v46, v46, v215
  v_cmp_eq_u32 vcc, -1, v46
  s_cbranch_vccnz kp_probe1
kp_go1:
  s_add_u32 s71, s71, 4096
  s_cmp_ge_u32 s71, 20480
  s_cselect_b32 s71, 0, s71
  s_add_u32 s62, s58, s71
  buffer_load_dwordx4 v[68:71], v9, s[8:11], s62 offen offset:0 sc1
  buffer_load_dwordx4 v[72:75], v9, s[8:11], s62 offen offset:1024 sc1
  buffer_load_dwordx4 v[76:79], v9, s[8:11], s62 offen offset:2048 sc1
  buffer_load_dwordx4 v[80:83], v9, s[8:11], s62 offen offset:3072 sc1
  s_add_u32 s71, s71, 4096
  s_cmp_ge_u32 s71, 20480
  s_cselect_b32 s71, 0, s71
  s_add_u32 s62, s58, s71
  buffer_load_dwordx4 v[84:87], v9, s[8:11], s62 offen offset:0 sc1
  buffer_load_dwordx4 v[88:91], v9, s[8:11], s62 offen offset:1024 sc1
  s_waitcnt vmcnt(6)
  v_max3_u32 v46, v52, v53, v54
  v_max3_u32 v46, v46, v55, v56
  v_max3_u32 v46, v46, v57, v58
  v_max3_u32 v46, v46, v59, v60
  v_max3_u32 v46, v46, v61, v62
  v_max3_u32 v46, v46, v63, v64
  v_max3_u32 v46, v46, v65, v66
  v_max_u32 v46, v46, v67
  v_cmp_eq_u32 vcc, -1, v46
  s_cbranch_vccnz kp_probe1
  s_barrier
  ds_read_b128 v[152:155], v18 offset:16384
  ds_read_b128 v[156:159], v18 offset:17408
  ds_read_b128 v[160:163], v18 offset:18432
  ds_read_b128 v[164:167], v18 offset:19456
  ds_read_b128 v[168:171], v18 offset:20480
  ds_read_b128 v[172:175], v18 offset:21504
  ds_read_b128 v[176:179], v18 offset:22528
  ds_read_b128 v[180:183], v18 offset:23552
  ds_read_b128 v[184:187], v18 offset:24576
  ds_read_b128 v[188:191], v18 offset:25600
  s_waitcnt lgkmcnt(5)
  v_mfma_f32_16x16x32_bf16 v[132:135], v[152:155], v[52:55], 0
  v_add_f32 v212, v212, v214
  ds_read_b128 v[192:195], v18 offset:26624
  v_mfma_f32_16x16x32_bf16 v[136:139], v[156:159], v[52:55], 0
  buffer_load_dwordx4 v[92:95], v9, s[8:11], s62 offen offset:2048 sc1
  ds_read_b128 v[196:199], v18 offset:27648
  v_mfma_f32_16x16x32_bf16 v[140:143], v[160:163], v[52:55], 0
  v_add_f32 v213, v213, v215
  ds_read_b128 v[200:203], v18 offset:28672
  v_mfma_f32_16x16x32_bf16 v[144:147], v[164:167], v[52:55], 0
  buffer_load_dwordx4 v[96:99], v9, s[8:11], s62 offen offset:3072 sc1
  ds_read_b128 v[204:207], v18 offset:29696
  v_mfma_f32_16x16x32_bf16 v[148:151], v[168:171], v[52:55], 0
  v_mov_b32 v1, v212
  ds_read_b128 v[208:211], v18 offset:30720
  s_waitcnt lgkmcnt(5)
  v_mfma_f32_16x16x32_bf16 v[132:135], v[172:175], v[56:59], v[132:135]
  s_add_u32 s71, s71, 4096
  s_cmp_ge_u32 s71, 20480
  s_cselect_b32 s71, 0, s71
  s_add_u32 s62, s58, s71
  buffer_load_dwordx4 v[100:103], v9, s[8:11], s62 offen offset:0 sc1
  ds_read_b128 v[152:155], v18 offset:31744
  v_mfma_f32_16x16x32_bf16 v[136:139], v[176:179], v[56:59], v[136:139]
  v_mov_b32 v2, v213
  ds_read_b128 v[156:159], v18 offset:32768
  v_mfma_f32_16x16x32_bf16 v[140:143], v[180:183], v[56:59], v[140:143]
  buffer_load_dwordx4 v[104:107], v9, s[8:11], s62 offen offset:1024 sc1
  ds_read_b128 v[160:163], v18 offset:33792
  v_mfma_f32_16x16x32_bf16 v[144:147], v[184:187], v[56:59], v[144:147]
  v_permlane16_swap_b32 v212, v1
  ds_read_b128 v[164:167], v18 offset:34816
  v_mfma_f32_16x16x32_bf16 v[148:151], v[188:191], v[56:59], v[148:151]
  buffer_load_dwordx4 v[108:111], v9, s[8:11], s62 offen offset:2048 sc1
  ds_read_b128 v[168:171], v18 offset:35840
  s_waitcnt lgkmcnt(5)
  v_mfma_f32_16x16x32_bf16 v[132:135], v[192:195], v[60:63], v[132:135]
  v_permlane16_swap_b32 v213, v2
  ds_read_b128 v[172:175], v18 offset:57344
  v_mfma_f32_16x16x32_bf16 v[136:139], v[196:199], v[60:63], v[136:139]
  buffer_load_dwordx4 v[112:115], v9, s[8:11], s62 offen offset:3072 sc1
  ds_read_b128 v[176:179], v18 offset:58368
  v_mfma_f32_16x16x32_bf16 v[140:143], v[200:203], v[60:63], v[140:143]
  v_add_f32 v212, v212, v1
  ds_read_b128 v[180:183], v18 offset:59392
  v_mfma_f32_16x16x32_bf16 v[144:147], v[204:207], v[60:63], v[144:147]
  s_add_u32 s71, s71, 4096
  s_cmp_ge_u32 s71, 20480
  s_cselect_b32 s71, 0, s71
  s_add_u32 s62, s58, s71
  buffer_load_dwordx4 v[116:119], v9, s[8:11], s62 offen offset:0 sc1
  ds_read_b128 v[184:187], v18 offset:60416
  v_mfma_f32_16x16x32_bf16 v[148:151], v[208:211], v[60:63], v[148:151]
  v_add_f32 v213, v213, v2
  ds_read_b128 v[188:191], v18 offset:61440
  s_waitcnt lgkmcnt(5)
  v_mfma_f32_16x16x32_bf16 v[132:135], v[152:155], v[64:67], v[132:135]
  buffer_load_dwordx4 v[120:123], v9, s[8:11], s62 offen offset:1024 sc1
  ds_read_b128 v[192:195], v18 offset:62464
  v_mfma_f32_16x16x32_bf16 v[136:139], v[156:159], v[64:67], v[136:139]
  v_mov_b32 v1, v212
  ds_read_b128 v[196:199], v18 offset:63488
  v_mfma_f32_16x16x32_bf16 v[140:143], v[160:163], v[64:67], v[140:143]
  buffer_load_dwordx4 v[124:127], v9, s[8:11], s62 offen offset:2048 sc1
  ds_read_b128 v[200:203], v18 offset:64512
  v_mfma_f32_16x16x32_bf16 v[144:147], v[164:167], v[64:67], v[144:147]
  v_mov_b32 v2, v213
  ds_read_b128 v[204:207], v19 offset:0
  v_mfma_f32_16x16x32_bf16 v[148:151], v[168:171], v[64:67], v[148:151]
  buffer_load_dwordx4 v[128:131], v9, s[8:11], s62 offen offset:3072 sc1
  ds_read_b128 v[208:211], v19 offset:1024
  s_waitcnt vmcnt(14)
  s_waitcnt lgkmcnt(5)
  v_mfma_f32_16x16x32_bf16 v[132:135], v[172:175], v[68:71], v[132:135]
  v_permlane32_swap_b32 v212, v1
  ds_read_b128 v[152:155], v19 offset:2048
  v_mfma_f32_16x16x32_bf16 v[136:139], v[176:179], v[68:71], v[136:139]
  ds_read_b128 v[156:159], v19 offset:3072
  v_mfma_f32_16x16x32_bf16 v[140:143], v[180:183], v[68:71], v[140:143]
  v_permlane32_swap_b32 v213, v2
  ds_read_b128 v[160:163], v19 offset:4096
  v_mfma_f32_16x16x32_bf16 v[144:147], v[184:187], v[68:71], v[144:147]
  ds_read_b128 v[164:167], v19 offset:5120
  v_mfma_f32_16x16x32_bf16 v[148:151], v[188:191], v[68:71], v[148:151]
  v_add_f32 v212, v212, v1
  ds_read_b128 v[168:171], v19 offset:6144
  s_waitcnt lgkmcnt(5)
  v_mfma_f32_16x16x32_bf16 v[132:135], v[192:195], v[72:75], v[132:135]
  ds_read_b128 v[172:175], v19 offset:7168
  v_mfma_f32_16x16x32_bf16 v[136:139], v[196:199], v[72:75], v[136:139]
  v_add_f32 v213, v213, v2
  ds_read_b128 v[176:179], v19 offset:8192
  v_mfma_f32_16x16x32_bf16 v[140:143], v[200:203], v[72:75], v[140:143]
  ds_read_b128 v[180:183], v19 offset:9216
  v_mfma_f32_16x16x32_bf16 v[144:147], v[204:207], v[72:75], v[144:147]
  v_mul_f32 v212, 0x3acccccd, v212
  ds_read_b128 v[184:187], v19 offset:10240
  v_mfma_f32_16x16x32_bf16 v[148:151], v[208:211], v[72:75], v[148:151]
  ds_read_b128 v[188:191], v19 offset:11264
  s_waitcnt vmcnt(12)
  s_waitcnt lgkmcnt(5)
  v_mfma_f32_16x16x32_bf16 v[132:135], v[152:155], v[76:79], v[132:135]
  v_mul_f32 v213, 0x3acccccd, v213
  s_barrier
  ds_read_b128 v[192:195], v18 offset:36864
  v_mfma_f32_16x16x32_bf16 v[136:139], v[156:159], v[76:79], v[136:139]
  ds_read_b128 v[196:199], v18 offset:37888
  v_mfma_f32_16x16x32_bf16 v[140:143], v[160:163], v[76:79], v[140:143]
  v_fma_f32 v213, -v212, v212, v213
  ds_read_b128 v[200:203], v18 offset:38912
  v_mfma_f32_16x16x32_bf16 v[144:147], v[164:167], v[76:79], v[144:147]
  ds_read_b128 v[204:207], v18 offset:39936
  v_mfma_f32_16x16x32_bf16 v[148:151], v[168:171], v[76:79], v[148:151]
  v_max_f32 v213, 0, v213
  ds_read_b128 v[208:211], v18 offset:40960
  s_waitcnt lgkmcnt(5)
  v_mfma_f32_16x16x32_bf16 v[132:135], v[172:175], v[80:83], v[132:135]
  ds_read_b128 v[152:155], v18 offset:41984
  v_mfma_f32_16x16x32_bf16 v[136:139], v[176:179], v[80:83], v[136:139]
  v_add_f32 v214, 0x3727c5ac, v213
  ds_read_b128 v[156:159], v18 offset:43008
  v_mfma_f32_16x16x32_bf16 v[140:143], v[180:183], v[80:83], v[140:143]
  ds_read_b128 v[160:163], v18 offset:44032
  v_mfma_f32_16x16x32_bf16 v[144:147], v[184:187], v[80:83], v[144:147]
  v_rsq_f32 v214, v214
  ds_read_b128 v[164:167], v18 offset:45056
  v_mfma_f32_16x16x32_bf16 v[148:151], v[188:191], v[80:83], v[148:151]
  ds_read_b128 v[168:171], v18 offset:46080
  s_waitcnt vmcnt(10)
  s_waitcnt lgkmcnt(5)
  v_mfma_f32_16x16x32_bf16 v[132:135], v[192:195], v[84:87], v[132:135]
  v_mov_b32 v34, v214
  ds_read_b128 v[172:175], v18 offset:47104
  v_mfma_f32_16x16x32_bf16 v[136:139], v[196:199], v[84:87], v[136:139]
  ds_read_b128 v[176:179], v18 offset:48128
  v_mfma_f32_16x16x32_bf16 v[140:143], v[200:203], v[84:87], v[140:143]
  v_mov_b32 v35, v214
  ds_read_b128 v[180:183], v18 offset:49152
  v_mfma_f32_16x16x32_bf16 v[144:147], v[204:207], v[84:87], v[144:147]
  ds_read_b128 v[184:187], v18 offset:50176
  v_mfma_f32_16x16x32_bf16 v[148:151], v[208:211], v[84:87], v[148:151]
  v_mul_f32_e64 v36, -v212, v214
  ds_read_b128 v[188:191], v18 offset:51200
  s_waitcnt lgkmcnt(5)
  v_mfma_f32_16x16x32_bf16 v[132:135], v[152:155], v[88:91], v[132:135]
  ds_read_b128 v[192:195], v18 offset:52224
  v_mfma_f32_16x16x32_bf16 v[136:139], v[156:159], v[88:91], v[136:139]
  v_mul_f32_e64 v37, -v212, v214
  ds_read_b128 v[196:199], v18 offset:53248
  v_mfma_f32_16x16x32_bf16 v[140:143], v[160:163], v[88:91], v[140:143]
  ds_read_b128 v[200:203], v18 offset:54272
  v_mfma_f32_16x16x32_bf16 v[144:147], v[164:167], v[88:91], v[144:147]
  v_mul_f32 v215, v214, v214
  ds_read_b128 v[204:207], v18 offset:55296
  v_mfma_f32_16x16x32_bf16 v[148:151], v[168:171], v[88:91], v[148:151]
  ds_read_b128 v[208:211], v18 offset:56320
  s_waitcnt vmcnt(8)
  s_waitcnt lgkmcnt(5)
  v_mfma_f32_16x16x32_bf16 v[132:135], v[172:175], v[92:95], v[132:135]
  v_fmaak_f32 v215, v215, v213, 0x3727c5ac
  ds_read_b128 v[152:155], v9 offset:0
  v_mfma_f32_16x16x32_bf16 v[136:139], v[176:179], v[92:95], v[136:139]
  ds_read_b128 v[156:159], v9 offset:1024
  v_mfma_f32_16x16x32_bf16 v[140:143], v[180:183], v[92:95], v[140:143]
  v_rsq_f32 v215, v215
  ds_read_b128 v[160:163], v9 offset:2048
  v_mfma_f32_16x16x32_bf16 v[144:147], v[184:187], v[92:95], v[144:147]
  ds_read_b128 v[164:167], v9 offset:3072
  v_mfma_f32_16x16x32_bf16 v[148:151], v[188:191], v[92:95], v[148:151]
  v_mul_f32 v214, v214, v215
  ds_read_b128 v[168:171], v9 offset:4096
  s_waitcnt lgkmcnt(5)
  v_mfma_f32_16x16x32_bf16 v[132:135], v[192:195], v[96:99], v[132:135]
  ds_read_b128 v[172:175], v9 offset:5120
  v_mfma_f32_16x16x32_bf16 v[136:139], v[196:199], v[96:99], v[136:139]
  v_sub_f32 v218, 0, v212
  ds_read_b128 v[176:179], v9 offset:6144
  v_mfma_f32_16x16x32_bf16 v[140:143], v[200:203], v[96:99], v[140:143]
  ds_read_b128 v[180:183], v9 offset:7168
  v_mfma_f32_16x16x32_bf16 v[144:147], v[204:207], v[96:99], v[144:147]
  v_mul_f32 v220, 0xc0135761, v214
  ds_read_b128 v[184:187], v9 offset:8192
  v_mfma_f32_16x16x32_bf16 v[148:151], v[208:211], v[96:99], v[148:151]
  ds_read_b128 v[188:191], v9 offset:9216
  s_waitcnt vmcnt(6)
  s_waitcnt lgkmcnt(5)
  v_mfma_f32_16x16x32_bf16 v[132:135], v[152:155], v[100:103], v[132:135]
  v_mul_f32 v215, v214, v214
  ds_read_b128 v[192:195], v9 offset:10240
  v_mfma_f32_16x16x32_bf16 v[136:139], v[156:159], v[100:103], v[136:139]
  ds_read_b128 v[196:199], v9 offset:11264
  v_mfma_f32_16x16x32_bf16 v[140:143], v[160:163], v[100:103], v[140:143]
  v_mul_f32 v222, 0x3d372713, v215
  ds_read_b128 v[200:203], v9 offset:12288
  v_mfma_f32_16x16x32_bf16 v[144:147], v[164:167], v[100:103], v[144:147]
  ds_read_b128 v[204:207], v9 offset:13312
  v_mfma_f32_16x16x32_bf16 v[148:151], v[168:171], v[100:103], v[148:151]
  v_mul_f32 v222, v222, v220
  ds_read_b128 v[208:211], v9 offset:14336
  s_waitcnt lgkmcnt(5)
  v_mfma_f32_16x16x32_bf16 v[132:135], v[172:175], v[104:107], v[132:135]
  ds_read_b128 v[152:155], v9 offset:15360
  v_mfma_f32_16x16x32_bf16 v[136:139], v[176:179], v[104:107], v[136:139]
  v_rcp_f32 v224, v214
  ds_read_b128 v[156:159], v9 offset:16384
  v_mfma_f32_16x16x32_bf16 v[140:143], v[180:183], v[104:107], v[140:143]
  ds_read_b128 v[160:163], v9 offset:17408
  v_mfma_f32_16x16x32_bf16 v[144:147], v[184:187], v[104:107], v[144:147]
  v_mov_b32 v219, v218
  ds_read_b128 v[164:167], v9 offset:18432
  v_mfma_f32_16x16x32_bf16 v[148:151], v[188:191], v[104:107], v[148:151]
  ds_read_b128 v[168:171], v9 offset:19456
  s_waitcnt vmcnt(4)
  s_waitcnt lgkmcnt(5)
  v_mfma_f32_16x16x32_bf16 v[132:135], v[192:195], v[108:111], v[132:135]
  v_mov_b32 v221, v220
  s_barrier
  ds_read_b128 v[172:175], v9 offset:20480
  v_mfma_f32_16x16x32_bf16 v[136:139], v[196:199], v[108:111], v[136:139]
  ds_read_b128 v[176:179], v9 offset:21504
  v_mfma_f32_16x16x32_bf16 v[140:143], v[200:203], v[108:111], v[140:143]
  v_mov_b32 v223, v222
  ds_read_b128 v[180:183], v9 offset:22528
  v_mfma_f32_16x16x32_bf16 v[144:147], v[204:207], v[108:111], v[144:147]
  ds_read_b128 v[184:187], v9 offset:23552
  v_mfma_f32_16x16x32_bf16 v[148:151], v[208:211], v[108:111], v[148:151]
  v_mov_b32 v225, v224
  ds_read_b128 v[188:191], v9 offset:24576
  s_waitcnt lgkmcnt(5)
  v_mfma_f32_16x16x32_bf16 v[132:135], v[152:155], v[112:115], v[132:135]
  ds_read_b128 v[192:195], v9 offset:25600
  v_mfma_f32_16x16x32_bf16 v[136:139], v[156:159], v[112:115], v[136:139]
  ds_read_b128 v[196:199], v9 offset:26624
  v_mfma_f32_16x16x32_bf16 v[140:143], v[160:163], v[112:115], v[140:143]
  ds_read_b128 v[200:203], v9 offset:27648
  v_mfma_f32_16x16x32_bf16 v[144:147], v[164:167], v[112:115], v[144:147]
  ds_read_b128 v[204:207], v9 offset:28672
  v_mfma_f32_16x16x32_bf16 v[148:151], v[168:171], v[112:115], v[148:151]
  ds_read_b128 v[208:211], v9 offset:29696
  s_waitcnt vmcnt(2)
  s_waitcnt lgkmcnt(5)
  v_mfma_f32_16x16x32_bf16 v[132:135], v[172:175], v[116:119], v[132:135]
  ds_read_b128 v[152:155], v9 offset:30720
  v_mfma_f32_16x16x32_bf16 v[136:139], v[176:179], v[116:119], v[136:139]
  ds_read_b128 v[156:159], v9 offset:31744
  v_mfma_f32_16x16x32_bf16 v[140:143], v[180:183], v[116:119], v[140:143]
  ds_read_b128 v[160:163], v9 offset:32768
  v_mfma_f32_16x16x32_bf16 v[144:147], v[184:187], v[116:119], v[144:147]
  ds_read_b128 v[164:167], v9 offset:33792
  v_mfma_f32_16x16x32_bf16 v[148:151], v[188:191], v[116:119], v[148:151]
  ds_read_b128 v[168:171], v9 offset:34816
  s_waitcnt lgkmcnt(5)
  v_mfma_f32_16x16x32_bf16 v[132:135], v[192:195], v[120:123], v[132:135]
  ds_read_b128 v[172:175], v9 offset:35840
  v_mfma_f32_16x16x32_bf16 v[136:139], v[196:199], v[120:123], v[136:139]
  ds_read_b128 v[176:179], v9 offset:36864
  v_mfma_f32_16x16x32_bf16 v[140:143], v[200:203], v[120:123], v[140:143]
  ds_read_b128 v[180:183], v9 offset:37888
  v_mfma_f32_16x16x32_bf16 v[144:147], v[204:207], v[120:123], v[144:147]
  ds_read_b128 v[184:187], v9 offset:38912
  v_mfma_f32_16x16x32_bf16 v[148:151], v[208:211], v[120:123], v[148:151]
  ds_read_b128 v[188:191], v9 offset:39936
  s_waitcnt vmcnt(0)
  s_waitcnt lgkmcnt(5)
  v_mfma_f32_16x16x32_bf16 v[132:135], v[152:155], v[124:127], v[132:135]
  v_mfma_f32_16x16x32_bf16 v[136:139], v[156:159], v[124:127], v[136:139]
  v_mfma_f32_16x16x32_bf16 v[140:143], v[160:163], v[124:127], v[140:143]
  v_mfma_f32_16x16x32_bf16 v[144:147], v[164:167], v[124:127], v[144:147]
  v_mfma_f32_16x16x32_bf16 v[148:151], v[168:171], v[124:127], v[148:151]
  s_waitcnt lgkmcnt(0)
  v_mfma_f32_16x16x32_bf16 v[132:135], v[172:175], v[128:131], v[132:135]
  ds_read_b128 v[228:231], v216 offset:0
  v_mfma_f32_16x16x32_bf16 v[136:139], v[176:179], v[128:131], v[136:139]
  ds_read_b128 v[232:235], v216 offset:64
  v_mfma_f32_16x16x32_bf16 v[140:143], v[180:183], v[128:131], v[140:143]
  ds_read_b128 v[236:239], v216 offset:128
  v_mfma_f32_16x16x32_bf16 v[144:147], v[184:187], v[128:131], v[144:147]
  ds_read_b128 v[240:243], v216 offset:192
  v_mfma_f32_16x16x32_bf16 v[148:151], v[188:191], v[128:131], v[148:151]
  ds_read_b128 v[244:247], v216 offset:256
  v_cmp_u_f32 vcc, v132, v132
  s_cbranch_vccnz kp_redo1
kp_back1:
  s_waitcnt lgkmcnt(0)
  v_pk_fma_f32 v[132:133], v[228:229], v[218:219], v[132:133]
  v_pk_fma_f32 v[134:135], v[230:231], v[218:219], v[134:135]
  v_pk_mul_f32 v[152:153], v[132:133], v[132:133]
  v_pk_mul_f32 v[154:155], v[134:135], v[134:135]
  v_pk_fma_f32 v[152:153], v[152:153], v[222:223], v[220:221]
  v_pk_fma_f32 v[154:155], v[154:155], v[222:223], v[220:221]
  v_pk_mul_f32 v[152:153], v[152:153], v[132:133]
  v_pk_mul_f32 v[154:155], v[154:155], v[134:135]
  v_exp_f32 v152, v152
  v_exp_f32 v153, v153
  v_exp_f32 v154, v154
  v_exp_f32 v155, v155
  v_pk_fma_f32 v[152:153], v[152:153], v[224:225], v[224:225]
  v_pk_fma_f32 v[154:155], v[154:155], v[224:225], v[224:225]
  v_rcp_f32 v152, v152
  v_rcp_f32 v153, v153
  v_rcp_f32 v154, v154
  v_rcp_f32 v155, v155
  v_pk_mul_f32 v[152:153], v[152:153], v[132:133]
  v_pk_mul_f32 v[154:155], v[154:155], v[134:135]
  v_cvt_pk_bf16_f32 v52, v152, v153
  v_cvt_pk_bf16_f32 v53, v154, v155
  v_min_u32 v52, v52, v249
  v_min_u32 v53, v53, v249
  v_pk_fma_f32 v[136:137], v[232:233], v[218:219], v[136:137]
  v_pk_fma_f32 v[138:139], v[234:235], v[218:219], v[138:139]
  v_pk_mul_f32 v[156:157], v[136:137], v[136:137]
  v_pk_mul_f32 v[158:159], v[138:139], v[138:139]
  v_pk_fma_f32 v[156:157], v[156:157], v[222:223], v[220:221]
  v_pk_fma_f32 v[158:159], v[158:159], v[222:223], v[220:221]
  v_pk_mul_f32 v[156:157], v[156:157], v[136:137]
  v_pk_mul_f32 v[158:159], v[158:159], v[138:139]
  v_exp_f32 v156, v156
  v_exp_f32 v157, v157
  v_exp_f32 v158, v158
  v_exp_f32 v159, v159
  v_pk_fma_f32 v[156:157], v[156:157], v[224:225], v[224:225]
  v_pk_fma_f32 v[158:159], v[158:159], v[224:225], v[224:225]
  v_rcp_f32 v156, v156
  v_rcp_f32 v157, v157
  v_rcp_f32 v158, v158
  v_rcp_f32 v159, v159
  v_pk_mul_f32 v[156:157], v[156:157], v[136:137]
  v_pk_mul_f32 v[158:159], v[158:159], v[138:139]
  v_cvt_pk_bf16_f32 v54, v156, v157
  v_cvt_pk_bf16_f32 v55, v158, v159
  v_min_u32 v54, v54, v249
  v_min_u32 v55, v55, v249
  s_nop 0
  v_permlane16_swap_b32 v52, v54
  v_permlane16_swap_b32 v53, v55
  buffer_store_dwordx4 v[52:55], v250, s[16:19], s53 offen offset:0 sc1
  v_pk_fma_f32 v[140:141], v[236:237], v[218:219], v[140:141]
  v_pk_fma_f32 v[142:143], v[238:239], v[218:219], v[142:143]
  v_pk_mul_f32 v[152:153], v[140:141], v[140:141]
  v_pk_mul_f32 v[154:155], v[142:143], v[142:143]
  v_pk_fma_f32 v[152:153], v[152:153], v[222:223], v[220:221]
  v_pk_fma_f32 v[154:155], v[154:155], v[222:223], v[220:221]
  v_pk_mul_f32 v[152:153], v[152:153], v[140:141]
  v_pk_mul_f32 v[154:155], v[154:155], v[142:143]
  v_exp_f32 v152, v152
  v_exp_f32 v153, v153
  v_exp_f32 v154, v154
  v_exp_f32 v155, v155
  v_pk_fma_f32 v[152:153], v[152:153], v[224:225], v[224:225]
  v_pk_fma_f32 v[154:155], v[154:155], v[224:225], v[224:225]
  v_rcp_f32 v152, v152
  v_rcp_f32 v153, v153
  v_rcp_f32 v154, v154
  v_rcp_f32 v155, v155
  v_pk_mul_f32 v[152:153], v[152:153], v[140:141]
  v_pk_mul_f32 v[154:155], v[154:155], v[142:143]
  v_cvt_pk_bf16_f32 v56, v152, v153
  v_cvt_pk_bf16_f32 v57, v154, v155
  v_min_u32 v56, v56, v249
  v_min_u32 v57, v57, v249
  v_pk_fma_f32 v[144:145], v[240:241], v[218:219], v[144:145]
  v_pk_fma_f32 v[146:147], v[242:243], v[218:219], v[146:147]
  v_pk_mul_f32 v[156:157], v[144:145], v[144:145]
  v_pk_mul_f32 v[158:159], v[146:147], v[146:147]
  v_pk_fma_f32 v[156:157], v[156:157], v[222:223], v[220:221]
  v_pk_fma_f32 v[158:159], v[158:159], v[222:223], v[220:221]
  v_pk_mul_f32 v[156:157], v[156:157], v[144:145]
  v_pk_mul_f32 v[158:159], v[158:159], v[146:147]
  v_exp_f32 v156, v156
  v_exp_f32 v157, v157
  v_exp_f32 v158, v158
  v_exp_f32 v159, v159
  v_pk_fma_f32 v[156:157], v[156:157], v[224:225], v[224:225]
  v_pk_fma_f32 v[158:159], v[158:159], v[224:225], v[224:225]
  v_rcp_f32 v156, v156
  v_rcp_f32 v157, v157
  v_rcp_f32 v158, v158
  v_rcp_f32 v159, v159
  v_pk_mul_f32 v[156:157], v[156:157], v[144:145]
  v_pk_mul_f32 v[158:159], v[158:159], v[146:147]
  v_cvt_pk_bf16_f32 v58, v156, v157
  v_cvt_pk_bf16_f32 v59, v158, v159
  v_min_u32 v58, v58, v249
  v_min_u32 v59, v59, v249
  s_nop 0
  v_permlane16_swap_b32 v56, v58
  v_permlane16_swap_b32 v57, v59
  buffer_store_dwordx4 v[56:59], v250, s[16:19], s53 offen offset:1024 sc1
  v_pk_fma_f32 v[148:149], v[244:245], v[218:219], v[148:149]
  v_pk_fma_f32 v[150:151], v[246:247], v[218:219], v[150:151]
  v_pk_mul_f32 v[152:153], v[148:149], v[148:149]
  v_pk_mul_f32 v[154:155], v[150:151], v[150:151]
  v_pk_fma_f32 v[152:153], v[152:153], v[222:223], v[220:221]
  v_pk_fma_f32 v[154:155], v[154:155], v[222:223], v[220:221]
  v_pk_mul_f32 v[152:153], v[152:153], v[148:149]
  v_pk_mul_f32 v[154:155], v[154:155], v[150:151]
  v_exp_f32 v152, v152
  v_exp_f32 v153, v153
  v_exp_f32 v154, v154
  v_exp_f32 v155, v155
  v_pk_fma_f32 v[152:153], v[152:153], v[224:225], v[224:225]
  v_pk_fma_f32 v[154:155], v[154:155], v[224:225], v[224:225]
  v_rcp_f32 v152, v152
  v_rcp_f32 v153, v153
  v_rcp_f32 v154, v154
  v_rcp_f32 v155, v155
  v_pk_mul_f32 v[152:153], v[152:153], v[148:149]
  v_pk_mul_f32 v[154:155], v[154:155], v[150:151]
  v_cvt_pk_bf16_f32 v168, v152, v153
  v_cvt_pk_bf16_f32 v169, v154, v155
  v_min_u32 v168, v168, v249
  v_min_u32 v169, v169, v249
  buffer_store_dwordx2 v[168:169], v248, s[16:19], s53 offen offset:2048 sc1
  s_mov_b64 exec, -1
  s_barrier
  s_add_u32 s8, s6, 0xd00000
  s_addc_u32 s9, s7, 0
  s_mov_b32 s10, 0x280000
  s_mov_b32 s11, 0x00020000
  s_mul_i32 s58, s46, 20480
  v_and_b32 v1, 7, v0
  v_min_u32 v2, 2, v11
  s_lshr_b32 s43, s46, 2
  s_add_u32 s43, s43, 31
  v_add_u32 v2, s43, v2
  v_and_b32 v2, 31, v2
  v_lshlrev_b32 v2, 6, v2
  v_lshl_add_u32 v45, v1, 2, v2
  v_add_u32 v45, 8192, v45
  s_add_u32 s16, s6, 0xfc0000
  s_addc_u32 s17, s7, 0
  s_mov_b32 s18, 0x280000
  s_mov_b32 s19, 0x00020000
  s_add_u32 s32, s6, 0xfa0000
  s_addc_u32 s33, s7, 0
  s_mov_b32 s34, 0x20000
  s_mov_b32 s35, 0x00020000
  s_lshl_b32 s53, s46, 10
  s_lshl_b32 s44, s47, 7
  s_add_u32 s53, s53, s44
  s_lshl_b32 s61, s46, 6
  s_lshl_b32 s44, s47, 2
  s_add_u32 s61, s61, s44
  s_add_u32 s61, s61, 16384
  v_and_b32 v1, 7, v0
  v_mul_u32_u24 v44, 2560, v1
  v_lshrrev_b32 v1, 3, v0
  v_lshl_add_u32 v44, v1, 5, v44
  v_lshrrev_b32 v1, 5, v0
  v_lshl_add_u32 v44, v1, 4, v44
  v_add_u32 v44, 2048, v44
  s_mov_b32 s60, 400000
  s_waitcnt vmcnt(0)
kp_probe2:
  s_sub_u32 s60, s60, 1
  s_cbranch_scc1 kp_end
  buffer_load_dword v46, v44, s[8:11], s58 offen sc1
  s_lshl_b32 s71, s68, 10
  s_add_u32 s62, s58, s71
  buffer_load_dwordx4 v[52:55], v9, s[8:11], s62 offen offset:0 sc1
  buffer_load_dwordx4 v[56:59], v9, s[8:11], s62 offen offset:1024 sc1
  buffer_load_dwordx4 v[60:63], v9, s[8:11], s62 offen offset:2048 sc1
  buffer_load_dwordx4 v[64:67], v9, s[8:11], s62 offen offset:3072 sc1
  s_waitcnt vmcnt(4)
  v_cmp_eq_u32 vcc, -1, v46
  s_cbranch_vccnz kp_probe2
kp_go2:
  s_add_u32 s71, s71, 4096
  s_cmp_ge_u32 s71, 20480
  s_cselect_b32 s71, 0, s71
  s_add_u32 s62, s58, s71
  buffer_load_dwordx4 v[68:71], v9, s[8:11], s62 offen offset:0 sc1
  buffer_load_dwordx4 v[72:75], v9, s[8:11], s62 offen offset:1024 sc1
  buffer_load_dwordx4 v[76:79], v9, s[8:11], s62 offen offset:2048 sc1
  buffer_load_dwordx4 v[80:83], v9, s[8:11], s62 offen offset:3072 sc1
  s_add_u32 s71, s71, 4096
  s_cmp_ge_u32 s71, 20480
  s_cselect_b32 s71, 0, s71
  s_add_u32 s62, s58, s71
  buffer_load_dwordx4 v[84:87], v9, s[8:11], s62 offen offset:0 sc1
  buffer_load_dwordx4 v[88:91], v9, s[8:11], s62 offen offset:1024 sc1
  s_waitcnt vmcnt(6)
  v_max3_u32 v46, v52, v53, v54
  v_max3_u32 v46, v46, v55, v56
  v_max3_u32 v46, v46, v57, v58
  v_max3_u32 v46, v46, v59, v60
  v_max3_u32 v46, v46, v61, v62
  v_max3_u32 v46, v46, v63, v64
  v_max3_u32 v46, v46, v65, v66
  v_max_u32 v46, v46, v67
  v_cmp_eq_u32 vcc, -1, v46
  s_cbranch_vccnz kp_probe2
  s_barrier
  ds_read_b128 v[152:155], v9 offset:40960
  ds_read_b128 v[156:159], v9 offset:41984
  ds_read_b128 v[160:163], v9 offset:43008
  ds_read_b128 v[164:167], v9 offset:44032
  ds_read_b128 v[168:171], v9 offset:45056
  ds_read_b128 v[172:175], v9 offset:46080
  ds_read_b128 v[176:179], v9 offset:47104
  ds_read_b128 v[180:183], v9 offset:48128
  ds_read_b128 v[184:187], v9 offset:49152
  ds_read_b128 v[188:191], v9 offset:50176
  s_waitcnt lgkmcnt(5)
  v_mfma_f32_16x16x32_bf16 v[132:135], v[152:155], v[52:55], 0
  ds_read_b128 v[192:195], v9 offset:51200
  v_mfma_f32_16x16x32_bf16 v[136:139], v[156:159], v[52:55], 0
  buffer_load_dwordx4 v[92:95], v9, s[8:11], s62 offen offset:2048 sc1
  ds_read_b128 v[196:199], v9 offset:52224
  v_mfma_f32_16x16x32_bf16 v[140:143], v[160:163], v[52:55], 0
  ds_read_b128 v[200:203], v9 offset:53248
  v_mfma_f32_16x16x32_bf16 v[144:147], v[164:167], v[52:55], 0
  buffer_load_dwordx4 v[96:99], v9, s[8:11], s62 offen offset:3072 sc1
  ds_read_b128 v[204:207], v9 offset:54272
  v_mfma_f32_16x16x32_bf16 v[148:151], v[168:171], v[52:55], 0
  ds_read_b128 v[208:211], v9 offset:55296
  s_waitcnt lgkmcnt(5)
  v_mfma_f32_16x16x32_bf16 v[132:135], v[172:175], v[56:59], v[132:135]
  s_add_u32 s71, s71, 4096
  s_cmp_ge_u32 s71, 20480
  s_cselect_b32 s71, 0, s71
  s_add_u32 s62, s58, s71
  buffer_load_dwordx4 v[100:103], v9, s[8:11], s62 offen offset:0 sc1
  ds_read_b128 v[152:155], v9 offset:56320
  v_mfma_f32_16x16x32_bf16 v[136:139], v[176:179], v[56:59], v[136:139]
  ds_read_b128 v[156:159], v9 offset:57344
  v_mfma_f32_16x16x32_bf16 v[140:143], v[180:183], v[56:59], v[140:143]
  buffer_load_dwordx4 v[104:107], v9, s[8:11], s62 offen offset:1024 sc1
  ds_read_b128 v[160:163], v9 offset:58368
  v_mfma_f32_16x16x32_bf16 v[144:147], v[184:187], v[56:59], v[144:147]
  ds_read_b128 v[164:167], v9 offset:59392
  v_mfma_f32_16x16x32_bf16 v[148:151], v[188:191], v[56:59], v[148:151]
  buffer_load_dwordx4 v[108:111], v9, s[8:11], s62 offen offset:2048 sc1
  ds_read_b128 v[168:171], v9 offset:60416
  s_waitcnt lgkmcnt(5)
  v_mfma_f32_16x16x32_bf16 v[132:135], v[192:195], v[60:63], v[132:135]
  ds_read_b128 v[172:175], v9 offset:61440
  v_mfma_f32_16x16x32_bf16 v[136:139], v[196:199], v[60:63], v[136:139]
  buffer_load_dwordx4 v[112:115], v9, s[8:11], s62 offen offset:3072 sc1
  ds_read_b128 v[176:179], v9 offset:62464
  v_mfma_f32_16x16x32_bf16 v[140:143], v[200:203], v[60:63], v[140:143]
  ds_read_b128 v[180:183], v9 offset:63488
  v_mfma_f32_16x16x32_bf16 v[144:147], v[204:207], v[60:63], v[144:147]
  s_add_u32 s71, s71, 4096
  s_cmp_ge_u32 s71, 20480
  s_cselect_b32 s71, 0, s71
  s_add_u32 s62, s58, s71
  buffer_load_dwordx4 v[116:119], v9, s[8:11], s62 offen offset:0 sc1
  ds_read_b128 v[184:187], v9 offset:64512
  v_mfma_f32_16x16x32_bf16 v[148:151], v[208:211], v[60:63], v[148:151]
  ds_read_b128 v[188:191], v18 offset:0
  s_waitcnt lgkmcnt(5)
  v_mfma_f32_16x16x32_bf16 v[132:135], v[152:155], v[64:67], v[132:135]
  buffer_load_dwordx4 v[120:123], v9, s[8:11], s62 offen offset:1024 sc1
  ds_read_b128 v[192:195], v18 offset:1024
  v_mfma_f32_16x16x32_bf16 v[136:139], v[156:159], v[64:67], v[136:139]
  ds_read_b128 v[196:199], v18 offset:2048
  v_mfma_f32_16x16x32_bf16 v[140:143], v[160:163], v[64:67], v[140:143]
  buffer_load_dwordx4 v[124:127], v9, s[8:11], s62 offen offset:2048 sc1
  ds_read_b128 v[200:203], v18 offset:3072
  v_mfma_f32_16x16x32_bf16 v[144:147], v[164:167], v[64:67], v[144:147]
  ds_read_b128 v[204:207], v18 offset:4096
  v_mfma_f32_16x16x32_bf16 v[148:151], v[168:171], v[64:67], v[148:151]
  buffer_load_dwordx4 v[128:131], v9, s[8:11], s62 offen offset:3072 sc1
  ds_read_b128 v[208:211], v18 offset:5120
  s_waitcnt vmcnt(14)
  s_waitcnt lgkmcnt(5)
  v_mfma_f32_16x16x32_bf16 v[132:135], v[172:175], v[68:71], v[132:135]
  ds_read_b128 v[152:155], v18 offset:6144
  v_mfma_f32_16x16x32_bf16 v[136:139], v[176:179], v[68:71], v[136:139]
  ds_read_b128 v[156:159], v18 offset:7168
  v_mfma_f32_16x16x32_bf16 v[140:143], v[180:183], v[68:71], v[140:143]
  ds_read_b128 v[160:163], v18 offset:8192
  v_mfma_f32_16x16x32_bf16 v[144:147], v[184:187], v[68:71], v[144:147]
  ds_read_b128 v[164:167], v18 offset:9216
  v_mfma_f32_16x16x32_bf16 v[148:151], v[188:191], v[68:71], v[148:151]
  ds_read_b128 v[168:171], v18 offset:10240
  s_waitcnt lgkmcnt(5)
  v_mfma_f32_16x16x32_bf16 v[132:135], v[192:195], v[72:75], v[132:135]
  ds_read_b128 v[172:175], v18 offset:11264
  v_mfma_f32_16x16x32_bf16 v[136:139], v[196:199], v[72:75], v[136:139]
  ds_read_b128 v[176:179], v18 offset:12288
  v_mfma_f32_16x16x32_bf16 v[140:143], v[200:203], v[72:75], v[140:143]
  ds_read_b128 v[180:183], v18 offset:13312
  v_mfma_f32_16x16x32_bf16 v[144:147], v[204:207], v[72:75], v[144:147]
  ds_read_b128 v[184:187], v18 offset:14336
  v_mfma_f32_16x16x32_bf16 v[148:151], v[208:211], v[72:75], v[148:151]
  ds_read_b128 v[188:191], v18 offset:15360
  s_waitcnt vmcnt(12)
  s_waitcnt lgkmcnt(5)
  v_mfma_f32_16x16x32_bf16 v[132:135], v[152:155], v[76:79], v[132:135]
  s_barrier
  ds_read_b128 v[192:195], v18 offset:16384
  v_mfma_f32_16x16x32_bf16 v[136:139], v[156:159], v[76:79], v[136:139]
  ds_read_b128 v[196:199], v18 offset:17408
  v_mfma_f32_16x16x32_bf16 v[140:143], v[160:163], v[76:79], v[140:143]
  ds_read_b128 v[200:203], v18 offset:18432
  v_mfma_f32_16x16x32_bf16 v[144:147], v[164:167], v[76:79], v[144:147]
  ds_read_b128 v[204:207], v18 offset:19456
  v_mfma_f32_16x16x32_bf16 v[148:151], v[168:171], v[76:79], v[148:151]
  ds_read_b128 v[208:211], v18 offset:20480
  s_waitcnt lgkmcnt(5)
  v_mfma_f32_16x16x32_bf16 v[132:135], v[172:175], v[80:83], v[132:135]
  ds_read_b128 v[152:155], v18 offset:21504
  v_mfma_f32_16x16x32_bf16 v[136:139], v[176:179], v[80:83], v[136:139]
  ds_read_b128 v[156:159], v18 offset:22528
  v_mfma_f32_16x16x32_bf16 v[140:143], v[180:183], v[80:83], v[140:143]
  ds_read_b128 v[160:163], v18 offset:23552
  v_mfma_f32_16x16x32_bf16 v[144:147], v[184:187], v[80:83], v[144:147]
  ds_read_b128 v[164:167], v18 offset:24576
  v_mfma_f32_16x16x32_bf16 v[148:151], v[188:191], v[80:83], v[148:151]
  ds_read_b128 v[168:171], v18 offset:25600
  s_waitcnt vmcnt(10)
  s_waitcnt lgkmcnt(5)
  v_mfma_f32_16x16x32_bf16 v[132:135], v[192:195], v[84:87], v[132:135]
  ds_read_b128 v[172:175], v18 offset:26624
  v_mfma_f32_16x16x32_bf16 v[136:139], v[196:199], v[84:87], v[136:139]
  ds_read_b128 v[176:179], v18 offset:27648
  v_mfma_f32_16x16x32_bf16 v[140:143], v[200:203], v[84:87], v[140:143]
  ds_read_b128 v[180:183], v18 offset:28672
  v_mfma_f32_16x16x32_bf16 v[144:147], v[204:207], v[84:87], v[144:147]
  ds_read_b128 v[184:187], v18 offset:29696
  v_mfma_f32_16x16x32_bf16 v[148:151], v[208:211], v[84:87], v[148:151]
  ds_read_b128 v[188:191], v18 offset:30720
  s_waitcnt lgkmcnt(5)
  v_mfma_f32_16x16x32_bf16 v[132:135], v[152:155], v[88:91], v[132:135]
  ds_read_b128 v[192:195], v18 offset:31744
  v_mfma_f32_16x16x32_bf16 v[136:139], v[156:159], v[88:91], v[136:139]
  ds_read_b128 v[196:199], v18 offset:32768
  v_mfma_f32_16x16x32_bf16 v[140:143], v[160:163], v[88:91], v[140:143]
  ds_read_b128 v[200:203], v18 offset:33792
  v_mfma_f32_16x16x32_bf16 v[144:147], v[164:167], v[88:91], v[144:147]
  ds_read_b128 v[204:207], v18 offset:34816
  v_mfma_f32_16x16x32_bf16 v[148:151], v[168:171], v[88:91], v[148:151]
  ds_read_b128 v[208:211], v18 offset:35840
  s_waitcnt vmcnt(8)
  s_waitcnt lgkmcnt(5)
  v_mfma_f32_16x16x32_bf16 v[132:135], v[172:175], v[92:95], v[132:135]
  ds_read_b128 v[152:155], v18 offset:57344
  v_mfma_f32_16x16x32_bf16 v[136:139], v[176:179], v[92:95], v[136:139]
  ds_read_b128 v[156:159], v18 offset:58368
  v_mfma_f32_16x16x32_bf16 v[140:143], v[180:183], v[92:95], v[140:143]
  ds_read_b128 v[160:163], v18 offset:59392
  v_mfma_f32_16x16x32_bf16 v[144:147], v[184:187], v[92:95], v[144:147]
  ds_read_b128 v[164:167], v18 offset:60416
  v_mfma_f32_16x16x32_bf16 v[148:151], v[188:191], v[92:95], v[148:151]
  ds_read_b128 v[168:171], v18 offset:61440
  s_waitcnt lgkmcnt(5)
  v_mfma_f32_16x16x32_bf16 v[132:135], v[192:195], v[96:99], v[132:135]
  ds_read_b128 v[172:175], v18 offset:62464
  v_mfma_f32_16x16x32_bf16 v[136:139], v[196:199], v[96:99], v[136:139]
  ds_read_b128 v[176:179], v18 offset:63488
  v_mfma_f32_16x16x32_bf16 v[140:143], v[200:203], v[96:99], v[140:143]
  ds_read_b128 v[180:183], v18 offset:64512
  v_mfma_f32_16x16x32_bf16 v[144:147], v[204:207], v[96:99], v[144:147]
  ds_read_b128 v[184:187], v19 offset:0
  v_mfma_f32_16x16x32_bf16 v[148:151], v[208:211], v[96:99], v[148:151]
  ds_read_b128 v[188:191], v19 offset:1024
  s_waitcnt vmcnt(6)
  s_waitcnt lgkmcnt(5)
  v_mfma_f32_16x16x32_bf16 v[132:135], v[152:155], v[100:103], v[132:135]
  ds_read_b128 v[192:195], v19 offset:2048
  v_mfma_f32_16x16x32_bf16 v[136:139], v[156:159], v[100:103], v[136:139]
  ds_read_b128 v[196:199], v19 offset:3072
  v_mfma_f32_16x16x32_bf16 v[140:143], v[160:163], v[100:103], v[140:143]
  ds_read_b128 v[200:203], v19 offset:4096
  v_mfma_f32_16x16x32_bf16 v[144:147], v[164:167], v[100:103], v[144:147]
  ds_read_b128 v[204:207], v19 offset:5120
  v_mfma_f32_16x16x32_bf16 v[148:151], v[168:171], v[100:103], v[148:151]
  ds_read_b128 v[208:211], v19 offset:6144
  s_waitcnt lgkmcnt(5)
  v_mfma_f32_16x16x32_bf16 v[132:135], v[172:175], v[104:107], v[132:135]
  ds_read_b128 v[152:155], v19 offset:7168
  v_mfma_f32_16x16x32_bf16 v[136:139], v[176:179], v[104:107], v[136:139]
  ds_read_b128 v[156:159], v19 offset:8192
  v_mfma_f32_16x16x32_bf16 v[140:143], v[180:183], v[104:107], v[140:143]
  ds_read_b128 v[160:163], v19 offset:9216
  v_mfma_f32_16x16x32_bf16 v[144:147], v[184:187], v[104:107], v[144:147]
  ds_read_b128 v[164:167], v19 offset:10240
  v_mfma_f32_16x16x32_bf16 v[148:151], v[188:191], v[104:107], v[148:151]
  ds_read_b128 v[168:171], v19 offset:11264
  s_waitcnt vmcnt(4)
  s_waitcnt lgkmcnt(5)
  v_mfma_f32_16x16x32_bf16 v[132:135], v[192:195], v[108:111], v[132:135]
  s_barrier
  ds_read_b128 v[172:175], v18 offset:36864
  v_mfma_f32_16x16x32_bf16 v[136:139], v[196:199], v[108:111], v[136:139]
  ds_read_b128 v[176:179], v18 offset:37888
  v_mfma_f32_16x16x32_bf16 v[140:143], v[200:203], v[108:111], v[140:143]
  ds_read_b128 v[180:183], v18 offset:38912
  v_mfma_f32_16x16x32_bf16 v[144:147], v[204:207], v[108:111], v[144:147]
  ds_read_b128 v[184:187], v18 offset:39936
  v_mfma_f32_16x16x32_bf16 v[148:151], v[208:211], v[108:111], v[148:151]
  ds_read_b128 v[188:191], v18 offset:40960
  s_waitcnt lgkmcnt(5)
  v_mfma_f32_16x16x32_bf16 v[132:135], v[152:155], v[112:115], v[132:135]
  ds_read_b128 v[192:195], v18 offset:41984
  v_mfma_f32_16x16x32_bf16 v[136:139], v[156:159], v[112:115], v[136:139]
  ds_read_b128 v[196:199], v18 offset:43008
  v_mfma_f32_16x16x32_bf16 v[140:143], v[160:163], v[112:115], v[140:143]
  ds_read_b128 v[200:203], v18 offset:44032
  v_mfma_f32_16x16x32_bf16 v[144:147], v[164:167], v[112:115], v[144:147]
  ds_read_b128 v[204:207], v18 offset:45056
  v_mfma_f32_16x16x32_bf16 v[148:151], v[168:171], v[112:115], v[148:151]
  ds_read_b128 v[208:211], v18 offset:46080
  s_waitcnt vmcnt(2)
  s_waitcnt lgkmcnt(5)
  v_mfma_f32_16x16x32_bf16 v[132:135], v[172:175], v[116:119], v[132:135]
  ds_read_b128 v[152:155], v18 offset:47104
  v_mfma_f32_16x16x32_bf16 v[136:139], v[176:179], v[116:119], v[136:139]
  ds_read_b128 v[156:159], v18 offset:48128
  v_mfma_f32_16x16x32_bf16 v[140:143], v[180:183], v[116:119], v[140:143]
  ds_read_b128 v[160:163], v18 offset:49152
  v_mfma_f32_16x16x32_bf16 v[144:147], v[184:187], v[116:119], v[144:147]
  ds_read_b128 v[164:167], v18 offset:50176
  v_mfma_f32_16x16x32_bf16 v[148:151], v[188:191], v[116:119], v[148:151]
  ds_read_b128 v[168:171], v18 offset:51200
  s_waitcnt lgkmcnt(5)
  v_mfma_f32_16x16x32_bf16 v[132:135], v[192:195], v[120:123], v[132:135]
  ds_read_b128 v[172:175], v18 offset:52224
  v_mfma_f32_16x16x32_bf16 v[136:139], v[196:199], v[120:123], v[136:139]
  ds_read_b128 v[176:179], v18 offset:53248
  v_mfma_f32_16x16x32_bf16 v[140:143], v[200:203], v[120:123], v[140:143]
  ds_read_b128 v[180:183], v18 offset:54272
  v_mfma_f32_16x16x32_bf16 v[144:147], v[204:207], v[120:123], v[144:147]
  ds_read_b128 v[184:187], v18 offset:55296
  v_mfma_f32_16x16x32_bf16 v[148:151], v[208:211], v[120:123], v[148:151]
  ds_read_b128 v[188:191], v18 offset:56320
  s_waitcnt vmcnt(0)
  s_waitcnt lgkmcnt(5)
  v_mfma_f32_16x16x32_bf16 v[132:135], v[152:155], v[124:127], v[132:135]
  v_mfma_f32_16x16x32_bf16 v[136:139], v[156:159], v[124:127], v[136:139]
  v_mfma_f32_16x16x32_bf16 v[140:143], v[160:163], v[124:127], v[140:143]
  v_mfma_f32_16x16x32_bf16 v[144:147], v[164:167], v[124:127], v[144:147]
  v_mfma_f32_16x16x32_bf16 v[148:151], v[168:171], v[124:127], v[148:151]
  s_waitcnt lgkmcnt(0)
  v_mfma_f32_16x16x32_bf16 v[132:135], v[172:175], v[128:131], v[132:135]
  v_mfma_f32_16x16x32_bf16 v[136:139], v[176:179], v[128:131], v[136:139]
  v_mfma_f32_16x16x32_bf16 v[140:143], v[180:183], v[128:131], v[140:143]
  v_mfma_f32_16x16x32_bf16 v[144:147], v[184:187], v[128:131], v[144:147]
  v_mfma_f32_16x16x32_bf16 v[148:151], v[188:191], v[128:131], v[148:151]
  s_nop 3
  v_cmp_u_f32 vcc, v132, v132
  s_cbranch_vccnz kp_redo2
kp_back2:
  v_mov_b32 v160, v34
  v_mov_b32 v161, v34
  v_mov_b32 v162, v36
  v_mov_b32 v163, v36
  v_lshlrev_b32 v152, 16, v24
  v_and_b32 v153, 0xffff0000, v24
  v_lshlrev_b32 v154, 16, v25
  v_and_b32 v155, 0xffff0000, v25
  v_pk_fma_f32 v[152:153], v[152:153], v[160:161], v[162:163]
  v_pk_fma_f32 v[154:155], v[154:155], v[160:161], v[162:163]
  v_pk_add_f32 v[152:153], v[152:153], v[132:133]
  v_pk_add_f32 v[154:155], v[154:155], v[134:135]
  v_cvt_pk_bf16_f32 v34, v152, v153
  v_cvt_pk_bf16_f32 v35, v154, v155
  v_min_u32 v34, -2, v34
  v_min_u32 v35, -2, v35
  v_mov_b32 v52, v34
  v_mov_b32 v53, v35
  v_dot2_f32_bf16 v212, v34, s52, 0
  v_dot2_f32_bf16 v213, v34, v34, 0
  v_dot2_f32_bf16 v212, v35, s52, v212
  v_dot2_f32_bf16 v213, v35, v35, v213
  v_lshlrev_b32 v156, 16, v26
  v_and_b32 v157, 0xffff0000, v26
  v_lshlrev_b32 v158, 16, v27
  v_and_b32 v159, 0xffff0000, v27
  v_pk_fma_f32 v[156:157], v[156:157], v[160:161], v[162:163]
  v_pk_fma_f32 v[158:159], v[158:159], v[160:161], v[162:163]
  v_pk_add_f32 v[156:157], v[156:157], v[136:137]
  v_pk_add_f32 v[158:159], v[158:159], v[138:139]
  v_cvt_pk_bf16_f32 v36, v156, v157
  v_cvt_pk_bf16_f32 v37, v158, v159
  v_min_u32 v36, -2, v36
  v_min_u32 v37, -2, v37
  v_mov_b32 v54, v36
  v_mov_b32 v55, v37
  s_nop 0
  v_permlane16_swap_b32 v52, v54
  v_permlane16_swap_b32 v53, v55
  buffer_store_dwordx4 v[52:55], v48, s[16:19], s57 offen offset:0 sc1
  v_dot2_f32_bf16 v212, v36, s52, v212
  v_dot2_f32_bf16 v213, v36, v36, v213
  v_dot2_f32_bf16 v212, v37, s52, v212
  v_dot2_f32_bf16 v213, v37, v37, v213
  v_lshlrev_b32 v152, 16, v28
  v_and_b32 v153, 0xffff0000, v28
  v_lshlrev_b32 v154, 16, v29
  v_and_b32 v155, 0xffff0000, v29
  v_pk_fma_f32 v[152:153], v[152:153], v[160:161], v[162:163]
  v_pk_fma_f32 v[154:155], v[154:155], v[160:161], v[162:163]
  v_pk_add_f32 v[152:153], v[152:153], v[140:141]
  v_pk_add_f32 v[154:155], v[154:155], v[142:143]
  v_cvt_pk_bf16_f32 v38, v152, v153
  v_cvt_pk_bf16_f32 v39, v154, v155
  v_min_u32 v38, -2, v38
  v_min_u32 v39, -2, v39
  v_mov_b32 v56, v38
  v_mov_b32 v57, v39
  v_dot2_f32_bf16 v212, v38, s52, v212
  v_dot2_f32_bf16 v213, v38, v38, v213
  v_dot2_f32_bf16 v212, v39, s52, v212
  v_dot2_f32_bf16 v213, v39, v39, v213
  v_lshlrev_b32 v156, 16, v30
  v_and_b32 v157, 0xffff0000, v30
  v_lshlrev_b32 v158, 16, v31
  v_and_b32 v159, 0xffff0000, v31
  v_pk_fma_f32 v[156:157], v[156:157], v[160:161], v[162:163]
  v_pk_fma_f32 v[158:159], v[158:159], v[160:161], v[162:163]
  v_pk_add_f32 v[156:157], v[156:157], v[144:145]
  v_pk_add_f32 v[158:159], v[158:159], v[146:147]
  v_cvt_pk_bf16_f32 v40, v156, v157
  v_cvt_pk_bf16_f32 v41, v158, v159
  v_min_u32 v40, -2, v40
  v_min_u32 v41, -2, v41
  v_mov_b32 v58, v40
  v_mov_b32 v59, v41
  s_nop 0
  v_permlane16_swap_b32 v56, v58
  v_permlane16_swap_b32 v57, v59
  buffer_store_dwordx4 v[56:59], v48, s[16:19], s57 offen offset:1024 sc1
  v_dot2_f32_bf16 v212, v40, s52, v212
  v_dot2_f32_bf16 v213, v40, v40, v213
  v_dot2_f32_bf16 v212, v41, s52, v212
  v_dot2_f32_bf16 v213, v41, v41, v213
  v_lshlrev_b32 v152, 16, v32
  v_and_b32 v153, 0xffff0000, v32
  v_lshlrev_b32 v154, 16, v33
  v_and_b32 v155, 0xffff0000, v33
  v_pk_fma_f32 v[152:153], v[152:153], v[160:161], v[162:163]
  v_pk_fma_f32 v[154:155], v[154:155], v[160:161], v[162:163]
  v_pk_add_f32 v[152:153], v[152:153], v[148:149]
  v_pk_add_f32 v[154:155], v[154:155], v[150:151]
  v_cvt_pk_bf16_f32 v42, v152, v153
  v_cvt_pk_bf16_f32 v43, v154, v155
  v_min_u32 v42, -2, v42
  v_min_u32 v43, -2, v43
  buffer_store_dwordx2 v[42:43], v13, s[16:19], s57 offen offset:2048 sc1
  v_dot2_f32_bf16 v212, v42, s52, v212
  v_dot2_f32_bf16 v213, v42, v42, v213
  v_dot2_f32_bf16 v212, v43, s52, v212
  v_dot2_f32_bf16 v213, v43, v43, v213
  s_nop 1
  v_mov_b32 v1, v212
  v_mov_b32 v2, v213
  s_nop 0
  v_permlane16_swap_b32 v212, v1
  v_permlane16_swap_b32 v213, v2
  v_add_f32 v212, v212, v1
  v_add_f32 v213, v213, v2
  v_mov_b32 v1, v212
  v_mov_b32 v2, v213
  s_nop 0
  v_permlane32_swap_b32 v212, v1
  v_permlane32_swap_b32 v213, v2
  v_add_f32 v212, v212, v1
  v_add_f32 v213, v213, v2
  v_min_u32 v212, -2, v212
  v_min_u32 v213, -2, v213
  s_mov_b64 exec, 0xffff
  buffer_store_dwordx2 v[212:213], v16, s[32:35], s53 offen sc1
  s_mov_b64 exec, -1
  s_barrier
  s_add_u32 s8, s6, 0xfc0000
  s_addc_u32 s9, s7, 0
  s_mov_b32 s10, 0x280000
  s_mov_b32 s11, 0x00020000
  s_mul_i32 s58, s48, 20480
  v_and_b32 v1, 7, v0
  v_lshlrev_b32 v45, 2, v1
  s_lshr_b32 s43, s48, 2
  s_lshl_b32 s43, s43, 6
  s_add_u32 s43, s43, 16384
  v_add_u32 v45, s43, v45
  s_add_u32 s24, s6, 0xfa0000
  s_addc_u32 s25, s7, 0
  s_mov_b32 s26, 0x20000
  s_mov_b32 s27, 0x00020000
  s_lshl_b32 s51, s48, 10
  v_lshlrev_b32 v236, 4, v11
  v_add_u32 v236, 143680, v236
  s_add_u32 s16, s6, 0x1240000
  s_addc_u32 s17, s7, 0
  s_mov_b32 s18, 0x6c0000
  s_mov_b32 s19, 0x00020000
  s_mul_i32 s53, s48, 55296
  s_mul_i32 s44, s49, 3584
  s_add_u32 s53, s53, s44
  s_add_u32 s54, s53, 55296
  s_lshl_b32 s61, s48, 10
  s_lshl_b32 s44, s49, 7
  s_add_u32 s61, s61, s44
  s_add_u32 s61, s61, 131072
  s_mov_b32 s60, 400000
  s_waitcnt vmcnt(0)
kp_probe3:
  s_sub_u32 s60, s60, 1
  s_cbranch_scc1 kp_end
  buffer_load_dwordx2 v[228:229], v15, s[24:27], s51 offen offset:0 sc1
  buffer_load_dwordx2 v[230:231], v15, s[24:27], s51 offen offset:128 sc1
  buffer_load_dwordx2 v[232:233], v15, s[24:27], s51 offen offset:1024 sc1
  buffer_load_dwordx2 v[234:235], v15, s[24:27], s51 offen offset:1152 sc1
  s_lshl_b32 s71, s69, 10
  s_add_u32 s62, s58, s71
  buffer_load_dwordx4 v[52:55], v9, s[8:11], s62 offen offset:0 sc1
  s_add_u32 s63, s62, 20480
  buffer_load_dwordx4 v[56:59], v9, s[8:11], s63 offen offset:0 sc1
  buffer_load_dwordx4 v[60:63], v9, s[8:11], s62 offen offset:1024 sc1
  buffer_load_dwordx4 v[64:67], v9, s[8:11], s63 offen offset:1024 sc1
  s_waitcnt vmcnt(4)
  v_max3_u32 v46, v228, v229, v230
  v_max3_u32 v46, v46, v231, v232
  v_max3_u32 v46, v46, v233, v234
  v_max_u32 v46, v46, v235
  v_cmp_eq_u32 vcc, -1, v46
  s_cbranch_vccnz kp_probe3
kp_go3:
  buffer_load_dwordx4 v[68:71], v9, s[8:11], s62 offen offset:2048 sc1
  buffer_load_dwordx4 v[72:75], v9, s[8:11], s63 offen offset:2048 sc1
  buffer_load_dwordx4 v[76:79], v9, s[8:11], s62 offen offset:3072 sc1
  buffer_load_dwordx4 v[80:83], v9, s[8:11], s63 offen offset:3072 sc1
  s_add_u32 s71, s71, 4096
  s_cmp_ge_u32 s71, 20480
  s_cselect_b32 s71, 0, s71
  s_add_u32 s62, s58, s71
  buffer_load_dwordx4 v[84:87], v9, s[8:11], s62 offen offset:0 sc1
  s_add_u32 s63, s62, 20480
  buffer_load_dwordx4 v[88:91], v9, s[8:11], s63 offen offset:0 sc1
  s_waitcnt vmcnt(6)
  v_max3_u32 v46, v52, v53, v54
  v_max3_u32 v46, v46, v55, v56
  v_max3_u32 v46, v46, v57, v58
  v_max3_u32 v46, v46, v59, v60
  v_max3_u32 v46, v46, v61, v62
  v_max3_u32 v46, v46, v63, v64
  v_max3_u32 v46, v46, v65, v66
  v_max_u32 v46, v46, v67
  v_cmp_eq_u32 vcc, -1, v46
  s_cbranch_vccnz kp_probe3
  s_barrier
  ds_read_b128 v[172:175], v9 offset:0
  ds_read_b128 v[176:179], v9 offset:1024
  ds_read_b128 v[180:183], v9 offset:2048
  ds_read_b128 v[184:187], v9 offset:3072
  ds_read_b128 v[188:191], v9 offset:4096
  ds_read_b128 v[192:195], v9 offset:5120
  ds_read_b128 v[196:199], v9 offset:6144
  s_waitcnt lgkmcnt(5)
  v_mfma_f32_16x16x32_bf16 v[116:119], v[172:175], v[52:55], 0
  v_add_f32 v228, v228, v230
  v_mfma_f32_16x16x32_bf16 v[144:147], v[172:175], v[56:59], 0
  ds_read_b128 v[200:203], v9 offset:7168
  v_mfma_f32_16x16x32_bf16 v[120:123], v[176:179], v[52:55], 0
  v_add_f32 v229, v229, v231
  v_mfma_f32_16x16x32_bf16 v[148:151], v[176:179], v[56:59], 0
  ds_read_b128 v[204:207], v9 offset:8192
  s_waitcnt lgkmcnt(5)
  v_mfma_f32_16x16x32_bf16 v[124:127], v[180:183], v[52:55], 0
  buffer_load_dwordx4 v[92:95], v9, s[8:11], s62 offen offset:1024 sc1
  v_mfma_f32_16x16x32_bf16 v[152:155], v[180:183], v[56:59], 0
  ds_read_b128 v[208:211], v9 offset:9216
  v_mfma_f32_16x16x32_bf16 v[128:131], v[184:187], v[52:55], 0
  v_add_f32 v232, v232, v234
  v_mfma_f32_16x16x32_bf16 v[156:159], v[184:187], v[56:59], 0
  ds_read_b128 v[212:215], v9 offset:10240
  s_waitcnt lgkmcnt(5)
  v_mfma_f32_16x16x32_bf16 v[132:135], v[188:191], v[52:55], 0
  v_add_f32 v233, v233, v235
  v_mfma_f32_16x16x32_bf16 v[160:163], v[188:191], v[56:59], 0
  buffer_load_dwordx4 v[96:99], v9, s[8:11], s63 offen offset:1024 sc1
  ds_read_b128 v[216:219], v9 offset:11264
  v_mfma_f32_16x16x32_bf16 v[136:139], v[192:195], v[52:55], 0
  v_mov_b32 v1, v228
  v_mfma_f32_16x16x32_bf16 v[164:167], v[192:195], v[56:59], 0
  ds_read_b128 v[220:223], v9 offset:12288
  s_waitcnt lgkmcnt(6)
  v_mfma_f32_16x16x32_bf16 v[140:143], v[196:199], v[52:55], 0
  v_mov_b32 v2, v229
  v_mfma_f32_16x16x32_bf16 v[168:171], v[196:199], v[56:59], 0
  ds_read_b128 v[224:227], v9 offset:13312
  s_waitcnt lgkmcnt(5)
  v_mfma_f32_16x16x32_bf16 v[116:119], v[200:203], v[60:63], v[116:119]
  buffer_load_dwordx4 v[100:103], v9, s[8:11], s62 offen offset:2048 sc1
  v_mfma_f32_16x16x32_bf16 v[144:147], v[200:203], v[64:67], v[144:147]
  ds_read_b128 v[172:175], v9 offset:14336
  v_mfma_f32_16x16x32_bf16 v[120:123], v[204:207], v[60:63], v[120:123]
  v_mov_b32 v3, v232
  v_mfma_f32_16x16x32_bf16 v[148:151], v[204:207], v[64:67], v[148:151]
  ds_read_b128 v[176:179], v9 offset:15360
  s_waitcnt lgkmcnt(5)
  v_mfma_f32_16x16x32_bf16 v[124:127], v[208:211], v[60:63], v[124:127]
  v_mov_b32 v4, v233
  v_mfma_f32_16x16x32_bf16 v[152:155], v[208:211], v[64:67], v[152:155]
  buffer_load_dwordx4 v[104:107], v9, s[8:11], s63 offen offset:2048 sc1
  ds_read_b128 v[180:183], v9 offset:16384
  v_mfma_f32_16x16x32_bf16 v[128:131], v[212:215], v[60:63], v[128:131]
  v_permlane16_swap_b32 v228, v1
  v_mfma_f32_16x16x32_bf16 v[156:159], v[212:215], v[64:67], v[156:159]
  ds_read_b128 v[184:187], v9 offset:17408
  s_waitcnt lgkmcnt(5)
  v_mfma_f32_16x16x32_bf16 v[132:135], v[216:219], v[60:63], v[132:135]
  v_permlane16_swap_b32 v229, v2
  v_mfma_f32_16x16x32_bf16 v[160:163], v[216:219], v[64:67], v[160:163]
  ds_read_b128 v[188:191], v9 offset:18432
  v_mfma_f32_16x16x32_bf16 v[136:139], v[220:223], v[60:63], v[136:139]
  buffer_load_dwordx4 v[108:111], v9, s[8:11], s62 offen offset:3072 sc1
  v_mfma_f32_16x16x32_bf16 v[164:167], v[220:223], v[64:67], v[164:167]
  ds_read_b128 v[192:195], v9 offset:19456
  s_waitcnt lgkmcnt(6)
  v_mfma_f32_16x16x32_bf16 v[140:143], v[224:227], v[60:63], v[140:143]
  v_permlane16_swap_b32 v232, v3
  v_mfma_f32_16x16x32_bf16 v[168:171], v[224:227], v[64:67], v[168:171]
  ds_read_b128 v[196:199], v9 offset:20480
  s_waitcnt vmcnt(9)
  s_waitcnt lgkmcnt(5)
  v_mfma_f32_16x16x32_bf16 v[116:119], v[172:175], v[68:71], v[116:119]
  v_permlane16_swap_b32 v233, v4
  v_mfma_f32_16x16x32_bf16 v[144:147], v[172:175], v[72:75], v[144:147]
  buffer_load_dwordx4 v[112:115], v9, s[8:11], s63 offen offset:3072 sc1
  ds_read_b128 v[200:203], v9 offset:21504
  v_mfma_f32_16x16x32_bf16 v[120:123], v[176:179], v[68:71], v[120:123]
  v_add_f32 v228, v228, v1
  v_mfma_f32_16x16x32_bf16 v[148:151], v[176:179], v[72:75], v[148:151]
  ds_read_b128 v[204:207], v9 offset:22528
  s_waitcnt lgkmcnt(5)
  v_mfma_f32_16x16x32_bf16 v[124:127], v[180:183], v[68:71], v[124:127]
  v_add_f32 v229, v229, v2
  v_mfma_f32_16x16x32_bf16 v[152:155], v[180:183], v[72:75], v[152:155]
  ds_read_b128 v[208:211], v9 offset:23552
  v_mfma_f32_16x16x32_bf16 v[128:131], v[184:187], v[68:71], v[128:131]
  s_add_u32 s71, s71, 4096
  s_cmp_ge_u32 s71, 20480
  s_cselect_b32 s71, 0, s71
  s_add_u32 s62, s58, s71
  buffer_load_dwordx4 v[52:55], v9, s[8:11], s62 offen offset:0 sc1
  v_mfma_f32_16x16x32_bf16 v[156:159], v[184:187], v[72:75], v[156:159]
  ds_read_b128 v[212:215], v9 offset:24576
  s_waitcnt lgkmcnt(5)
  v_mfma_f32_16x16x32_bf16 v[132:135], v[188:191], v[68:71], v[132:135]
  v_add_f32 v232, v232, v3
  v_mfma_f32_16x16x32_bf16 v[160:163], v[188:191], v[72:75], v[160:163]
  ds_read_b128 v[216:219], v9 offset:25600
  v_mfma_f32_16x16x32_bf16 v[136:139], v[192:195], v[68:71], v[136:139]
  v_add_f32 v233, v233, v4
  v_mfma_f32_16x16x32_bf16 v[164:167], v[192:195], v[72:75], v[164:167]
  s_add_u32 s63, s62, 20480
  buffer_load_dwordx4 v[56:59], v9, s[8:11], s63 offen offset:0 sc1
  ds_read_b128 v[220:223], v9 offset:26624
  s_waitcnt lgkmcnt(6)
  v_mfma_f32_16x16x32_bf16 v[140:143], v[196:199], v[68:71], v[140:143]
  v_mov_b32 v1, v228
  v_mfma_f32_16x16x32_bf16 v[168:171], v[196:199], v[72:75], v[168:171]
  ds_read_b128 v[224:227], v9 offset:27648
  s_waitcnt vmcnt(10)
  s_waitcnt lgkmcnt(5)
  v_mfma_f32_16x16x32_bf16 v[116:119], v[200:203], v[76:79], v[116:119]
  v_mov_b32 v2, v229
  v_mfma_f32_16x16x32_bf16 v[144:147], v[200:203], v[80:83], v[144:147]
  ds_read_b128 v[172:175], v9 offset:28672
  v_mfma_f32_16x16x32_bf16 v[120:123], v[204:207], v[76:79], v[120:123]
  buffer_load_dwordx4 v[60:63], v9, s[8:11], s62 offen offset:1024 sc1
  v_mfma_f32_16x16x32_bf16 v[148:151], v[204:207], v[80:83], v[148:151]
  ds_read_b128 v[176:179], v9 offset:29696
  s_waitcnt lgkmcnt(5)
  v_mfma_f32_16x16x32_bf16 v[124:127], v[208:211], v[76:79], v[124:127]
  v_mov_b32 v3, v232
  v_mfma_f32_16x16x32_bf16 v[152:155], v[208:211], v[80:83], v[152:155]
  ds_read_b128 v[180:183], v9 offset:30720
  v_mfma_f32_16x16x32_bf16 v[128:131], v[212:215], v[76:79], v[128:131]
  v_mov_b32 v4, v233
  v_mfma_f32_16x16x32_bf16 v[156:159], v[212:215], v[80:83], v[156:159]
  buffer_load_dwordx4 v[64:67], v9, s[8:11], s63 offen offset:1024 sc1
  ds_read_b128 v[184:187], v9 offset:31744
  s_waitcnt lgkmcnt(5)
  v_mfma_f32_16x16x32_bf16 v[132:135], v[216:219], v[76:79], v[132:135]
  v_permlane32_swap_b32 v228, v1
  v_mfma_f32_16x16x32_bf16 v[160:163], v[216:219], v[80:83], v[160:163]
  ds_read_b128 v[188:191], v9 offset:32768
  v_mfma_f32_16x16x32_bf16 v[136:139], v[220:223], v[76:79], v[136:139]
  v_permlane32_swap_b32 v229, v2
  v_mfma_f32_16x16x32_bf16 v[164:167], v[220:223], v[80:83], v[164:167]
  ds_read_b128 v[192:195], v9 offset:33792
  s_waitcnt lgkmcnt(6)
  v_mfma_f32_16x16x32_bf16 v[140:143], v[224:227], v[76:79], v[140:143]
  buffer_load_dwordx4 v[68:71], v9, s[8:11], s62 offen offset:2048 sc1
  v_mfma_f32_16x16x32_bf16 v[168:171], v[224:227], v[80:83], v[168:171]
  ds_read_b128 v[196:199], v9 offset:34816
  s_waitcnt vmcnt(11)
  s_waitcnt lgkmcnt(5)
  v_mfma_f32_16x16x32_bf16 v[116:119], v[172:175], v[84:87], v[116:119]
  v_permlane32_swap_b32 v232, v3
  v_mfma_f32_16x16x32_bf16 v[144:147], v[172:175], v[88:91], v[144:147]
  ds_read_b128 v[200:203], v9 offset:35840
  v_mfma_f32_16x16x32_bf16 v[120:123], v[176:179], v[84:87], v[120:123]
  v_permlane32_swap_b32 v233, v4
  v_mfma_f32_16x16x32_bf16 v[148:151], v[176:179], v[88:91], v[148:151]
  buffer_load_dwordx4 v[72:75], v9, s[8:11], s63 offen offset:2048 sc1
  ds_read_b128 v[204:207], v9 offset:36864
  s_waitcnt lgkmcnt(5)
  v_mfma_f32_16x16x32_bf16 v[124:127], v[180:183], v[84:87], v[124:127]
  v_add_f32 v228, v228, v1
  v_mfma_f32_16x16x32_bf16 v[152:155], v[180:183], v[88:91], v[152:155]
  ds_read_b128 v[208:211], v9 offset:37888
  v_mfma_f32_16x16x32_bf16 v[128:131], v[184:187], v[84:87], v[128:131]
  v_add_f32 v229, v229, v2
  v_mfma_f32_16x16x32_bf16 v[156:159], v[184:187], v[88:91], v[156:159]
  ds_read_b128 v[212:215], v9 offset:38912
  s_waitcnt lgkmcnt(5)
  v_mfma_f32_16x16x32_bf16 v[132:135], v[188:191], v[84:87], v[132:135]
  buffer_load_dwordx4 v[76:79], v9, s[8:11], s62 offen offset:3072 sc1
  v_mfma_f32_16x16x32_bf16 v[160:163], v[188:191], v[88:91], v[160:163]
  ds_read_b128 v[216:219], v9 offset:39936
  v_mfma_f32_16x16x32_bf16 v[136:139], v[192:195], v[84:87], v[136:139]
  v_add_f32 v232, v232, v3
  v_mfma_f32_16x16x32_bf16 v[164:167], v[192:195], v[88:91], v[164:167]
  ds_read_b128 v[220:223], v9 offset:40960
  s_waitcnt lgkmcnt(6)
  v_mfma_f32_16x16x32_bf16 v[140:143], v[196:199], v[84:87], v[140:143]
  v_add_f32 v233, v233, v4
  v_mfma_f32_16x16x32_bf16 v[168:171], v[196:199], v[88:91], v[168:171]
  buffer_load_dwordx4 v[80:83], v9, s[8:11], s63 offen offset:3072 sc1
  ds_read_b128 v[224:227], v9 offset:41984
  s_waitcnt vmcnt(12)
  s_waitcnt lgkmcnt(5)
  v_mfma_f32_16x16x32_bf16 v[116:119], v[200:203], v[92:95], v[116:119]
  v_mul_f32 v228, 0x3acccccd, v228
  v_mfma_f32_16x16x32_bf16 v[144:147], v[200:203], v[96:99], v[144:147]
  ds_read_b128 v[172:175], v9 offset:43008
  v_mfma_f32_16x16x32_bf16 v[120:123], v[204:207], v[92:95], v[120:123]
  v_mul_f32 v229, 0x3acccccd, v229
  v_mfma_f32_16x16x32_bf16 v[148:151], v[204:207], v[96:99], v[148:151]
  ds_read_b128 v[176:179], v9 offset:44032
  s_waitcnt lgkmcnt(5)
  v_mfma_f32_16x16x32_bf16 v[124:127], v[208:211], v[92:95], v[124:127]
  s_add_u32 s71, s71, 4096
  s_cmp_ge_u32 s71, 20480
  s_cselect_b32 s71, 0, s71
  s_add_u32 s62, s58, s71
  buffer_load_dwordx4 v[84:87], v9, s[8:11], s62 offen offset:0 sc1
  v_mfma_f32_16x16x32_bf16 v[152:155], v[208:211], v[96:99], v[152:155]
  ds_read_b128 v[180:183], v9 offset:45056
  v_mfma_f32_16x16x32_bf16 v[128:131], v[212:215], v[92:95], v[128:131]
  v_fma_f32 v229, -v228, v228, v229
  v_mfma_f32_16x16x32_bf16 v[156:159], v[212:215], v[96:99], v[156:159]
  ds_read_b128 v[184:187], v9 offset:46080
  s_waitcnt lgkmcnt(5)
  v_mfma_f32_16x16x32_bf16 v[132:135], v[216:219], v[92:95], v[132:135]
  v_max_f32 v229, 0, v229
  v_mfma_f32_16x16x32_bf16 v[160:163], v[216:219], v[96:99], v[160:163]
  s_add_u32 s63, s62, 20480
  buffer_load_dwordx4 v[88:91], v9, s[8:11], s63 offen offset:0 sc1
  ds_read_b128 v[188:191], v9 offset:47104
  v_mfma_f32_16x16x32_bf16 v[136:139], v[220:223], v[92:95], v[136:139]
  v_add_f32 v230, 0x3727c5ac, v229
  v_mfma_f32_16x16x32_bf16 v[164:167], v[220:223], v[96:99], v[164:167]
  ds_read_b128 v[192:195], v9 offset:48128
  s_waitcnt lgkmcnt(6)
  v_mfma_f32_16x16x32_bf16 v[140:143], v[224:227], v[92:95], v[140:143]
  v_rsq_f32 v230, v230
  v_mfma_f32_16x16x32_bf16 v[168:171], v[224:227], v[96:99], v[168:171]
  ds_read_b128 v[196:199], v9 offset:49152
  s_waitcnt vmcnt(12)
  s_waitcnt lgkmcnt(5)
  v_mfma_f32_16x16x32_bf16 v[116:119], v[172:175], v[100:103], v[116:119]
  buffer_load_dwordx4 v[92:95], v9, s[8:11], s62 offen offset:1024 sc1
  v_mfma_f32_16x16x32_bf16 v[144:147], v[172:175], v[104:107], v[144:147]
  ds_read_b128 v[200:203], v9 offset:50176
  v_mfma_f32_16x16x32_bf16 v[120:123], v[176:179], v[100:103], v[120:123]
  v_sub_f32 v238, 0, v228
  v_mfma_f32_16x16x32_bf16 v[148:151], v[176:179], v[104:107], v[148:151]
  ds_read_b128 v[204:207], v9 offset:51200
  s_waitcnt lgkmcnt(5)
  v_mfma_f32_16x16x32_bf16 v[124:127], v[180:183], v[100:103], v[124:127]
  v_mul_f32 v240, 0xc0135761, v230
  v_mfma_f32_16x16x32_bf16 v[152:155], v[180:183], v[104:107], v[152:155]
  buffer_load_dwordx4 v[96:99], v9, s[8:11], s63 offen offset:1024 sc1
  ds_read_b128 v[208:211], v9 offset:52224
  v_mfma_f32_16x16x32_bf16 v[128:131], v[184:187], v[100:103], v[128:131]
  v_mul_f32 v231, v230, v230
  v_mfma_f32_16x16x32_bf16 v[156:159], v[184:187], v[104:107], v[156:159]
  ds_read_b128 v[212:215], v9 offset:53248
  s_waitcnt lgkmcnt(5)
  v_mfma_f32_16x16x32_bf16 v[132:135], v[188:191], v[100:103], v[132:135]
  v_mul_f32 v242, 0x3d372713, v231
  v_mfma_f32_16x16x32_bf16 v[160:163], v[188:191], v[104:107], v[160:163]
  ds_read_b128 v[216:219], v9 offset:54272
  v_mfma_f32_16x16x32_bf16 v[136:139], v[192:195], v[100:103], v[136:139]
  v_mfma_f32_16x16x32_bf16 v[164:167], v[192:195], v[104:107], v[164:167]
  ds_read_b128 v[220:223], v9 offset:55296
  s_waitcnt lgkmcnt(6)
  v_mfma_f32_16x16x32_bf16 v[140:143], v[196:199], v[100:103], v[140:143]
  v_mul_f32 v242, v242, v240
  v_mfma_f32_16x16x32_bf16 v[168:171], v[196:199], v[104:107], v[168:171]
  ds_read_b128 v[224:227], v9 offset:56320
  s_waitcnt vmcnt(12)
  s_waitcnt lgkmcnt(5)
  v_mfma_f32_16x16x32_bf16 v[116:119], v[200:203], v[108:111], v[116:119]
  v_rcp_f32 v244, v230
  v_mfma_f32_16x16x32_bf16 v[144:147], v[200:203], v[112:115], v[144:147]
  buffer_load_dwordx4 v[100:103], v9, s[8:11], s62 offen offset:2048 sc1
  s_barrier
  ds_read_b128 v[172:175], v9 offset:57344
  v_mfma_f32_16x16x32_bf16 v[120:123], v[204:207], v[108:111], v[120:123]
  v_mov_b32 v239, v238
  v_mfma_f32_16x16x32_bf16 v[148:151], v[204:207], v[112:115], v[148:151]
  ds_read_b128 v[176:179], v9 offset:58368
  s_waitcnt lgkmcnt(5)
  v_mfma_f32_16x16x32_bf16 v[124:127], v[208:211], v[108:111], v[124:127]
  v_mov_b32 v241, v240
  v_mfma_f32_16x16x32_bf16 v[152:155], v[208:211], v[112:115], v[152:155]
  ds_read_b128 v[180:183], v9 offset:59392
  v_mfma_f32_16x16x32_bf16 v[128:131], v[212:215], v[108:111], v[128:131]
  buffer_load_dwordx4 v[104:107], v9, s[8:11], s63 offen offset:2048 sc1
  v_mfma_f32_16x16x32_bf16 v[156:159], v[212:215], v[112:115], v[156:159]
  ds_read_b128 v[184:187], v9 offset:60416
  s_waitcnt lgkmcnt(5)
  v_mfma_f32_16x16x32_bf16 v[132:135], v[216:219], v[108:111], v[132:135]
  v_mov_b32 v243, v242
  v_mfma_f32_16x16x32_bf16 v[160:163], v[216:219], v[112:115], v[160:163]
  ds_read_b128 v[188:191], v9 offset:61440
  v_mfma_f32_16x16x32_bf16 v[136:139], v[220:223], v[108:111], v[136:139]
  v_mov_b32 v245, v244
  v_mfma_f32_16x16x32_bf16 v[164:167], v[220:223], v[112:115], v[164:167]
  ds_read_b128 v[192:195], v9 offset:62464
  s_waitcnt lgkmcnt(6)
  v_mfma_f32_16x16x32_bf16 v[140:143], v[224:227], v[108:111], v[140:143]
  v_mul_f32 v232, 0x3acccccd, v232
  v_mfma_f32_16x16x32_bf16 v[168:171], v[224:227], v[112:115], v[168:171]
  ds_read_b128 v[196:199], v9 offset:63488
  s_waitcnt vmcnt(12)
  s_waitcnt lgkmcnt(5)
  v_mfma_f32_16x16x32_bf16 v[116:119], v[172:175], v[52:55], v[116:119]
  v_mul_f32 v233, 0x3acccccd, v233
  v_mfma_f32_16x16x32_bf16 v[144:147], v[172:175], v[56:59], v[144:147]
  ds_read_b128 v[200:203], v9 offset:64512
  v_mfma_f32_16x16x32_bf16 v[120:123], v[176:179], v[52:55], v[120:123]
  buffer_load_dwordx4 v[108:111], v9, s[8:11], s62 offen offset:3072 sc1
  v_mfma_f32_16x16x32_bf16 v[148:151], v[176:179], v[56:59], v[148:151]
  ds_read_b128 v[204:207], v18 offset:0
  s_waitcnt lgkmcnt(5)
  v_mfma_f32_16x16x32_bf16 v[124:127], v[180:183], v[52:55], v[124:127]
  v_fma_f32 v233, -v232, v232, v233
  v_mfma_f32_16x16x32_bf16 v[152:155], v[180:183], v[56:59], v[152:155]
  ds_read_b128 v[208:211], v18 offset:1024
  v_mfma_f32_16x16x32_bf16 v[128:131], v[184:187], v[52:55], v[128:131]
  v_max_f32 v233, 0, v233
  v_mfma_f32_16x16x32_bf16 v[156:159], v[184:187], v[56:59], v[156:159]
  buffer_load_dwordx4 v[112:115], v9, s[8:11], s63 offen offset:3072 sc1
  ds_read_b128 v[212:215], v18 offset:2048
  s_waitcnt lgkmcnt(5)
  v_mfma_f32_16x16x32_bf16 v[132:135], v[188:191], v[52:55], v[132:135]
  v_add_f32 v234, 0x3727c5ac, v233
  v_mfma_f32_16x16x32_bf16 v[160:163], v[188:191], v[56:59], v[160:163]
  ds_read_b128 v[216:219], v18 offset:3072
  v_mfma_f32_16x16x32_bf16 v[136:139], v[192:195], v[52:55], v[136:139]
  v_rsq_f32 v234, v234
  v_mfma_f32_16x16x32_bf16 v[164:167], v[192:195], v[56:59], v[164:167]
  ds_read_b128 v[220:223], v18 offset:4096
  s_waitcnt lgkmcnt(6)
  v_mfma_f32_16x16x32_bf16 v[140:143], v[196:199], v[52:55], v[140:143]
  v_mfma_f32_16x16x32_bf16 v[168:171], v[196:199], v[56:59], v[168:171]
  ds_read_b128 v[224:227], v18 offset:5120
  s_waitcnt vmcnt(12)
  s_waitcnt lgkmcnt(5)
  v_mfma_f32_16x16x32_bf16 v[116:119], v[200:203], v[60:63], v[116:119]
  v_sub_f32 v246, 0, v232
  v_mfma_f32_16x16x32_bf16 v[144:147], v[200:203], v[64:67], v[144:147]
  ds_read_b128 v[172:175], v18 offset:6144
  v_mfma_f32_16x16x32_bf16 v[120:123], v[204:207], v[60:63], v[120:123]
  v_mul_f32 v248, 0xc0135761, v234
  v_mfma_f32_16x16x32_bf16 v[148:151], v[204:207], v[64:67], v[148:151]
  s_add_u32 s71, s71, 4096
  s_cmp_ge_u32 s71, 20480
  s_cselect_b32 s71, 0, s71
  s_add_u32 s62, s58, s71
  buffer_load_dwordx4 v[52:55], v9, s[8:11], s62 offen offset:0 sc1
  ds_read_b128 v[176:179], v18 offset:7168
  s_waitcnt lgkmcnt(5)
  v_mfma_f32_16x16x32_bf16 v[124:127], v[208:211], v[60:63], v[124:127]
  v_mul_f32 v235, v234, v234
  v_mfma_f32_16x16x32_bf16 v[152:155], v[208:211], v[64:67], v[152:155]
  ds_read_b128 v[180:183], v18 offset:8192
  v_mfma_f32_16x16x32_bf16 v[128:131], v[212:215], v[60:63], v[128:131]
  v_mul_f32 v250, 0x3d372713, v235
  v_mfma_f32_16x16x32_bf16 v[156:159], v[212:215], v[64:67], v[156:159]
  ds_read_b128 v[184:187], v18 offset:9216
  s_waitcnt lgkmcnt(5)
  v_mfma_f32_16x16x32_bf16 v[132:135], v[216:219], v[60:63], v[132:135]
  s_add_u32 s63, s62, 20480
  buffer_load_dwordx4 v[56:59], v9, s[8:11], s63 offen offset:0 sc1
  v_mfma_f32_16x16x32_bf16 v[160:163], v[216:219], v[64:67], v[160:163]
  ds_read_b128 v[188:191], v18 offset:10240
  v_mfma_f32_16x16x32_bf16 v[136:139], v[220:223], v[60:63], v[136:139]
  v_mul_f32 v250, v250, v248
  v_mfma_f32_16x16x32_bf16 v[164:167], v[220:223], v[64:67], v[164:167]
  ds_read_b128 v[192:195], v18 offset:11264
  s_waitcnt lgkmcnt(6)
  v_mfma_f32_16x16x32_bf16 v[140:143], v[224:227], v[60:63], v[140:143]
  v_rcp_f32 v252, v234
  v_mfma_f32_16x16x32_bf16 v[168:171], v[224:227], v[64:67], v[168:171]
  ds_read_b128 v[196:199], v18 offset:12288
  s_waitcnt vmcnt(12)
  s_waitcnt lgkmcnt(5)
  v_mfma_f32_16x16x32_bf16 v[116:119], v[172:175], v[68:71], v[116:119]
  v_mov_b32 v247, v246
  v_mfma_f32_16x16x32_bf16 v[144:147], v[172:175], v[72:75], v[144:147]
  ds_read_b128 v[200:203], v18 offset:13312
  v_mfma_f32_16x16x32_bf16 v[120:123], v[176:179], v[68:71], v[120:123]
  v_mov_b32 v249, v248
  v_mfma_f32_16x16x32_bf16 v[148:151], v[176:179], v[72:75], v[148:151]
  ds_read_b128 v[204:207], v18 offset:14336
  s_waitcnt lgkmcnt(5)
  v_mfma_f32_16x16x32_bf16 v[124:127], v[180:183], v[68:71], v[124:127]
  buffer_load_dwordx4 v[60:63], v9, s[8:11], s62 offen offset:1024 sc1
  v_mfma_f32_16x16x32_bf16 v[152:155], v[180:183], v[72:75], v[152:155]
  ds_read_b128 v[208:211], v18 offset:15360
  v_mfma_f32_16x16x32_bf16 v[128:131], v[184:187], v[68:71], v[128:131]
  v_mov_b32 v251, v250
  v_mfma_f32_16x16x32_bf16 v[156:159], v[184:187], v[72:75], v[156:159]
  ds_read_b128 v[212:215], v18 offset:16384
  s_waitcnt lgkmcnt(5)
  v_mfma_f32_16x16x32_bf16 v[132:135], v[188:191], v[68:71], v[132:135]
  v_mov_b32 v253, v252
  v_mfma_f32_16x16x32_bf16 v[160:163], v[188:191], v[72:75], v[160:163]
  buffer_load_dwordx4 v[64:67], v9, s[8:11], s63 offen offset:1024 sc1
  ds_read_b128 v[216:219], v18 offset:17408
  v_mfma_f32_16x16x32_bf16 v[136:139], v[192:195], v[68:71], v[136:139]
  v_mfma_f32_16x16x32_bf16 v[164:167], v[192:195], v[72:75], v[164:167]
  ds_read_b128 v[220:223], v18 offset:18432
  s_waitcnt lgkmcnt(6)
  v_mfma_f32_16x16x32_bf16 v[140:143], v[196:199], v[68:71], v[140:143]
  v_mfma_f32_16x16x32_bf16 v[168:171], v[196:199], v[72:75], v[168:171]
  ds_read_b128 v[224:227], v18 offset:19456
  s_waitcnt vmcnt(12)
  s_waitcnt lgkmcnt(5)
  v_mfma_f32_16x16x32_bf16 v[116:119], v[200:203], v[76:79], v[116:119]
  buffer_load_dwordx4 v[68:71], v9, s[8:11], s62 offen offset:2048 sc1
  v_mfma_f32_16x16x32_bf16 v[144:147], v[200:203], v[80:83], v[144:147]
  s_barrier
  ds_read_b128 v[172:175], v18 offset:49152
  v_mfma_f32_16x16x32_bf16 v[120:123], v[204:207], v[76:79], v[120:123]
  v_mfma_f32_16x16x32_bf16 v[148:151], v[204:207], v[80:83], v[148:151]
  ds_read_b128 v[176:179], v18 offset:50176
  s_waitcnt lgkmcnt(5)
  v_mfma_f32_16x16x32_bf16 v[124:127], v[208:211], v[76:79], v[124:127]
  v_mfma_f32_16x16x32_bf16 v[152:155], v[208:211], v[80:83], v[152:155]
  buffer_load_dwordx4 v[72:75], v9, s[8:11], s63 offen offset:2048 sc1
  ds_read_b128 v[180:183], v18 offset:51200
  v_mfma_f32_16x16x32_bf16 v[128:131], v[212:215], v[76:79], v[128:131]
  v_mfma_f32_16x16x32_bf16 v[156:159], v[212:215], v[80:83], v[156:159]
  ds_read_b128 v[184:187], v18 offset:52224
  s_waitcnt lgkmcnt(5)
  v_mfma_f32_16x16x32_bf16 v[132:135], v[216:219], v[76:79], v[132:135]
  v_mfma_f32_16x16x32_bf16 v[160:163], v[216:219], v[80:83], v[160:163]
  ds_read_b128 v[188:191], v18 offset:53248
  v_mfma_f32_16x16x32_bf16 v[136:139], v[220:223], v[76:79], v[136:139]
  v_mfma_f32_16x16x32_bf16 v[164:167], v[220:223], v[80:83], v[164:167]
  ds_read_b128 v[192:195], v18 offset:54272
  s_waitcnt lgkmcnt(6)
  v_mfma_f32_16x16x32_bf16 v[140:143], v[224:227], v[76:79], v[140:143]
  v_mfma_f32_16x16x32_bf16 v[168:171], v[224:227], v[80:83], v[168:171]
  ds_read_b128 v[196:199], v18 offset:55296
  s_waitcnt vmcnt(12)
  s_waitcnt lgkmcnt(5)
  v_mfma_f32_16x16x32_bf16 v[116:119], v[172:175], v[84:87], v[116:119]
  v_mfma_f32_16x16x32_bf16 v[144:147], v[172:175], v[88:91], v[144:147]
  buffer_load_dwordx4 v[76:79], v9, s[8:11], s62 offen offset:3072 sc1
  ds_read_b128 v[200:203], v18 offset:56320
  v_mfma_f32_16x16x32_bf16 v[120:123], v[176:179], v[84:87], v[120:123]
  v_mfma_f32_16x16x32_bf16 v[148:151], v[176:179], v[88:91], v[148:151]
  ds_read_b128 v[204:207], v18 offset:57344
  s_waitcnt lgkmcnt(5)
  v_mfma_f32_16x16x32_bf16 v[124:127], v[180:183], v[84:87], v[124:127]
  v_mfma_f32_16x16x32_bf16 v[152:155], v[180:183], v[88:91], v[152:155]
  ds_read_b128 v[208:211], v18 offset:58368
  v_mfma_f32_16x16x32_bf16 v[128:131], v[184:187], v[84:87], v[128:131]
  buffer_load_dwordx4 v[80:83], v9, s[8:11], s63 offen offset:3072 sc1
  v_mfma_f32_16x16x32_bf16 v[156:159], v[184:187], v[88:91], v[156:159]
  ds_read_b128 v[212:215], v18 offset:59392
  s_waitcnt lgkmcnt(5)
  v_mfma_f32_16x16x32_bf16 v[132:135], v[188:191], v[84:87], v[132:135]
  v_mfma_f32_16x16x32_bf16 v[160:163], v[188:191], v[88:91], v[160:163]
  ds_read_b128 v[216:219], v18 offset:60416
  v_mfma_f32_16x16x32_bf16 v[136:139], v[192:195], v[84:87], v[136:139]
  v_mfma_f32_16x16x32_bf16 v[164:167], v[192:195], v[88:91], v[164:167]
  ds_read_b128 v[220:223], v18 offset:61440
  s_waitcnt lgkmcnt(6)
  v_mfma_f32_16x16x32_bf16 v[140:143], v[196:199], v[84:87], v[140:143]
  v_mfma_f32_16x16x32_bf16 v[168:171], v[196:199], v[88:91], v[168:171]
  ds_read_b128 v[224:227], v18 offset:62464
  s_waitcnt vmcnt(12)
  s_waitcnt lgkmcnt(5)
  v_mfma_f32_16x16x32_bf16 v[116:119], v[200:203], v[92:95], v[116:119]
  v_mfma_f32_16x16x32_bf16 v[144:147], v[200:203], v[96:99], v[144:147]
  ds_read_b128 v[172:175], v18 offset:63488
  v_mfma_f32_16x16x32_bf16 v[120:123], v[204:207], v[92:95], v[120:123]
  v_mfma_f32_16x16x32_bf16 v[148:151], v[204:207], v[96:99], v[148:151]
  ds_read_b128 v[176:179], v18 offset:64512
  s_waitcnt lgkmcnt(5)
  v_mfma_f32_16x16x32_bf16 v[124:127], v[208:211], v[92:95], v[124:127]
  v_mfma_f32_16x16x32_bf16 v[152:155], v[208:211], v[96:99], v[152:155]
  ds_read_b128 v[180:183], v19 offset:0
  v_mfma_f32_16x16x32_bf16 v[128:131], v[212:215], v[92:95], v[128:131]
  v_mfma_f32_16x16x32_bf16 v[156:159], v[212:215], v[96:99], v[156:159]
  ds_read_b128 v[184:187], v19 offset:1024
  s_waitcnt lgkmcnt(5)
  v_mfma_f32_16x16x32_bf16 v[132:135], v[216:219], v[92:95], v[132:135]
  v_mfma_f32_16x16x32_bf16 v[160:163], v[216:219], v[96:99], v[160:163]
  ds_read_b128 v[188:191], v19 offset:2048
  v_mfma_f32_16x16x32_bf16 v[136:139], v[220:223], v[92:95], v[136:139]
  v_mfma_f32_16x16x32_bf16 v[164:167], v[220:223], v[96:99], v[164:167]
  ds_read_b128 v[192:195], v19 offset:3072
  s_waitcnt lgkmcnt(6)
  v_mfma_f32_16x16x32_bf16 v[140:143], v[224:227], v[92:95], v[140:143]
  v_mfma_f32_16x16x32_bf16 v[168:171], v[224:227], v[96:99], v[168:171]
  ds_read_b128 v[196:199], v19 offset:4096
  s_waitcnt vmcnt(10)
  s_waitcnt lgkmcnt(5)
  v_mfma_f32_16x16x32_bf16 v[116:119], v[172:175], v[100:103], v[116:119]
  v_mfma_f32_16x16x32_bf16 v[144:147], v[172:175], v[104:107], v[144:147]
  ds_read_b128 v[200:203], v19 offset:5120
  v_mfma_f32_16x16x32_bf16 v[120:123], v[176:179], v[100:103], v[120:123]
  v_mfma_f32_16x16x32_bf16 v[148:151], v[176:179], v[104:107], v[148:151]
  ds_read_b128 v[204:207], v19 offset:6144
  s_waitcnt lgkmcnt(5)
  v_mfma_f32_16x16x32_bf16 v[124:127], v[180:183], v[100:103], v[124:127]
  v_mfma_f32_16x16x32_bf16 v[152:155], v[180:183], v[104:107], v[152:155]
  ds_read_b128 v[208:211], v19 offset:7168
  v_mfma_f32_16x16x32_bf16 v[128:131], v[184:187], v[100:103], v[128:131]
  v_mfma_f32_16x16x32_bf16 v[156:159], v[184:187], v[104:107], v[156:159]
  ds_read_b128 v[212:215], v19 offset:8192
  s_waitcnt lgkmcnt(5)
  v_mfma_f32_16x16x32_bf16 v[132:135], v[188:191], v[100:103], v[132:135]
  v_mfma_f32_16x16x32_bf16 v[160:163], v[188:191], v[104:107], v[160:163]
  ds_read_b128 v[216:219], v19 offset:9216
  v_mfma_f32_16x16x32_bf16 v[136:139], v[192:195], v[100:103], v[136:139]
  v_mfma_f32_16x16x32_bf16 v[164:167], v[192:195], v[104:107], v[164:167]
  ds_read_b128 v[220:223], v19 offset:10240
  s_waitcnt lgkmcnt(6)
  v_mfma_f32_16x16x32_bf16 v[140:143], v[196:199], v[100:103], v[140:143]
  v_mfma_f32_16x16x32_bf16 v[168:171], v[196:199], v[104:107], v[168:171]
  ds_read_b128 v[224:227], v19 offset:11264
  s_waitcnt vmcnt(8)
  s_waitcnt lgkmcnt(5)
  v_mfma_f32_16x16x32_bf16 v[116:119], v[200:203], v[108:111], v[116:119]
  v_mfma_f32_16x16x32_bf16 v[144:147], v[200:203], v[112:115], v[144:147]
  s_barrier
  ds_read_b128 v[172:175], v18 offset:20480
  v_mfma_f32_16x16x32_bf16 v[120:123], v[204:207], v[108:111], v[120:123]
  v_mfma_f32_16x16x32_bf16 v[148:151], v[204:207], v[112:115], v[148:151]
  ds_read_b128 v[176:179], v18 offset:21504
  s_waitcnt lgkmcnt(5)
  v_mfma_f32_16x16x32_bf16 v[124:127], v[208:211], v[108:111], v[124:127]
  v_mfma_f32_16x16x32_bf16 v[152:155], v[208:211], v[112:115], v[152:155]
  ds_read_b128 v[180:183], v18 offset:22528
  v_mfma_f32_16x16x32_bf16 v[128:131], v[212:215], v[108:111], v[128:131]
  v_mfma_f32_16x16x32_bf16 v[156:159], v[212:215], v[112:115], v[156:159]
  ds_read_b128 v[184:187], v18 offset:23552
  s_waitcnt lgkmcnt(5)
  v_mfma_f32_16x16x32_bf16 v[132:135], v[216:219], v[108:111], v[132:135]
  v_mfma_f32_16x16x32_bf16 v[160:163], v[216:219], v[112:115], v[160:163]
  ds_read_b128 v[188:191], v18 offset:24576
  v_mfma_f32_16x16x32_bf16 v[136:139], v[220:223], v[108:111], v[136:139]
  v_mfma_f32_16x16x32_bf16 v[164:167], v[220:223], v[112:115], v[164:167]
  ds_read_b128 v[192:195], v18 offset:25600
  s_waitcnt lgkmcnt(6)
  v_mfma_f32_16x16x32_bf16 v[140:143], v[224:227], v[108:111], v[140:143]
  v_mfma_f32_16x16x32_bf16 v[168:171], v[224:227], v[112:115], v[168:171]
  ds_read_b128 v[196:199], v18 offset:26624
  s_waitcnt vmcnt(6)
  s_waitcnt lgkmcnt(5)
  v_mfma_f32_16x16x32_bf16 v[116:119], v[172:175], v[52:55], v[116:119]
  v_mfma_f32_16x16x32_bf16 v[144:147], v[172:175], v[56:59], v[144:147]
  ds_read_b128 v[200:203], v18 offset:27648
  v_mfma_f32_16x16x32_bf16 v[120:123], v[176:179], v[52:55], v[120:123]
  v_mfma_f32_16x16x32_bf16 v[148:151], v[176:179], v[56:59], v[148:151]
  ds_read_b128 v[204:207], v18 offset:28672
  s_waitcnt lgkmcnt(5)
  v_mfma_f32_16x16x32_bf16 v[124:127], v[180:183], v[52:55], v[124:127]
  v_mfma_f32_16x16x32_bf16 v[152:155], v[180:183], v[56:59], v[152:155]
  ds_read_b128 v[208:211], v18 offset:29696
  v_mfma_f32_16x16x32_bf16 v[128:131], v[184:187], v[52:55], v[128:131]
  v_mfma_f32_16x16x32_bf16 v[156:159], v[184:187], v[56:59], v[156:159]
  ds_read_b128 v[212:215], v18 offset:30720
  s_waitcnt lgkmcnt(5)
  v_mfma_f32_16x16x32_bf16 v[132:135], v[188:191], v[52:55], v[132:135]
  v_mfma_f32_16x16x32_bf16 v[160:163], v[188:191], v[56:59], v[160:163]
  ds_read_b128 v[216:219], v18 offset:31744
  v_mfma_f32_16x16x32_bf16 v[136:139], v[192:195], v[52:55], v[136:139]
  v_mfma_f32_16x16x32_bf16 v[164:167], v[192:195], v[56:59], v[164:167]
  ds_read_b128 v[220:223], v18 offset:32768
  s_waitcnt lgkmcnt(6)
  v_mfma_f32_16x16x32_bf16 v[140:143], v[196:199], v[52:55], v[140:143]
  v_mfma_f32_16x16x32_bf16 v[168:171], v[196:199], v[56:59], v[168:171]
  ds_read_b128 v[224:227], v18 offset:33792
  s_waitcnt vmcnt(4)
  s_waitcnt lgkmcnt(5)
  v_mfma_f32_16x16x32_bf16 v[116:119], v[200:203], v[60:63], v[116:119]
  v_mfma_f32_16x16x32_bf16 v[144:147], v[200:203], v[64:67], v[144:147]
  ds_read_b128 v[172:175], v18 offset:34816
  v_mfma_f32_16x16x32_bf16 v[120:123], v[204:207], v[60:63], v[120:123]
  v_mfma_f32_16x16x32_bf16 v[148:151], v[204:207], v[64:67], v[148:151]
  ds_read_b128 v[176:179], v18 offset:35840
  s_waitcnt lgkmcnt(5)
  v_mfma_f32_16x16x32_bf16 v[124:127], v[208:211], v[60:63], v[124:127]
  v_mfma_f32_16x16x32_bf16 v[152:155], v[208:211], v[64:67], v[152:155]
  ds_read_b128 v[180:183], v18 offset:36864
  v_mfma_f32_16x16x32_bf16 v[128:131], v[212:215], v[60:63], v[128:131]
  v_mfma_f32_16x16x32_bf16 v[156:159], v[212:215], v[64:67], v[156:159]
  ds_read_b128 v[184:187], v18 offset:37888
  s_waitcnt lgkmcnt(5)
  v_mfma_f32_16x16x32_bf16 v[132:135], v[216:219], v[60:63], v[132:135]
  v_mfma_f32_16x16x32_bf16 v[160:163], v[216:219], v[64:67], v[160:163]
  ds_read_b128 v[188:191], v18 offset:38912
  v_mfma_f32_16x16x32_bf16 v[136:139], v[220:223], v[60:63], v[136:139]
  v_mfma_f32_16x16x32_bf16 v[164:167], v[220:223], v[64:67], v[164:167]
  ds_read_b128 v[192:195], v18 offset:39936
  s_waitcnt lgkmcnt(6)
  v_mfma_f32_16x16x32_bf16 v[140:143], v[224:227], v[60:63], v[140:143]
  v_mfma_f32_16x16x32_bf16 v[168:171], v[224:227], v[64:67], v[168:171]
  ds_read_b128 v[196:199], v18 offset:40960
  s_waitcnt vmcnt(2)
  s_waitcnt lgkmcnt(5)
  v_mfma_f32_16x16x32_bf16 v[116:119], v[172:175], v[68:71], v[116:119]
  v_mfma_f32_16x16x32_bf16 v[144:147], v[172:175], v[72:75], v[144:147]
  ds_read_b128 v[200:203], v18 offset:41984
  v_mfma_f32_16x16x32_bf16 v[120:123], v[176:179], v[68:71], v[120:123]
  v_mfma_f32_16x16x32_bf16 v[148:151], v[176:179], v[72:75], v[148:151]
  ds_read_b128 v[204:207], v18 offset:43008
  s_waitcnt lgkmcnt(5)
  v_mfma_f32_16x16x32_bf16 v[124:127], v[180:183], v[68:71], v[124:127]
  v_mfma_f32_16x16x32_bf16 v[152:155], v[180:183], v[72:75], v[152:155]
  ds_read_b128 v[208:211], v18 offset:44032
  v_mfma_f32_16x16x32_bf16 v[128:131], v[184:187], v[68:71], v[128:131]
  v_mfma_f32_16x16x32_bf16 v[156:159], v[184:187], v[72:75], v[156:159]
  ds_read_b128 v[212:215], v18 offset:45056
  s_waitcnt lgkmcnt(5)
  v_mfma_f32_16x16x32_bf16 v[132:135], v[188:191], v[68:71], v[132:135]
  v_mfma_f32_16x16x32_bf16 v[160:163], v[188:191], v[72:75], v[160:163]
  ds_read_b128 v[216:219], v18 offset:46080
  v_mfma_f32_16x16x32_bf16 v[136:139], v[192:195], v[68:71], v[136:139]
  v_mfma_f32_16x16x32_bf16 v[164:167], v[192:195], v[72:75], v[164:167]
  ds_read_b128 v[220:223], v18 offset:47104
  s_waitcnt lgkmcnt(6)
  v_mfma_f32_16x16x32_bf16 v[140:143], v[196:199], v[68:71], v[140:143]
  v_mfma_f32_16x16x32_bf16 v[168:171], v[196:199], v[72:75], v[168:171]
  ds_read_b128 v[224:227], v18 offset:48128
  s_waitcnt vmcnt(0)
  s_waitcnt lgkmcnt(5)
  v_mfma_f32_16x16x32_bf16 v[116:119], v[200:203], v[76:79], v[116:119]
  v_mfma_f32_16x16x32_bf16 v[144:147], v[200:203], v[80:83], v[144:147]
  ds_read_b128 v[84:87], v236 offset:0
  v_mfma_f32_16x16x32_bf16 v[120:123], v[204:207], v[76:79], v[120:123]
  v_mfma_f32_16x16x32_bf16 v[148:151], v[204:207], v[80:83], v[148:151]
  ds_read_b128 v[88:91], v236 offset:64
  s_waitcnt lgkmcnt(5)
  v_mfma_f32_16x16x32_bf16 v[124:127], v[208:211], v[76:79], v[124:127]
  v_mfma_f32_16x16x32_bf16 v[152:155], v[208:211], v[80:83], v[152:155]
  ds_read_b128 v[92:95], v236 offset:128
  v_mfma_f32_16x16x32_bf16 v[128:131], v[212:215], v[76:79], v[128:131]
  v_mfma_f32_16x16x32_bf16 v[156:159], v[212:215], v[80:83], v[156:159]
  ds_read_b128 v[96:99], v236 offset:192
  s_waitcnt lgkmcnt(5)
  v_mfma_f32_16x16x32_bf16 v[132:135], v[216:219], v[76:79], v[132:135]
  v_mfma_f32_16x16x32_bf16 v[160:163], v[216:219], v[80:83], v[160:163]
  ds_read_b128 v[100:103], v236 offset:256
  v_mfma_f32_16x16x32_bf16 v[136:139], v[220:223], v[76:79], v[136:139]
  v_mfma_f32_16x16x32_bf16 v[164:167], v[220:223], v[80:83], v[164:167]
  ds_read_b128 v[104:107], v236 offset:320
  s_waitcnt lgkmcnt(6)
  v_mfma_f32_16x16x32_bf16 v[140:143], v[224:227], v[76:79], v[140:143]
  v_mfma_f32_16x16x32_bf16 v[168:171], v[224:227], v[80:83], v[168:171]
  ds_read_b128 v[108:111], v236 offset:384
  v_cmp_u_f32 vcc, v116, v144
  s_cbranch_vccnz kp_redo3
kp_back3:
  s_waitcnt lgkmcnt(0)
  v_pk_fma_f32 v[116:117], v[84:85], v[238:239], v[116:117]
  v_pk_fma_f32 v[118:119], v[86:87], v[238:239], v[118:119]
  v_pk_mul_f32 v[172:173], v[116:117], v[116:117]
  v_pk_mul_f32 v[174:175], v[118:119], v[118:119]
  v_pk_fma_f32 v[172:173], v[172:173], v[242:243], v[240:241]
  v_pk_fma_f32 v[174:175], v[174:175], v[242:243], v[240:241]
  v_pk_mul_f32 v[172:173], v[172:173], v[116:117]
  v_pk_mul_f32 v[174:175], v[174:175], v[118:119]
  v_exp_f32 v172, v172
  v_exp_f32 v173, v173
  v_exp_f32 v174, v174
  v_exp_f32 v175, v175
  v_pk_fma_f32 v[172:173], v[172:173], v[244:245], v[244:245]
  v_pk_fma_f32 v[174:175], v[174:175], v[244:245], v[244:245]
  v_rcp_f32 v172, v172
  v_rcp_f32 v173, v173
  v_rcp_f32 v174, v174
  v_rcp_f32 v175, v175
  v_pk_mul_f32 v[172:173], v[172:173], v[116:117]
  v_pk_mul_f32 v[174:175], v[174:175], v[118:119]
  v_cvt_pk_bf16_f32 v52, v172, v173
  v_cvt_pk_bf16_f32 v53, v174, v175
  v_min_u32 v52, -2, v52
  v_min_u32 v53, -2, v53
  v_pk_fma_f32 v[144:145], v[84:85], v[246:247], v[144:145]
  v_pk_fma_f32 v[146:147], v[86:87], v[246:247], v[146:147]
  v_pk_mul_f32 v[176:177], v[144:145], v[144:145]
  v_pk_mul_f32 v[178:179], v[146:147], v[146:147]
  v_pk_fma_f32 v[176:177], v[176:177], v[250:251], v[248:249]
  v_pk_fma_f32 v[178:179], v[178:179], v[250:251], v[248:249]
  v_pk_mul_f32 v[176:177], v[176:177], v[144:145]
  v_pk_mul_f32 v[178:179], v[178:179], v[146:147]
  v_exp_f32 v176, v176
  v_exp_f32 v177, v177
  v_exp_f32 v178, v178
  v_exp_f32 v179, v179
  v_pk_fma_f32 v[176:177], v[176:177], v[252:253], v[252:253]
  v_pk_fma_f32 v[178:179], v[178:179], v[252:253], v[252:253]
  v_rcp_f32 v176, v176
  v_rcp_f32 v177, v177
  v_rcp_f32 v178, v178
  v_rcp_f32 v179, v179
  v_pk_mul_f32 v[176:177], v[176:177], v[144:145]
  v_pk_mul_f32 v[178:179], v[178:179], v[146:147]
  v_cvt_pk_bf16_f32 v56, v176, v177
  v_cvt_pk_bf16_f32 v57, v178, v179
  v_min_u32 v56, -2, v56
  v_min_u32 v57, -2, v57
  v_pk_fma_f32 v[120:121], v[88:89], v[238:239], v[120:121]
  v_pk_fma_f32 v[122:123], v[90:91], v[238:239], v[122:123]
  v_pk_mul_f32 v[172:173], v[120:121], v[120:121]
  v_pk_mul_f32 v[174:175], v[122:123], v[122:123]
  v_pk_fma_f32 v[172:173], v[172:173], v[242:243], v[240:241]
  v_pk_fma_f32 v[174:175], v[174:175], v[242:243], v[240:241]
  v_pk_mul_f32 v[172:173], v[172:173], v[120:121]
  v_pk_mul_f32 v[174:175], v[174:175], v[122:123]
  v_exp_f32 v172, v172
  v_exp_f32 v173, v173
  v_exp_f32 v174, v174
  v_exp_f32 v175, v175
  v_pk_fma_f32 v[172:173], v[172:173], v[244:245], v[244:245]
  v_pk_fma_f32 v[174:175], v[174:175], v[244:245], v[244:245]
  v_rcp_f32 v172, v172
  v_rcp_f32 v173, v173
  v_rcp_f32 v174, v174
  v_rcp_f32 v175, v175
  v_pk_mul_f32 v[172:173], v[172:173], v[120:121]
  v_pk_mul_f32 v[174:175], v[174:175], v[122:123]
  v_cvt_pk_bf16_f32 v54, v172, v173
  v_cvt_pk_bf16_f32 v55, v174, v175
  v_min_u32 v54, -2, v54
  v_min_u32 v55, -2, v55
  s_nop 0
  v_permlane16_swap_b32 v52, v54
  v_permlane16_swap_b32 v53, v55
  buffer_store_dwordx4 v[52:55], v48, s[16:19], s53 offen offset:0 sc1
  v_pk_fma_f32 v[148:149], v[88:89], v[246:247], v[148:149]
  v_pk_fma_f32 v[150:151], v[90:91], v[246:247], v[150:151]
  v_pk_mul_f32 v[176:177], v[148:149], v[148:149]
  v_pk_mul_f32 v[178:179], v[150:151], v[150:151]
  v_pk_fma_f32 v[176:177], v[176:177], v[250:251], v[248:249]
  v_pk_fma_f32 v[178:179], v[178:179], v[250:251], v[248:249]
  v_pk_mul_f32 v[176:177], v[176:177], v[148:149]
  v_pk_mul_f32 v[178:179], v[178:179], v[150:151]
  v_exp_f32 v176, v176
  v_exp_f32 v177, v177
  v_exp_f32 v178, v178
  v_exp_f32 v179, v179
  v_pk_fma_f32 v[176:177], v[176:177], v[252:253], v[252:253]
  v_pk_fma_f32 v[178:179], v[178:179], v[252:253], v[252:253]
  v_rcp_f32 v176, v176
  v_rcp_f32 v177, v177
  v_rcp_f32 v178, v178
  v_rcp_f32 v179, v179
  v_pk_mul_f32 v[176:177], v[176:177], v[148:149]
  v_pk_mul_f32 v[178:179], v[178:179], v[150:151]
  v_cvt_pk_bf16_f32 v58, v176, v177
  v_cvt_pk_bf16_f32 v59, v178, v179
  v_min_u32 v58, -2, v58
  v_min_u32 v59, -2, v59
  s_nop 0
  v_permlane16_swap_b32 v56, v58
  v_permlane16_swap_b32 v57, v59
  buffer_store_dwordx4 v[56:59], v48, s[16:19], s54 offen offset:0 sc1
  v_pk_fma_f32 v[124:125], v[92:93], v[238:239], v[124:125]
  v_pk_fma_f32 v[126:127], v[94:95], v[238:239], v[126:127]
  v_pk_mul_f32 v[172:173], v[124:125], v[124:125]
  v_pk_mul_f32 v[174:175], v[126:127], v[126:127]
  v_pk_fma_f32 v[172:173], v[172:173], v[242:243], v[240:241]
  v_pk_fma_f32 v[174:175], v[174:175], v[242:243], v[240:241]
  v_pk_mul_f32 v[172:173], v[172:173], v[124:125]
  v_pk_mul_f32 v[174:175], v[174:175], v[126:127]
  v_exp_f32 v172, v172
  v_exp_f32 v173, v173
  v_exp_f32 v174, v174
  v_exp_f32 v175, v175
  v_pk_fma_f32 v[172:173], v[172:173], v[244:245], v[244:245]
  v_pk_fma_f32 v[174:175], v[174:175], v[244:245], v[244:245]
  v_rcp_f32 v172, v172
  v_rcp_f32 v173, v173
  v_rcp_f32 v174, v174
  v_rcp_f32 v175, v175
  v_pk_mul_f32 v[172:173], v[172:173], v[124:125]
  v_pk_mul_f32 v[174:175], v[174:175], v[126:127]
  v_cvt_pk_bf16_f32 v188, v172, v173
  v_cvt_pk_bf16_f32 v189, v174, v175
  v_min_u32 v188, -2, v188
  v_min_u32 v189, -2, v189
  buffer_store_dwordx2 v[188:189], v13, s[16:19], s53 offen offset:1024 sc1
  v_pk_fma_f32 v[152:153], v[92:93], v[246:247], v[152:153]
  v_pk_fma_f32 v[154:155], v[94:95], v[246:247], v[154:155]
  v_pk_mul_f32 v[176:177], v[152:153], v[152:153]
  v_pk_mul_f32 v[178:179], v[154:155], v[154:155]
  v_pk_fma_f32 v[176:177], v[176:177], v[250:251], v[248:249]
  v_pk_fma_f32 v[178:179], v[178:179], v[250:251], v[248:249]
  v_pk_mul_f32 v[176:177], v[176:177], v[152:153]
  v_pk_mul_f32 v[178:179], v[178:179], v[154:155]
  v_exp_f32 v176, v176
  v_exp_f32 v177, v177
  v_exp_f32 v178, v178
  v_exp_f32 v179, v179
  v_pk_fma_f32 v[176:177], v[176:177], v[252:253], v[252:253]
  v_pk_fma_f32 v[178:179], v[178:179], v[252:253], v[252:253]
  v_rcp_f32 v176, v176
  v_rcp_f32 v177, v177
  v_rcp_f32 v178, v178
  v_rcp_f32 v179, v179
  v_pk_mul_f32 v[176:177], v[176:177], v[152:153]
  v_pk_mul_f32 v[178:179], v[178:179], v[154:155]
  v_cvt_pk_bf16_f32 v190, v176, v177
  v_cvt_pk_bf16_f32 v191, v178, v179
  v_min_u32 v190, -2, v190
  v_min_u32 v191, -2, v191
  buffer_store_dwordx2 v[190:191], v13, s[16:19], s54 offen offset:1024 sc1
  s_cmp_eq_u32 s49, 15
  s_cbranch_scc1 kp_w3fin
  v_pk_fma_f32 v[128:129], v[96:97], v[238:239], v[128:129]
  v_pk_fma_f32 v[130:131], v[98:99], v[238:239], v[130:131]
  v_pk_mul_f32 v[172:173], v[128:129], v[128:129]
  v_pk_mul_f32 v[174:175], v[130:131], v[130:131]
  v_pk_fma_f32 v[172:173], v[172:173], v[242:243], v[240:241]
  v_pk_fma_f32 v[174:175], v[174:175], v[242:243], v[240:241]
  v_pk_mul_f32 v[172:173], v[172:173], v[128:129]
  v_pk_mul_f32 v[174:175], v[174:175], v[130:131]
  v_exp_f32 v172, v172
  v_exp_f32 v173, v173
  v_exp_f32 v174, v174
  v_exp_f32 v175, v175
  v_pk_fma_f32 v[172:173], v[172:173], v[244:245], v[244:245]
  v_pk_fma_f32 v[174:175], v[174:175], v[244:245], v[244:245]
  v_rcp_f32 v172, v172
  v_rcp_f32 v173, v173
  v_rcp_f32 v174, v174
  v_rcp_f32 v175, v175
  v_pk_mul_f32 v[172:173], v[172:173], v[128:129]
  v_pk_mul_f32 v[174:175], v[174:175], v[130:131]
  v_cvt_pk_bf16_f32 v60, v172, v173
  v_cvt_pk_bf16_f32 v61, v174, v175
  v_min_u32 v60, -2, v60
  v_min_u32 v61, -2, v61
  v_pk_fma_f32 v[156:157], v[96:97], v[246:247], v[156:157]
  v_pk_fma_f32 v[158:159], v[98:99], v[246:247], v[158:159]
  v_pk_mul_f32 v[176:177], v[156:157], v[156:157]
  v_pk_mul_f32 v[178:179], v[158:159], v[158:159]
  v_pk_fma_f32 v[176:177], v[176:177], v[250:251], v[248:249]
  v_pk_fma_f32 v[178:179], v[178:179], v[250:251], v[248:249]
  v_pk_mul_f32 v[176:177], v[176:177], v[156:157]
  v_pk_mul_f32 v[178:179], v[178:179], v[158:159]
  v_exp_f32 v176, v176
  v_exp_f32 v177, v177
  v_exp_f32 v178, v178
  v_exp_f32 v179, v179
  v_pk_fma_f32 v[176:177], v[176:177], v[252:253], v[252:253]
  v_pk_fma_f32 v[178:179], v[178:179], v[252:253], v[252:253]
  v_rcp_f32 v176, v176
  v_rcp_f32 v177, v177
  v_rcp_f32 v178, v178
  v_rcp_f32 v179, v179
  v_pk_mul_f32 v[176:177], v[176:177], v[156:157]
  v_pk_mul_f32 v[178:179], v[178:179], v[158:159]
  v_cvt_pk_bf16_f32 v64, v176, v177
  v_cvt_pk_bf16_f32 v65, v178, v179
  v_min_u32 v64, -2, v64
  v_min_u32 v65, -2, v65
  v_pk_fma_f32 v[132:133], v[100:101], v[238:239], v[132:133]
  v_pk_fma_f32 v[134:135], v[102:103], v[238:239], v[134:135]
  v_pk_mul_f32 v[172:173], v[132:133], v[132:133]
  v_pk_mul_f32 v[174:175], v[134:135], v[134:135]
  v_pk_fma_f32 v[172:173], v[172:173], v[242:243], v[240:241]
  v_pk_fma_f32 v[174:175], v[174:175], v[242:243], v[240:241]
  v_pk_mul_f32 v[172:173], v[172:173], v[132:133]
  v_pk_mul_f32 v[174:175], v[174:175], v[134:135]
  v_exp_f32 v172, v172
  v_exp_f32 v173, v173
  v_exp_f32 v174, v174
  v_exp_f32 v175, v175
  v_pk_fma_f32 v[172:173], v[172:173], v[244:245], v[244:245]
  v_pk_fma_f32 v[174:175], v[174:175], v[244:245], v[244:245]
  v_rcp_f32 v172, v172
  v_rcp_f32 v173, v173
  v_rcp_f32 v174, v174
  v_rcp_f32 v175, v175
  v_pk_mul_f32 v[172:173], v[172:173], v[132:133]
  v_pk_mul_f32 v[174:175], v[174:175], v[134:135]
  v_cvt_pk_bf16_f32 v62, v172, v173
  v_cvt_pk_bf16_f32 v63, v174, v175
  v_min_u32 v62, -2, v62
  v_min_u32 v63, -2, v63
  s_nop 0
  v_permlane16_swap_b32 v60, v62
  v_permlane16_swap_b32 v61, v63
  buffer_store_dwordx4 v[60:63], v48, s[16:19], s53 offen offset:1536 sc1
  v_pk_fma_f32 v[160:161], v[100:101], v[246:247], v[160:161]
  v_pk_fma_f32 v[162:163], v[102:103], v[246:247], v[162:163]
  v_pk_mul_f32 v[176:177], v[160:161], v[160:161]
  v_pk_mul_f32 v[178:179], v[162:163], v[162:163]
  v_pk_fma_f32 v[176:177], v[176:177], v[250:251], v[248:249]
  v_pk_fma_f32 v[178:179], v[178:179], v[250:251], v[248:249]
  v_pk_mul_f32 v[176:177], v[176:177], v[160:161]
  v_pk_mul_f32 v[178:179], v[178:179], v[162:163]
  v_exp_f32 v176, v176
  v_exp_f32 v177, v177
  v_exp_f32 v178, v178
  v_exp_f32 v179, v179
  v_pk_fma_f32 v[176:177], v[176:177], v[252:253], v[252:253]
  v_pk_fma_f32 v[178:179], v[178:179], v[252:253], v[252:253]
  v_rcp_f32 v176, v176
  v_rcp_f32 v177, v177
  v_rcp_f32 v178, v178
  v_rcp_f32 v179, v179
  v_pk_mul_f32 v[176:177], v[176:177], v[160:161]
  v_pk_mul_f32 v[178:179], v[178:179], v[162:163]
  v_cvt_pk_bf16_f32 v66, v176, v177
  v_cvt_pk_bf16_f32 v67, v178, v179
  v_min_u32 v66, -2, v66
  v_min_u32 v67, -2, v67
  s_nop 0
  v_permlane16_swap_b32 v64, v66
  v_permlane16_swap_b32 v65, v67
  buffer_store_dwordx4 v[64:67], v48, s[16:19], s54 offen offset:1536 sc1
  v_pk_fma_f32 v[136:137], v[104:105], v[238:239], v[136:137]
  v_pk_fma_f32 v[138:139], v[106:107], v[238:239], v[138:139]
  v_pk_mul_f32 v[172:173], v[136:137], v[136:137]
  v_pk_mul_f32 v[174:175], v[138:139], v[138:139]
  v_pk_fma_f32 v[172:173], v[172:173], v[242:243], v[240:241]
  v_pk_fma_f32 v[174:175], v[174:175], v[242:243], v[240:241]
  v_pk_mul_f32 v[172:173], v[172:173], v[136:137]
  v_pk_mul_f32 v[174:175], v[174:175], v[138:139]
  v_exp_f32 v172, v172
  v_exp_f32 v173, v173
  v_exp_f32 v174, v174
  v_exp_f32 v175, v175
  v_pk_fma_f32 v[172:173], v[172:173], v[244:245], v[244:245]
  v_pk_fma_f32 v[174:175], v[174:175], v[244:245], v[244:245]
  v_rcp_f32 v172, v172
  v_rcp_f32 v173, v173
  v_rcp_f32 v174, v174
  v_rcp_f32 v175, v175
  v_pk_mul_f32 v[172:173], v[172:173], v[136:137]
  v_pk_mul_f32 v[174:175], v[174:175], v[138:139]
  v_cvt_pk_bf16_f32 v52, v172, v173
  v_cvt_pk_bf16_f32 v53, v174, v175
  v_min_u32 v52, -2, v52
  v_min_u32 v53, -2, v53
  v_pk_fma_f32 v[164:165], v[104:105], v[246:247], v[164:165]
  v_pk_fma_f32 v[166:167], v[106:107], v[246:247], v[166:167]
  v_pk_mul_f32 v[176:177], v[164:165], v[164:165]
  v_pk_mul_f32 v[178:179], v[166:167], v[166:167]
  v_pk_fma_f32 v[176:177], v[176:177], v[250:251], v[248:249]
  v_pk_fma_f32 v[178:179], v[178:179], v[250:251], v[248:249]
  v_pk_mul_f32 v[176:177], v[176:177], v[164:165]
  v_pk_mul_f32 v[178:179], v[178:179], v[166:167]
  v_exp_f32 v176, v176
  v_exp_f32 v177, v177
  v_exp_f32 v178, v178
  v_exp_f32 v179, v179
  v_pk_fma_f32 v[176:177], v[176:177], v[252:253], v[252:253]
  v_pk_fma_f32 v[178:179], v[178:179], v[252:253], v[252:253]
  v_rcp_f32 v176, v176
  v_rcp_f32 v177, v177
  v_rcp_f32 v178, v178
  v_rcp_f32 v179, v179
  v_pk_mul_f32 v[176:177], v[176:177], v[164:165]
  v_pk_mul_f32 v[178:179], v[178:179], v[166:167]
  v_cvt_pk_bf16_f32 v56, v176, v177
  v_cvt_pk_bf16_f32 v57, v178, v179
  v_min_u32 v56, -2, v56
  v_min_u32 v57, -2, v57
  v_pk_fma_f32 v[140:141], v[108:109], v[238:239], v[140:141]
  v_pk_fma_f32 v[142:143], v[110:111], v[238:239], v[142:143]
  v_pk_mul_f32 v[172:173], v[140:141], v[140:141]
  v_pk_mul_f32 v[174:175], v[142:143], v[142:143]
  v_pk_fma_f32 v[172:173], v[172:173], v[242:243], v[240:241]
  v_pk_fma_f32 v[174:175], v[174:175], v[242:243], v[240:241]
  v_pk_mul_f32 v[172:173], v[172:173], v[140:141]
  v_pk_mul_f32 v[174:175], v[174:175], v[142:143]
  v_exp_f32 v172, v172
  v_exp_f32 v173, v173
  v_exp_f32 v174, v174
  v_exp_f32 v175, v175
  v_pk_fma_f32 v[172:173], v[172:173], v[244:245], v[244:245]
  v_pk_fma_f32 v[174:175], v[174:175], v[244:245], v[244:245]
  v_rcp_f32 v172, v172
  v_rcp_f32 v173, v173
  v_rcp_f32 v174, v174
  v_rcp_f32 v175, v175
  v_pk_mul_f32 v[172:173], v[172:173], v[140:141]
  v_pk_mul_f32 v[174:175], v[174:175], v[142:143]
  v_cvt_pk_bf16_f32 v54, v172, v173
  v_cvt_pk_bf16_f32 v55, v174, v175
  v_min_u32 v54, -2, v54
  v_min_u32 v55, -2, v55
  s_nop 0
  v_permlane16_swap_b32 v52, v54
  v_permlane16_swap_b32 v53, v55
  buffer_store_dwordx4 v[52:55], v48, s[16:19], s53 offen offset:2560 sc1
  v_pk_fma_f32 v[168:169], v[108:109], v[246:247], v[168:169]
  v_pk_fma_f32 v[170:171], v[110:111], v[246:247], v[170:171]
  v_pk_mul_f32 v[176:177], v[168:169], v[168:169]
  v_pk_mul_f32 v[178:179], v[170:171], v[170:171]
  v_pk_fma_f32 v[176:177], v[176:177], v[250:251], v[248:249]
  v_pk_fma_f32 v[178:179], v[178:179], v[250:251], v[248:249]
  v_pk_mul_f32 v[176:177], v[176:177], v[168:169]
  v_pk_mul_f32 v[178:179], v[178:179], v[170:171]
  v_exp_f32 v176, v176
  v_exp_f32 v177, v177
  v_exp_f32 v178, v178
  v_exp_f32 v179, v179
  v_pk_fma_f32 v[176:177], v[176:177], v[252:253], v[252:253]
  v_pk_fma_f32 v[178:179], v[178:179], v[252:253], v[252:253]
  v_rcp_f32 v176, v176
  v_rcp_f32 v177, v177
  v_rcp_f32 v178, v178
  v_rcp_f32 v179, v179
  v_pk_mul_f32 v[176:177], v[176:177], v[168:169]
  v_pk_mul_f32 v[178:179], v[178:179], v[170:171]
  v_cvt_pk_bf16_f32 v58, v176, v177
  v_cvt_pk_bf16_f32 v59, v178, v179
  v_min_u32 v58, -2, v58
  v_min_u32 v59, -2, v59
  s_nop 0
  v_permlane16_swap_b32 v56, v58
  v_permlane16_swap_b32 v57, v59
  buffer_store_dwordx4 v[56:59], v48, s[16:19], s54 offen offset:2560 sc1
kp_w3fin:
  s_mov_b64 exec, 1
  s_waitcnt vmcnt(0)
  buffer_store_dword v17, off, s[36:39], s61 sc1
  s_mov_b64 exec, -1
  s_barrier
  s_add_u32 s8, s6, 0x1240000
  s_addc_u32 s9, s7, 0
  s_mov_b32 s10, 0x6c0000
  s_mov_b32 s11, 0x00020000
  s_mul_i32 s58, s46, 55296
  s_and_b32 s43, s40, 1
  s_lshl_b32 s44, s43, 10
  s_add_u32 s58, s58, s44
  s_xor_b32 s51, s46, 1
  s_mul_i32 s51, s51, 55296
  s_add_u32 s51, s51, s44
  s_mul_i32 s43, s43, 5120
  s_mul_i32 s44, s40, 5120
  s_xor_b32 s45, s40, 1
  s_mul_i32 s45, s45, 5120
  v_add_u32 v215, s44, v9
  v_add_u32 v216, s45, v9
  s_sub_u32 s59, s59, 131072
  v_subrev_u32 v14, 131072, v14
  v_add_u32 v212, s43, v9
  v_add_u32 v213, s43, v18
  v_add_u32 v214, s43, v19
  s_andn2_b32 s43, s46, 1
  s_lshl_b32 s43, s43, 10
  s_add_u32 s43, s43, 131072
  v_lshl_add_u32 v45, v10, 7, s43
  s_mov_b32 s16, s64
  s_mov_b32 s17, s65
  s_mov_b32 s18, 0x280000
  s_mov_b32 s19, 0x00020000
  s_mov_b32 s60, 400000
kp_probe4:
  s_sub_u32 s60, s60, 1
  s_cbranch_scc1 kp_end
  buffer_load_dword v46, v45, s[36:39], 0 offen sc1
  s_lshl_b32 s71, s70, 10
  s_add_u32 s62, s58, s71
  buffer_load_dwordx4 v[52:55], v9, s[8:11], s62 offen offset:0 sc1
  s_add_u32 s63, s51, s71
  buffer_load_dwordx4 v[56:59], v9, s[8:11], s63 offen offset:0 sc1
  s_add_u32 s71, s71, 2048
  s_cmp_ge_u32 s71, 55296
  s_cselect_b32 s71, 0, s71
  s_add_u32 s62, s58, s71
  buffer_load_dwordx4 v[60:63], v9, s[8:11], s62 offen offset:0 sc1
  s_add_u32 s63, s51, s71
  buffer_load_dwordx4 v[64:67], v9, s[8:11], s63 offen offset:0 sc1
  s_waitcnt vmcnt(4)
  v_cmp_eq_u32 vcc, 0, v46
  s_cbranch_vccnz kp_probe4
  s_add_u32 s71, s71, 2048
  s_cmp_ge_u32 s71, 55296
  s_cselect_b32 s71, 0, s71
  s_add_u32 s62, s58, s71
  buffer_load_dwordx4 v[68:71], v9, s[8:11], s62 offen offset:0 sc1
  s_add_u32 s63, s51, s71
  buffer_load_dwordx4 v[72:75], v9, s[8:11], s63 offen offset:0 sc1
  s_add_u32 s71, s71, 2048
  s_cmp_ge_u32 s71, 55296
  s_cselect_b32 s71, 0, s71
  s_add_u32 s62, s58, s71
  buffer_load_dwordx4 v[76:79], v9, s[8:11], s62 offen offset:0 sc1
  s_add_u32 s63, s51, s71
  buffer_load_dwordx4 v[80:83], v9, s[8:11], s63 offen offset:0 sc1
  s_add_u32 s71, s71, 2048
  s_cmp_ge_u32 s71, 55296
  s_cselect_b32 s71, 0, s71
  s_add_u32 s62, s58, s71
  buffer_load_dwordx4 v[84:87], v9, s[8:11], s62 offen offset:0 sc1
  s_add_u32 s63, s51, s71
  buffer_load_dwordx4 v[88:91], v9, s[8:11], s63 offen offset:0 sc1
  s_add_u32 s71, s71, 2048
  s_cmp_ge_u32 s71, 55296
  s_cselect_b32 s71, 0, s71
  s_add_u32 s62, s58, s71
  buffer_load_dwordx4 v[92:95], v9, s[8:11], s62 offen offset:0 sc1
  s_add_u32 s63, s51, s71
  buffer_load_dwordx4 v[96:99], v9, s[8:11], s63 offen offset:0 sc1
  s_add_u32 s71, s71, 2048
  s_cmp_ge_u32 s71, 55296
  s_cselect_b32 s71, 0, s71
  s_add_u32 s62, s58, s71
  buffer_load_dwordx4 v[100:103], v9, s[8:11], s62 offen offset:0 sc1
  s_add_u32 s63, s51, s71
  buffer_load_dwordx4 v[104:107], v9, s[8:11], s63 offen offset:0 sc1
  s_waitcnt vmcnt(10)
  v_max3_u32 v46, v52, v53, v54
  v_max3_u32 v46, v46, v55, v56
  v_max3_u32 v46, v46, v57, v58
  v_max3_u32 v46, v46, v59, v60
  v_max3_u32 v46, v46, v61, v62
  v_max3_u32 v46, v46, v63, v64
  v_max3_u32 v46, v46, v65, v66
  v_max_u32 v46, v46, v67
  v_cmp_eq_u32 vcc, -1, v46
  s_cbranch_vccnz kp_probe4
  s_barrier
  ds_read_b128 v[172:175], v212 offset:0
  ds_read_b128 v[176:179], v212 offset:1024
  ds_read_b128 v[180:183], v212 offset:2048
  ds_read_b128 v[184:187], v212 offset:3072
  ds_read_b128 v[188:191], v212 offset:4096
  s_waitcnt lgkmcnt(3)
  v_mfma_f32_16x16x32_bf16 v[132:135], v[172:175], v[52:55], 0
  v_mfma_f32_16x16x32_bf16 v[152:155], v[172:175], v[56:59], 0
  ds_read_b128 v[192:195], v212 offset:10240
  v_mfma_f32_16x16x32_bf16 v[136:139], v[176:179], v[52:55], 0
  v_mfma_f32_16x16x32_bf16 v[156:159], v[176:179], v[56:59], 0
  s_add_u32 s71, s71, 2048
  s_cmp_ge_u32 s71, 55296
  s_cselect_b32 s71, 0, s71
  s_add_u32 s62, s58, s71
  buffer_load_dwordx4 v[108:111], v9, s[8:11], s62 offen offset:0 sc1
  ds_read_b128 v[196:199], v212 offset:11264
  s_waitcnt lgkmcnt(3)
  v_mfma_f32_16x16x32_bf16 v[140:143], v[180:183], v[52:55], 0
  v_mfma_f32_16x16x32_bf16 v[160:163], v[180:183], v[56:59], 0
  ds_read_b128 v[200:203], v212 offset:12288
  v_mfma_f32_16x16x32_bf16 v[144:147], v[184:187], v[52:55], 0
  v_mfma_f32_16x16x32_bf16 v[164:167], v[184:187], v[56:59], 0
  s_add_u32 s63, s51, s71
  buffer_load_dwordx4 v[112:115], v9, s[8:11], s63 offen offset:0 sc1
  ds_read_b128 v[204:207], v212 offset:13312
  s_waitcnt lgkmcnt(4)
  v_mfma_f32_16x16x32_bf16 v[148:151], v[188:191], v[52:55], 0
  v_mfma_f32_16x16x32_bf16 v[168:171], v[188:191], v[56:59], 0
  ds_read_b128 v[208:211], v212 offset:14336
  s_waitcnt lgkmcnt(3)
  v_mfma_f32_16x16x32_bf16 v[132:135], v[192:195], v[60:63], v[132:135]
  v_mfma_f32_16x16x32_bf16 v[152:155], v[192:195], v[64:67], v[152:155]
  s_add_u32 s71, s71, 2048
  s_cmp_ge_u32 s71, 55296
  s_cselect_b32 s71, 0, s71
  s_add_u32 s62, s58, s71
  buffer_load_dwordx4 v[116:119], v9, s[8:11], s62 offen offset:0 sc1
  ds_read_b128 v[172:175], v212 offset:20480
  v_mfma_f32_16x16x32_bf16 v[136:139], v[196:199], v[60:63], v[136:139]
  v_mfma_f32_16x16x32_bf16 v[156:159], v[196:199], v[64:67], v[156:159]
  ds_read_b128 v[176:179], v212 offset:21504
  s_waitcnt lgkmcnt(3)
  v_mfma_f32_16x16x32_bf16 v[140:143], v[200:203], v[60:63], v[140:143]
  v_mfma_f32_16x16x32_bf16 v[160:163], v[200:203], v[64:67], v[160:163]
  s_add_u32 s63, s51, s71
  buffer_load_dwordx4 v[120:123], v9, s[8:11], s63 offen offset:0 sc1
  ds_read_b128 v[180:183], v212 offset:22528
  v_mfma_f32_16x16x32_bf16 v[144:147], v[204:207], v[60:63], v[144:147]
  v_mfma_f32_16x16x32_bf16 v[164:167], v[204:207], v[64:67], v[164:167]
  ds_read_b128 v[184:187], v212 offset:23552
  s_waitcnt lgkmcnt(4)
  v_mfma_f32_16x16x32_bf16 v[148:151], v[208:211], v[60:63], v[148:151]
  v_mfma_f32_16x16x32_bf16 v[168:171], v[208:211], v[64:67], v[168:171]
  s_add_u32 s71, s71, 2048
  s_cmp_ge_u32 s71, 55296
  s_cselect_b32 s71, 0, s71
  s_add_u32 s62, s58, s71
  buffer_load_dwordx4 v[124:127], v9, s[8:11], s62 offen offset:0 sc1
  ds_read_b128 v[188:191], v212 offset:24576
  s_waitcnt vmcnt(13)
  s_waitcnt lgkmcnt(3)
  v_mfma_f32_16x16x32_bf16 v[132:135], v[172:175], v[68:71], v[132:135]
  v_mfma_f32_16x16x32_bf16 v[152:155], v[172:175], v[72:75], v[152:155]
  ds_read_b128 v[192:195], v212 offset:30720
  v_mfma_f32_16x16x32_bf16 v[136:139], v[176:179], v[68:71], v[136:139]
  v_mfma_f32_16x16x32_bf16 v[156:159], v[176:179], v[72:75], v[156:159]
  s_add_u32 s63, s51, s71
  buffer_load_dwordx4 v[128:131], v9, s[8:11], s63 offen offset:0 sc1
  ds_read_b128 v[196:199], v212 offset:31744
  s_waitcnt lgkmcnt(3)
  v_mfma_f32_16x16x32_bf16 v[140:143], v[180:183], v[68:71], v[140:143]
  v_mfma_f32_16x16x32_bf16 v[160:163], v[180:183], v[72:75], v[160:163]
  ds_read_b128 v[200:203], v212 offset:32768
  v_mfma_f32_16x16x32_bf16 v[144:147], v[184:187], v[68:71], v[144:147]
  v_mfma_f32_16x16x32_bf16 v[164:167], v[184:187], v[72:75], v[164:167]
  s_add_u32 s71, s71, 2048
  s_cmp_ge_u32 s71, 55296
  s_cselect_b32 s71, 0, s71
  s_add_u32 s62, s58, s71
  buffer_load_dwordx4 v[52:55], v9, s[8:11], s62 offen offset:0 sc1
  ds_read_b128 v[204:207], v212 offset:33792
  s_waitcnt lgkmcnt(4)
  v_mfma_f32_16x16x32_bf16 v[148:151], v[188:191], v[68:71], v[148:151]
  v_mfma_f32_16x16x32_bf16 v[168:171], v[188:191], v[72:75], v[168:171]
  ds_read_b128 v[208:211], v212 offset:34816
  s_waitcnt vmcnt(13)
  s_waitcnt lgkmcnt(3)
  v_mfma_f32_16x16x32_bf16 v[132:135], v[192:195], v[76:79], v[132:135]
  v_mfma_f32_16x16x32_bf16 v[152:155], v[192:195], v[80:83], v[152:155]
  s_add_u32 s63, s51, s71
  buffer_load_dwordx4 v[56:59], v9, s[8:11], s63 offen offset:0 sc1
  s_barrier
  ds_read_b128 v[172:175], v212 offset:40960
  v_mfma_f32_16x16x32_bf16 v[136:139], v[196:199], v[76:79], v[136:139]
  v_mfma_f32_16x16x32_bf16 v[156:159], v[196:199], v[80:83], v[156:159]
  ds_read_b128 v[176:179], v212 offset:41984
  s_waitcnt lgkmcnt(3)
  v_mfma_f32_16x16x32_bf16 v[140:143], v[200:203], v[76:79], v[140:143]
  v_mfma_f32_16x16x32_bf16 v[160:163], v[200:203], v[80:83], v[160:163]
  s_add_u32 s71, s71, 2048
  s_cmp_ge_u32 s71, 55296
  s_cselect_b32 s71, 0, s71
  s_add_u32 s62, s58, s71
  buffer_load_dwordx4 v[60:63], v9, s[8:11], s62 offen offset:0 sc1
  ds_read_b128 v[180:183], v212 offset:43008
  v_mfma_f32_16x16x32_bf16 v[144:147], v[204:207], v[76:79], v[144:147]
  v_mfma_f32_16x16x32_bf16 v[164:167], v[204:207], v[80:83], v[164:167]
  ds_read_b128 v[184:187], v212 offset:44032
  s_waitcnt lgkmcnt(4)
  v_mfma_f32_16x16x32_bf16 v[148:151], v[208:211], v[76:79], v[148:151]
  v_mfma_f32_16x16x32_bf16 v[168:171], v[208:211], v[80:83], v[168:171]
  s_add_u32 s63, s51, s71
  buffer_load_dwordx4 v[64:67], v9, s[8:11], s63 offen offset:0 sc1
  ds_read_b128 v[188:191], v212 offset:45056
  s_waitcnt vmcnt(14)
  s_waitcnt lgkmcnt(3)
  v_mfma_f32_16x16x32_bf16 v[132:135], v[172:175], v[84:87], v[132:135]
  v_mfma_f32_16x16x32_bf16 v[152:155], v[172:175], v[88:91], v[152:155]
  ds_read_b128 v[192:195], v212 offset:51200
  v_mfma_f32_16x16x32_bf16 v[136:139], v[176:179], v[84:87], v[136:139]
  v_mfma_f32_16x16x32_bf16 v[156:159], v[176:179], v[88:91], v[156:159]
  s_add_u32 s71, s71, 2048
  s_cmp_ge_u32 s71, 55296
  s_cselect_b32 s71, 0, s71
  s_add_u32 s62, s58, s71
  buffer_load_dwordx4 v[68:71], v9, s[8:11], s62 offen offset:0 sc1
  ds_read_b128 v[196:199], v212 offset:52224
  s_waitcnt lgkmcnt(3)
  v_mfma_f32_16x16x32_bf16 v[140:143], v[180:183], v[84:87], v[140:143]
  v_mfma_f32_16x16x32_bf16 v[160:163], v[180:183], v[88:91], v[160:163]
  ds_read_b128 v[200:203], v212 offset:53248
  v_mfma_f32_16x16x32_bf16 v[144:147], v[184:187], v[84:87], v[144:147]
  v_mfma_f32_16x16x32_bf16 v[164:167], v[184:187], v[88:91], v[164:167]
  s_add_u32 s63, s51, s71
  buffer_load_dwordx4 v[72:75], v9, s[8:11], s63 offen offset:0 sc1
  ds_read_b128 v[204:207], v212 offset:54272
  s_waitcnt lgkmcnt(4)
  v_mfma_f32_16x16x32_bf16 v[148:151], v[188:191], v[84:87], v[148:151]
  v_mfma_f32_16x16x32_bf16 v[168:171], v[188:191], v[88:91], v[168:171]
  ds_read_b128 v[208:211], v212 offset:55296
  s_waitcnt vmcnt(14)
  s_waitcnt lgkmcnt(3)
  v_mfma_f32_16x16x32_bf16 v[132:135], v[192:195], v[92:95], v[132:135]
  v_mfma_f32_16x16x32_bf16 v[152:155], v[192:195], v[96:99], v[152:155]
  s_add_u32 s71, s71, 2048
  s_cmp_ge_u32 s71, 55296
  s_cselect_b32 s71, 0, s71
  s_add_u32 s62, s58, s71
  buffer_load_dwordx4 v[76:79], v9, s[8:11], s62 offen offset:0 sc1
  s_barrier
  ds_read_b128 v[172:175], v212 offset:61440
  v_mfma_f32_16x16x32_bf16 v[136:139], v[196:199], v[92:95], v[136:139]
  v_mfma_f32_16x16x32_bf16 v[156:159], v[196:199], v[96:99], v[156:159]
  ds_read_b128 v[176:179], v212 offset:62464
  s_waitcnt lgkmcnt(3)
  v_mfma_f32_16x16x32_bf16 v[140:143], v[200:203], v[92:95], v[140:143]
  v_mfma_f32_16x16x32_bf16 v[160:163], v[200:203], v[96:99], v[160:163]
  s_add_u32 s63, s51, s71
  buffer_load_dwordx4 v[80:83], v9, s[8:11], s63 offen offset:0 sc1
  ds_read_b128 v[180:183], v212 offset:63488
  v_mfma_f32_16x16x32_bf16 v[144:147], v[204:207], v[92:95], v[144:147]
  v_mfma_f32_16x16x32_bf16 v[164:167], v[204:207], v[96:99], v[164:167]
  ds_read_b128 v[184:187], v212 offset:64512
  s_waitcnt lgkmcnt(4)
  v_mfma_f32_16x16x32_bf16 v[148:151], v[208:211], v[92:95], v[148:151]
  v_mfma_f32_16x16x32_bf16 v[168:171], v[208:211], v[96:99], v[168:171]
  s_add_u32 s71, s71, 2048
  s_cmp_ge_u32 s71, 55296
  s_cselect_b32 s71, 0, s71
  s_add_u32 s62, s58, s71
  buffer_load_dwordx4 v[84:87], v9, s[8:11], s62 offen offset:0 sc1
  ds_read_b128 v[188:191], v213 offset:0
  s_waitcnt vmcnt(15)
  s_waitcnt lgkmcnt(3)
  v_mfma_f32_16x16x32_bf16 v[132:135], v[172:175], v[100:103], v[132:135]
  v_mfma_f32_16x16x32_bf16 v[152:155], v[172:175], v[104:107], v[152:155]
  ds_read_b128 v[192:195], v213 offset:6144
  v_mfma_f32_16x16x32_bf16 v[136:139], v[176:179], v[100:103], v[136:139]
  v_mfma_f32_16x16x32_bf16 v[156:159], v[176:179], v[104:107], v[156:159]
  s_add_u32 s63, s51, s71
  buffer_load_dwordx4 v[88:91], v9, s[8:11], s63 offen offset:0 sc1
  ds_read_b128 v[196:199], v213 offset:7168
  s_waitcnt lgkmcnt(3)
  v_mfma_f32_16x16x32_bf16 v[140:143], v[180:183], v[100:103], v[140:143]
  v_mfma_f32_16x16x32_bf16 v[160:163], v[180:183], v[104:107], v[160:163]
  ds_read_b128 v[200:203], v213 offset:8192
  v_mfma_f32_16x16x32_bf16 v[144:147], v[184:187], v[100:103], v[144:147]
  v_mfma_f32_16x16x32_bf16 v[164:167], v[184:187], v[104:107], v[164:167]
  s_add_u32 s71, s71, 2048
  s_cmp_ge_u32 s71, 55296
  s_cselect_b32 s71, 0, s71
  s_add_u32 s62, s58, s71
  buffer_load_dwordx4 v[92:95], v9, s[8:11], s62 offen offset:0 sc1
  ds_read_b128 v[204:207], v213 offset:9216
  s_waitcnt lgkmcnt(4)
  v_mfma_f32_16x16x32_bf16 v[148:151], v[188:191], v[100:103], v[148:151]
  v_mfma_f32_16x16x32_bf16 v[168:171], v[188:191], v[104:107], v[168:171]
  ds_read_b128 v[208:211], v213 offset:10240
  s_waitcnt vmcnt(15)
  s_waitcnt lgkmcnt(3)
  v_mfma_f32_16x16x32_bf16 v[132:135], v[192:195], v[108:111], v[132:135]
  v_mfma_f32_16x16x32_bf16 v[152:155], v[192:195], v[112:115], v[152:155]
  s_add_u32 s63, s51, s71
  buffer_load_dwordx4 v[96:99], v9, s[8:11], s63 offen offset:0 sc1
  s_barrier
  ds_read_b128 v[172:175], v213 offset:16384
  v_mfma_f32_16x16x32_bf16 v[136:139], v[196:199], v[108:111], v[136:139]
  v_mfma_f32_16x16x32_bf16 v[156:159], v[196:199], v[112:115], v[156:159]
  ds_read_b128 v[176:179], v213 offset:17408
  s_waitcnt lgkmcnt(3)
  v_mfma_f32_16x16x32_bf16 v[140:143], v[200:203], v[108:111], v[140:143]
  v_mfma_f32_16x16x32_bf16 v[160:163], v[200:203], v[112:115], v[160:163]
  s_add_u32 s71, s71, 2048
  s_cmp_ge_u32 s71, 55296
  s_cselect_b32 s71, 0, s71
  s_add_u32 s62, s58, s71
  buffer_load_dwordx4 v[100:103], v9, s[8:11], s62 offen offset:0 sc1
  ds_read_b128 v[180:183], v213 offset:18432
  v_mfma_f32_16x16x32_bf16 v[144:147], v[204:207], v[108:111], v[144:147]
  v_mfma_f32_16x16x32_bf16 v[164:167], v[204:207], v[112:115], v[164:167]
  ds_read_b128 v[184:187], v213 offset:19456
  s_waitcnt lgkmcnt(4)
  v_mfma_f32_16x16x32_bf16 v[148:151], v[208:211], v[108:111], v[148:151]
  v_mfma_f32_16x16x32_bf16 v[168:171], v[208:211], v[112:115], v[168:171]
  s_add_u32 s63, s51, s71
  buffer_load_dwordx4 v[104:107], v9, s[8:11], s63 offen offset:0 sc1
  ds_read_b128 v[188:191], v213 offset:20480
  s_waitcnt vmcnt(16)
  s_waitcnt lgkmcnt(3)
  v_mfma_f32_16x16x32_bf16 v[132:135], v[172:175], v[116:119], v[132:135]
  v_mfma_f32_16x16x32_bf16 v[152:155], v[172:175], v[120:123], v[152:155]
  ds_read_b128 v[192:195], v213 offset:26624
  v_mfma_f32_16x16x32_bf16 v[136:139], v[176:179], v[116:119], v[136:139]
  v_mfma_f32_16x16x32_bf16 v[156:159], v[176:179], v[120:123], v[156:159]
  s_add_u32 s71, s71, 2048
  s_cmp_ge_u32 s71, 55296
  s_cselect_b32 s71, 0, s71
  s_add_u32 s62, s58, s71
  buffer_load_dwordx4 v[108:111], v9, s[8:11], s62 offen offset:0 sc1
  ds_read_b128 v[196:199], v213 offset:27648
  s_waitcnt lgkmcnt(3)
  v_mfma_f32_16x16x32_bf16 v[140:143], v[180:183], v[116:119], v[140:143]
  v_mfma_f32_16x16x32_bf16 v[160:163], v[180:183], v[120:123], v[160:163]
  ds_read_b128 v[200:203], v213 offset:28672
  v_mfma_f32_16x16x32_bf16 v[144:147], v[184:187], v[116:119], v[144:147]
  v_mfma_f32_16x16x32_bf16 v[164:167], v[184:187], v[120:123], v[164:167]
  s_add_u32 s63, s51, s71
  buffer_load_dwordx4 v[112:115], v9, s[8:11], s63 offen offset:0 sc1
  ds_read_b128 v[204:207], v213 offset:29696
  s_waitcnt lgkmcnt(4)
  v_mfma_f32_16x16x32_bf16 v[148:151], v[188:191], v[116:119], v[148:151]
  v_mfma_f32_16x16x32_bf16 v[168:171], v[188:191], v[120:123], v[168:171]
  ds_read_b128 v[208:211], v213 offset:30720
  s_waitcnt vmcnt(16)
  s_waitcnt lgkmcnt(3)
  v_mfma_f32_16x16x32_bf16 v[132:135], v[192:195], v[124:127], v[132:135]
  v_mfma_f32_16x16x32_bf16 v[152:155], v[192:195], v[128:131], v[152:155]
  s_add_u32 s71, s71, 2048
  s_cmp_ge_u32 s71, 55296
  s_cselect_b32 s71, 0, s71
  s_add_u32 s62, s58, s71
  buffer_load_dwordx4 v[116:119], v9, s[8:11], s62 offen offset:0 sc1
  s_barrier
  ds_read_b128 v[172:175], v213 offset:36864
  v_mfma_f32_16x16x32_bf16 v[136:139], v[196:199], v[124:127], v[136:139]
  v_mfma_f32_16x16x32_bf16 v[156:159], v[196:199], v[128:131], v[156:159]
  ds_read_b128 v[176:179], v213 offset:37888
  s_waitcnt lgkmcnt(3)
  v_mfma_f32_16x16x32_bf16 v[140:143], v[200:203], v[124:127], v[140:143]
  v_mfma_f32_16x16x32_bf16 v[160:163], v[200:203], v[128:131], v[160:163]
  s_add_u32 s63, s51, s71
  buffer_load_dwordx4 v[120:123], v9, s[8:11], s63 offen offset:0 sc1
  ds_read_b128 v[180:183], v213 offset:38912
  v_mfma_f32_16x16x32_bf16 v[144:147], v[204:207], v[124:127], v[144:147]
  v_mfma_f32_16x16x32_bf16 v[164:167], v[204:207], v[128:131], v[164:167]
  ds_read_b128 v[184:187], v213 offset:39936
  s_waitcnt lgkmcnt(4)
  v_mfma_f32_16x16x32_bf16 v[148:151], v[208:211], v[124:127], v[148:151]
  v_mfma_f32_16x16x32_bf16 v[168:171], v[208:211], v[128:131], v[168:171]
  ds_read_b128 v[188:191], v213 offset:40960
  s_waitcnt vmcnt(16)
  s_waitcnt lgkmcnt(3)
  v_mfma_f32_16x16x32_bf16 v[132:135], v[172:175], v[52:55], v[132:135]
  v_mfma_f32_16x16x32_bf16 v[152:155], v[172:175], v[56:59], v[152:155]
  ds_read_b128 v[192:195], v213 offset:47104
  v_mfma_f32_16x16x32_bf16 v[136:139], v[176:179], v[52:55], v[136:139]
  v_mfma_f32_16x16x32_bf16 v[156:159], v[176:179], v[56:59], v[156:159]
  s_add_u32 s71, s71, 2048
  s_cmp_ge_u32 s71, 55296
  s_cselect_b32 s71, 0, s71
  s_add_u32 s62, s58, s71
  buffer_load_dwordx4 v[124:127], v9, s[8:11], s62 offen offset:0 sc1
  ds_read_b128 v[196:199], v213 offset:48128
  s_waitcnt lgkmcnt(3)
  v_mfma_f32_16x16x32_bf16 v[140:143], v[180:183], v[52:55], v[140:143]
  v_mfma_f32_16x16x32_bf16 v[160:163], v[180:183], v[56:59], v[160:163]
  ds_read_b128 v[200:203], v213 offset:49152
  v_mfma_f32_16x16x32_bf16 v[144:147], v[184:187], v[52:55], v[144:147]
  v_mfma_f32_16x16x32_bf16 v[164:167], v[184:187], v[56:59], v[164:167]
  s_add_u32 s63, s51, s71
  buffer_load_dwordx4 v[128:131], v9, s[8:11], s63 offen offset:0 sc1
  ds_read_b128 v[204:207], v213 offset:50176
  s_waitcnt lgkmcnt(4)
  v_mfma_f32_16x16x32_bf16 v[148:151], v[188:191], v[52:55], v[148:151]
  v_mfma_f32_16x16x32_bf16 v[168:171], v[188:191], v[56:59], v[168:171]
  ds_read_b128 v[208:211], v213 offset:51200
  s_waitcnt vmcnt(16)
  s_waitcnt lgkmcnt(3)
  v_mfma_f32_16x16x32_bf16 v[132:135], v[192:195], v[60:63], v[132:135]
  v_mfma_f32_16x16x32_bf16 v[152:155], v[192:195], v[64:67], v[152:155]
  s_add_u32 s71, s71, 2048
  s_cmp_ge_u32 s71, 55296
  s_cselect_b32 s71, 0, s71
  s_add_u32 s62, s58, s71
  buffer_load_dwordx4 v[52:55], v9, s[8:11], s62 offen offset:0 sc1
  s_barrier
  ds_read_b128 v[172:175], v213 offset:57344
  v_mfma_f32_16x16x32_bf16 v[136:139], v[196:199], v[60:63], v[136:139]
  v_mfma_f32_16x16x32_bf16 v[156:159], v[196:199], v[64:67], v[156:159]
  ds_read_b128 v[176:179], v213 offset:58368
  s_waitcnt lgkmcnt(3)
  v_mfma_f32_16x16x32_bf16 v[140:143], v[200:203], v[60:63], v[140:143]
  v_mfma_f32_16x16x32_bf16 v[160:163], v[200:203], v[64:67], v[160:163]
  s_add_u32 s63, s51, s71
  buffer_load_dwordx4 v[56:59], v9, s[8:11], s63 offen offset:0 sc1
  ds_read_b128 v[180:183], v213 offset:59392
  v_mfma_f32_16x16x32_bf16 v[144:147], v[204:207], v[60:63], v[144:147]
  v_mfma_f32_16x16x32_bf16 v[164:167], v[204:207], v[64:67], v[164:167]
  ds_read_b128 v[184:187], v213 offset:60416
  s_waitcnt lgkmcnt(4)
  v_mfma_f32_16x16x32_bf16 v[148:151], v[208:211], v[60:63], v[148:151]
  v_mfma_f32_16x16x32_bf16 v[168:171], v[208:211], v[64:67], v[168:171]
  ds_read_b128 v[188:191], v213 offset:61440
  s_waitcnt vmcnt(16)
  s_waitcnt lgkmcnt(3)
  v_mfma_f32_16x16x32_bf16 v[132:135], v[172:175], v[68:71], v[132:135]
  v_mfma_f32_16x16x32_bf16 v[152:155], v[172:175], v[72:75], v[152:155]
  ds_read_b128 v[192:195], v214 offset:2048
  v_mfma_f32_16x16x32_bf16 v[136:139], v[176:179], v[68:71], v[136:139]
  v_mfma_f32_16x16x32_bf16 v[156:159], v[176:179], v[72:75], v[156:159]
  s_add_u32 s71, s71, 2048
  s_cmp_ge_u32 s71, 55296
  s_cselect_b32 s71, 0, s71
  s_add_u32 s62, s58, s71
  buffer_load_dwordx4 v[60:63], v9, s[8:11], s62 offen offset:0 sc1
  ds_read_b128 v[196:199], v214 offset:3072
  s_waitcnt lgkmcnt(3)
  v_mfma_f32_16x16x32_bf16 v[140:143], v[180:183], v[68:71], v[140:143]
  v_mfma_f32_16x16x32_bf16 v[160:163], v[180:183], v[72:75], v[160:163]
  ds_read_b128 v[200:203], v214 offset:4096
  v_mfma_f32_16x16x32_bf16 v[144:147], v[184:187], v[68:71], v[144:147]
  v_mfma_f32_16x16x32_bf16 v[164:167], v[184:187], v[72:75], v[164:167]
  s_add_u32 s63, s51, s71
  buffer_load_dwordx4 v[64:67], v9, s[8:11], s63 offen offset:0 sc1
  ds_read_b128 v[204:207], v214 offset:5120
  s_waitcnt lgkmcnt(4)
  v_mfma_f32_16x16x32_bf16 v[148:151], v[188:191], v[68:71], v[148:151]
  v_mfma_f32_16x16x32_bf16 v[168:171], v[188:191], v[72:75], v[168:171]
  ds_read_b128 v[208:211], v214 offset:6144
  s_waitcnt vmcnt(16)
  s_waitcnt lgkmcnt(3)
  v_mfma_f32_16x16x32_bf16 v[132:135], v[192:195], v[76:79], v[132:135]
  v_mfma_f32_16x16x32_bf16 v[152:155], v[192:195], v[80:83], v[152:155]
  s_add_u32 s71, s71, 2048
  s_cmp_ge_u32 s71, 55296
  s_cselect_b32 s71, 0, s71
  s_add_u32 s62, s58, s71
  buffer_load_dwordx4 v[68:71], v9, s[8:11], s62 offen offset:0 sc1
  s_barrier
  ds_read_b128 v[172:175], v214 offset:12288
  v_mfma_f32_16x16x32_bf16 v[136:139], v[196:199], v[76:79], v[136:139]
  v_mfma_f32_16x16x32_bf16 v[156:159], v[196:199], v[80:83], v[156:159]
  ds_read_b128 v[176:179], v214 offset:13312
  s_waitcnt lgkmcnt(3)
  v_mfma_f32_16x16x32_bf16 v[140:143], v[200:203], v[76:79], v[140:143]
  v_mfma_f32_16x16x32_bf16 v[160:163], v[200:203], v[80:83], v[160:163]
  s_add_u32 s63, s51, s71
  buffer_load_dwordx4 v[72:75], v9, s[8:11], s63 offen offset:0 sc1
  ds_read_b128 v[180:183], v214 offset:14336
  v_mfma_f32_16x16x32_bf16 v[144:147], v[204:207], v[76:79], v[144:147]
  v_mfma_f32_16x16x32_bf16 v[164:167], v[204:207], v[80:83], v[164:167]
  ds_read_b128 v[184:187], v214 offset:15360
  s_waitcnt lgkmcnt(4)
  v_mfma_f32_16x16x32_bf16 v[148:151], v[208:211], v[76:79], v[148:151]
  v_mfma_f32_16x16x32_bf16 v[168:171], v[208:211], v[80:83], v[168:171]
  ds_read_b128 v[188:191], v214 offset:16384
  s_waitcnt vmcnt(16)
  s_waitcnt lgkmcnt(3)
  v_mfma_f32_16x16x32_bf16 v[132:135], v[172:175], v[84:87], v[132:135]
  v_mfma_f32_16x16x32_bf16 v[152:155], v[172:175], v[88:91], v[152:155]
  ds_read_b128 v[192:195], v214 offset:22528
  v_mfma_f32_16x16x32_bf16 v[136:139], v[176:179], v[84:87], v[136:139]
  v_mfma_f32_16x16x32_bf16 v[156:159], v[176:179], v[88:91], v[156:159]
  s_add_u32 s71, s71, 2048
  s_cmp_ge_u32 s71, 55296
  s_cselect_b32 s71, 0, s71
  s_add_u32 s62, s58, s71
  buffer_load_dwordx4 v[76:79], v9, s[8:11], s62 offen offset:0 sc1
  ds_read_b128 v[196:199], v214 offset:23552
  s_waitcnt lgkmcnt(3)
  v_mfma_f32_16x16x32_bf16 v[140:143], v[180:183], v[84:87], v[140:143]
  v_mfma_f32_16x16x32_bf16 v[160:163], v[180:183], v[88:91], v[160:163]
  ds_read_b128 v[200:203], v214 offset:24576
  v_mfma_f32_16x16x32_bf16 v[144:147], v[184:187], v[84:87], v[144:147]
  v_mfma_f32_16x16x32_bf16 v[164:167], v[184:187], v[88:91], v[164:167]
  s_add_u32 s63, s51, s71
  buffer_load_dwordx4 v[80:83], v9, s[8:11], s63 offen offset:0 sc1
  ds_read_b128 v[204:207], v214 offset:25600
  s_waitcnt lgkmcnt(4)
  v_mfma_f32_16x16x32_bf16 v[148:151], v[188:191], v[84:87], v[148:151]
  v_mfma_f32_16x16x32_bf16 v[168:171], v[188:191], v[88:91], v[168:171]
  ds_read_b128 v[208:211], v214 offset:26624
  s_waitcnt vmcnt(16)
  s_waitcnt lgkmcnt(3)
  v_mfma_f32_16x16x32_bf16 v[132:135], v[192:195], v[92:95], v[132:135]
  v_mfma_f32_16x16x32_bf16 v[152:155], v[192:195], v[96:99], v[152:155]
  s_add_u32 s71, s71, 2048
  s_cmp_ge_u32 s71, 55296
  s_cselect_b32 s71, 0, s71
  s_add_u32 s62, s58, s71
  buffer_load_dwordx4 v[84:87], v9, s[8:11], s62 offen offset:0 sc1
  s_barrier
  ds_read_b128 v[172:175], v212 offset:0
  v_mfma_f32_16x16x32_bf16 v[136:139], v[196:199], v[92:95], v[136:139]
  v_mfma_f32_16x16x32_bf16 v[156:159], v[196:199], v[96:99], v[156:159]
  ds_read_b128 v[176:179], v212 offset:1024
  s_waitcnt lgkmcnt(3)
  v_mfma_f32_16x16x32_bf16 v[140:143], v[200:203], v[92:95], v[140:143]
  v_mfma_f32_16x16x32_bf16 v[160:163], v[200:203], v[96:99], v[160:163]
  s_add_u32 s63, s51, s71
  buffer_load_dwordx4 v[88:91], v9, s[8:11], s63 offen offset:0 sc1
  ds_read_b128 v[180:183], v212 offset:2048
  v_mfma_f32_16x16x32_bf16 v[144:147], v[204:207], v[92:95], v[144:147]
  v_mfma_f32_16x16x32_bf16 v[164:167], v[204:207], v[96:99], v[164:167]
  ds_read_b128 v[184:187], v212 offset:3072
  s_waitcnt lgkmcnt(4)
  v_mfma_f32_16x16x32_bf16 v[148:151], v[208:211], v[92:95], v[148:151]
  v_mfma_f32_16x16x32_bf16 v[168:171], v[208:211], v[96:99], v[168:171]
  ds_read_b128 v[188:191], v212 offset:4096
  s_waitcnt vmcnt(16)
  s_waitcnt lgkmcnt(3)
  v_mfma_f32_16x16x32_bf16 v[132:135], v[172:175], v[100:103], v[132:135]
  v_mfma_f32_16x16x32_bf16 v[152:155], v[172:175], v[104:107], v[152:155]
  ds_read_b128 v[192:195], v212 offset:10240
  v_mfma_f32_16x16x32_bf16 v[136:139], v[176:179], v[100:103], v[136:139]
  v_mfma_f32_16x16x32_bf16 v[156:159], v[176:179], v[104:107], v[156:159]
  s_add_u32 s71, s71, 2048
  s_cmp_ge_u32 s71, 55296
  s_cselect_b32 s71, 0, s71
  s_add_u32 s62, s58, s71
  buffer_load_dwordx4 v[92:95], v9, s[8:11], s62 offen offset:0 sc1
  ds_read_b128 v[196:199], v212 offset:11264
  s_waitcnt lgkmcnt(3)
  v_mfma_f32_16x16x32_bf16 v[140:143], v[180:183], v[100:103], v[140:143]
  v_mfma_f32_16x16x32_bf16 v[160:163], v[180:183], v[104:107], v[160:163]
  ds_read_b128 v[200:203], v212 offset:12288
  v_mfma_f32_16x16x32_bf16 v[144:147], v[184:187], v[100:103], v[144:147]
  v_mfma_f32_16x16x32_bf16 v[164:167], v[184:187], v[104:107], v[164:167]
  s_add_u32 s63, s51, s71
  buffer_load_dwordx4 v[96:99], v9, s[8:11], s63 offen offset:0 sc1
  ds_read_b128 v[204:207], v212 offset:13312
  s_waitcnt lgkmcnt(4)
  v_mfma_f32_16x16x32_bf16 v[148:151], v[188:191], v[100:103], v[148:151]
  v_mfma_f32_16x16x32_bf16 v[168:171], v[188:191], v[104:107], v[168:171]
  ds_read_b128 v[208:211], v212 offset:14336
  s_waitcnt vmcnt(16)
  s_waitcnt lgkmcnt(3)
  v_mfma_f32_16x16x32_bf16 v[132:135], v[192:195], v[108:111], v[132:135]
  v_mfma_f32_16x16x32_bf16 v[152:155], v[192:195], v[112:115], v[152:155]
  s_add_u32 s71, s71, 2048
  s_cmp_ge_u32 s71, 55296
  s_cselect_b32 s71, 0, s71
  s_add_u32 s62, s58, s71
  buffer_load_dwordx4 v[100:103], v9, s[8:11], s62 offen offset:0 sc1
  s_barrier
  ds_read_b128 v[172:175], v212 offset:20480
  v_mfma_f32_16x16x32_bf16 v[136:139], v[196:199], v[108:111], v[136:139]
  v_mfma_f32_16x16x32_bf16 v[156:159], v[196:199], v[112:115], v[156:159]
  ds_read_b128 v[176:179], v212 offset:21504
  s_waitcnt lgkmcnt(3)
  v_mfma_f32_16x16x32_bf16 v[140:143], v[200:203], v[108:111], v[140:143]
  v_mfma_f32_16x16x32_bf16 v[160:163], v[200:203], v[112:115], v[160:163]
  s_add_u32 s63, s51, s71
  buffer_load_dwordx4 v[104:107], v9, s[8:11], s63 offen offset:0 sc1
  ds_read_b128 v[180:183], v212 offset:22528
  v_mfma_f32_16x16x32_bf16 v[144:147], v[204:207], v[108:111], v[144:147]
  v_mfma_f32_16x16x32_bf16 v[164:167], v[204:207], v[112:115], v[164:167]
  ds_read_b128 v[184:187], v212 offset:23552
  s_waitcnt lgkmcnt(4)
  v_mfma_f32_16x16x32_bf16 v[148:151], v[208:211], v[108:111], v[148:151]
  v_mfma_f32_16x16x32_bf16 v[168:171], v[208:211], v[112:115], v[168:171]
  ds_read_b128 v[188:191], v212 offset:24576
  s_waitcnt vmcnt(16)
  s_waitcnt lgkmcnt(3)
  v_mfma_f32_16x16x32_bf16 v[132:135], v[172:175], v[116:119], v[132:135]
  v_mfma_f32_16x16x32_bf16 v[152:155], v[172:175], v[120:123], v[152:155]
  ds_read_b128 v[192:195], v212 offset:30720
  v_mfma_f32_16x16x32_bf16 v[136:139], v[176:179], v[116:119], v[136:139]
  v_mfma_f32_16x16x32_bf16 v[156:159], v[176:179], v[120:123], v[156:159]
  ds_read_b128 v[196:199], v212 offset:31744
  s_waitcnt lgkmcnt(3)
  v_mfma_f32_16x16x32_bf16 v[140:143], v[180:183], v[116:119], v[140:143]
  v_mfma_f32_16x16x32_bf16 v[160:163], v[180:183], v[120:123], v[160:163]
  ds_read_b128 v[200:203], v212 offset:32768
  v_mfma_f32_16x16x32_bf16 v[144:147], v[184:187], v[116:119], v[144:147]
  v_mfma_f32_16x16x32_bf16 v[164:167], v[184:187], v[120:123], v[164:167]
  ds_read_b128 v[204:207], v212 offset:33792
  s_waitcnt lgkmcnt(4)
  v_mfma_f32_16x16x32_bf16 v[148:151], v[188:191], v[116:119], v[148:151]
  v_mfma_f32_16x16x32_bf16 v[168:171], v[188:191], v[120:123], v[168:171]
  ds_read_b128 v[208:211], v212 offset:34816
  s_waitcnt vmcnt(14)
  s_waitcnt lgkmcnt(3)
  v_mfma_f32_16x16x32_bf16 v[132:135], v[192:195], v[124:127], v[132:135]
  v_mfma_f32_16x16x32_bf16 v[152:155], v[192:195], v[128:131], v[152:155]
  s_barrier
  ds_read_b128 v[172:175], v212 offset:40960
  v_mfma_f32_16x16x32_bf16 v[136:139], v[196:199], v[124:127], v[136:139]
  v_mfma_f32_16x16x32_bf16 v[156:159], v[196:199], v[128:131], v[156:159]
  ds_read_b128 v[176:179], v212 offset:41984
  s_waitcnt lgkmcnt(3)
  v_mfma_f32_16x16x32_bf16 v[140:143], v[200:203], v[124:127], v[140:143]
  v_mfma_f32_16x16x32_bf16 v[160:163], v[200:203], v[128:131], v[160:163]
  ds_read_b128 v[180:183], v212 offset:43008
  v_mfma_f32_16x16x32_bf16 v[144:147], v[204:207], v[124:127], v[144:147]
  v_mfma_f32_16x16x32_bf16 v[164:167], v[204:207], v[128:131], v[164:167]
  ds_read_b128 v[184:187], v212 offset:44032
  s_waitcnt lgkmcnt(4)
  v_mfma_f32_16x16x32_bf16 v[148:151], v[208:211], v[124:127], v[148:151]
  v_mfma_f32_16x16x32_bf16 v[168:171], v[208:211], v[128:131], v[168:171]
  ds_read_b128 v[188:191], v212 offset:45056
  s_waitcnt vmcnt(12)
  s_waitcnt lgkmcnt(3)
  v_mfma_f32_16x16x32_bf16 v[132:135], v[172:175], v[52:55], v[132:135]
  v_mfma_f32_16x16x32_bf16 v[152:155], v[172:175], v[56:59], v[152:155]
  ds_read_b128 v[192:195], v212 offset:51200
  v_mfma_f32_16x16x32_bf16 v[136:139], v[176:179], v[52:55], v[136:139]
  v_mfma_f32_16x16x32_bf16 v[156:159], v[176:179], v[56:59], v[156:159]
  ds_read_b128 v[196:199], v212 offset:52224
  s_waitcnt lgkmcnt(3)
  v_mfma_f32_16x16x32_bf16 v[140:143], v[180:183], v[52:55], v[140:143]
  v_mfma_f32_16x16x32_bf16 v[160:163], v[180:183], v[56:59], v[160:163]
  ds_read_b128 v[200:203], v212 offset:53248
  v_mfma_f32_16x16x32_bf16 v[144:147], v[184:187], v[52:55], v[144:147]
  v_mfma_f32_16x16x32_bf16 v[164:167], v[184:187], v[56:59], v[164:167]
  ds_read_b128 v[204:207], v212 offset:54272
  s_waitcnt lgkmcnt(4)
  v_mfma_f32_16x16x32_bf16 v[148:151], v[188:191], v[52:55], v[148:151]
  v_mfma_f32_16x16x32_bf16 v[168:171], v[188:191], v[56:59], v[168:171]
  ds_read_b128 v[208:211], v212 offset:55296
  s_waitcnt vmcnt(10)
  s_waitcnt lgkmcnt(3)
  v_mfma_f32_16x16x32_bf16 v[132:135], v[192:195], v[60:63], v[132:135]
  v_mfma_f32_16x16x32_bf16 v[152:155], v[192:195], v[64:67], v[152:155]
  s_barrier
  ds_read_b128 v[172:175], v212 offset:61440
  v_mfma_f32_16x16x32_bf16 v[136:139], v[196:199], v[60:63], v[136:139]
  v_mfma_f32_16x16x32_bf16 v[156:159], v[196:199], v[64:67], v[156:159]
  ds_read_b128 v[176:179], v212 offset:62464
  s_waitcnt lgkmcnt(3)
  v_mfma_f32_16x16x32_bf16 v[140:143], v[200:203], v[60:63], v[140:143]
  v_mfma_f32_16x16x32_bf16 v[160:163], v[200:203], v[64:67], v[160:163]
  ds_read_b128 v[180:183], v212 offset:63488
  v_mfma_f32_16x16x32_bf16 v[144:147], v[204:207], v[60:63], v[144:147]
  v_mfma_f32_16x16x32_bf16 v[164:167], v[204:207], v[64:67], v[164:167]
  ds_read_b128 v[184:187], v212 offset:64512
  s_waitcnt lgkmcnt(4)
  v_mfma_f32_16x16x32_bf16 v[148:151], v[208:211], v[60:63], v[148:151]
  v_mfma_f32_16x16x32_bf16 v[168:171], v[208:211], v[64:67], v[168:171]
  ds_read_b128 v[188:191], v213 offset:0
  s_waitcnt vmcnt(8)
  s_waitcnt lgkmcnt(3)
  v_mfma_f32_16x16x32_bf16 v[132:135], v[172:175], v[68:71], v[132:135]
  v_mfma_f32_16x16x32_bf16 v[152:155], v[172:175], v[72:75], v[152:155]
  ds_read_b128 v[192:195], v213 offset:6144
  v_mfma_f32_16x16x32_bf16 v[136:139], v[176:179], v[68:71], v[136:139]
  v_mfma_f32_16x16x32_bf16 v[156:159], v[176:179], v[72:75], v[156:159]
  ds_read_b128 v[196:199], v213 offset:7168
  s_waitcnt lgkmcnt(3)
  v_mfma_f32_16x16x32_bf16 v[140:143], v[180:183], v[68:71], v[140:143]
  v_mfma_f32_16x16x32_bf16 v[160:163], v[180:183], v[72:75], v[160:163]
  ds_read_b128 v[200:203], v213 offset:8192
  v_mfma_f32_16x16x32_bf16 v[144:147], v[184:187], v[68:71], v[144:147]
  v_mfma_f32_16x16x32_bf16 v[164:167], v[184:187], v[72:75], v[164:167]
  ds_read_b128 v[204:207], v213 offset:9216
  s_waitcnt lgkmcnt(4)
  v_mfma_f32_16x16x32_bf16 v[148:151], v[188:191], v[68:71], v[148:151]
  v_mfma_f32_16x16x32_bf16 v[168:171], v[188:191], v[72:75], v[168:171]
  ds_read_b128 v[208:211], v213 offset:10240
  s_waitcnt vmcnt(6)
  s_waitcnt lgkmcnt(3)
  v_mfma_f32_16x16x32_bf16 v[132:135], v[192:195], v[76:79], v[132:135]
  v_mfma_f32_16x16x32_bf16 v[152:155], v[192:195], v[80:83], v[152:155]
  s_barrier
  ds_read_b128 v[172:175], v213 offset:16384
  v_mfma_f32_16x16x32_bf16 v[136:139], v[196:199], v[76:79], v[136:139]
  v_mfma_f32_16x16x32_bf16 v[156:159], v[196:199], v[80:83], v[156:159]
  ds_read_b128 v[176:179], v213 offset:17408
  s_waitcnt lgkmcnt(3)
  v_mfma_f32_16x16x32_bf16 v[140:143], v[200:203], v[76:79], v[140:143]
  v_mfma_f32_16x16x32_bf16 v[160:163], v[200:203], v[80:83], v[160:163]
  ds_read_b128 v[180:183], v213 offset:18432
  v_mfma_f32_16x16x32_bf16 v[144:147], v[204:207], v[76:79], v[144:147]
  v_mfma_f32_16x16x32_bf16 v[164:167], v[204:207], v[80:83], v[164:167]
  ds_read_b128 v[184:187], v213 offset:19456
  s_waitcnt lgkmcnt(4)
  v_mfma_f32_16x16x32_bf16 v[148:151], v[208:211], v[76:79], v[148:151]
  v_mfma_f32_16x16x32_bf16 v[168:171], v[208:211], v[80:83], v[168:171]
  ds_read_b128 v[188:191], v213 offset:20480
  s_waitcnt vmcnt(4)
  s_waitcnt lgkmcnt(3)
  v_mfma_f32_16x16x32_bf16 v[132:135], v[172:175], v[84:87], v[132:135]
  v_mfma_f32_16x16x32_bf16 v[152:155], v[172:175], v[88:91], v[152:155]
  ds_read_b128 v[192:195], v213 offset:26624
  v_mfma_f32_16x16x32_bf16 v[136:139], v[176:179], v[84:87], v[136:139]
  v_mfma_f32_16x16x32_bf16 v[156:159], v[176:179], v[88:91], v[156:159]
  ds_read_b128 v[196:199], v213 offset:27648
  s_waitcnt lgkmcnt(3)
  v_mfma_f32_16x16x32_bf16 v[140:143], v[180:183], v[84:87], v[140:143]
  v_mfma_f32_16x16x32_bf16 v[160:163], v[180:183], v[88:91], v[160:163]
  ds_read_b128 v[200:203], v213 offset:28672
  v_mfma_f32_16x16x32_bf16 v[144:147], v[184:187], v[84:87], v[144:147]
  v_mfma_f32_16x16x32_bf16 v[164:167], v[184:187], v[88:91], v[164:167]
  ds_read_b128 v[204:207], v213 offset:29696
  s_waitcnt lgkmcnt(4)
  v_mfma_f32_16x16x32_bf16 v[148:151], v[188:191], v[84:87], v[148:151]
  v_mfma_f32_16x16x32_bf16 v[168:171], v[188:191], v[88:91], v[168:171]
  ds_read_b128 v[208:211], v213 offset:30720
  s_waitcnt vmcnt(2)
  s_waitcnt lgkmcnt(3)
  v_mfma_f32_16x16x32_bf16 v[132:135], v[192:195], v[92:95], v[132:135]
  v_mfma_f32_16x16x32_bf16 v[152:155], v[192:195], v[96:99], v[152:155]
  s_barrier
  ds_read_b128 v[172:175], v213 offset:36864
  v_mfma_f32_16x16x32_bf16 v[136:139], v[196:199], v[92:95], v[136:139]
  v_mfma_f32_16x16x32_bf16 v[156:159], v[196:199], v[96:99], v[156:159]
  ds_read_b128 v[176:179], v213 offset:37888
  s_waitcnt lgkmcnt(3)
  v_mfma_f32_16x16x32_bf16 v[140:143], v[200:203], v[92:95], v[140:143]
  v_mfma_f32_16x16x32_bf16 v[160:163], v[200:203], v[96:99], v[160:163]
  ds_read_b128 v[180:183], v213 offset:38912
  v_mfma_f32_16x16x32_bf16 v[144:147], v[204:207], v[92:95], v[144:147]
  v_mfma_f32_16x16x32_bf16 v[164:167], v[204:207], v[96:99], v[164:167]
  ds_read_b128 v[184:187], v213 offset:39936
  s_waitcnt lgkmcnt(4)
  v_mfma_f32_16x16x32_bf16 v[148:151], v[208:211], v[92:95], v[148:151]
  v_mfma_f32_16x16x32_bf16 v[168:171], v[208:211], v[96:99], v[168:171]
  ds_read_b128 v[188:191], v213 offset:40960
  s_waitcnt vmcnt(0)
  s_waitcnt lgkmcnt(3)
  v_mfma_f32_16x16x32_bf16 v[132:135], v[172:175], v[100:103], v[132:135]
  v_mfma_f32_16x16x32_bf16 v[152:155], v[172:175], v[104:107], v[152:155]
  v_mfma_f32_16x16x32_bf16 v[136:139], v[176:179], v[100:103], v[136:139]
  v_mfma_f32_16x16x32_bf16 v[156:159], v[176:179], v[104:107], v[156:159]
  s_waitcnt lgkmcnt(1)
  v_mfma_f32_16x16x32_bf16 v[140:143], v[180:183], v[100:103], v[140:143]
  v_mfma_f32_16x16x32_bf16 v[160:163], v[180:183], v[104:107], v[160:163]
  v_mfma_f32_16x16x32_bf16 v[144:147], v[184:187], v[100:103], v[144:147]
  v_mfma_f32_16x16x32_bf16 v[164:167], v[184:187], v[104:107], v[164:167]
  s_waitcnt lgkmcnt(0)
  v_mfma_f32_16x16x32_bf16 v[148:151], v[188:191], v[100:103], v[148:151]
  v_mfma_f32_16x16x32_bf16 v[168:171], v[188:191], v[104:107], v[168:171]
  ds_write_b128 v215, v[152:155] offset:0
  ds_write_b128 v215, v[156:159] offset:1024
  s_nop 0
  ds_write_b128 v215, v[160:163] offset:2048
  s_nop 0
  ds_write_b128 v215, v[164:167] offset:3072
  s_nop 1
  ds_write_b128 v215, v[168:171] offset:4096
  s_waitcnt lgkmcnt(0)
  s_barrier
  ds_read_b128 v[152:155], v216 offset:0
  ds_read_b128 v[156:159], v216 offset:1024
  ds_read_b128 v[160:163], v216 offset:2048
  ds_read_b128 v[164:167], v216 offset:3072
  ds_read_b128 v[168:171], v216 offset:4096
  s_waitcnt lgkmcnt(0)
  v_lshlrev_b32 v200, 16, v34
  v_and_b32 v201, 0xffff0000, v34
  v_lshlrev_b32 v202, 16, v35
  v_and_b32 v203, 0xffff0000, v35
  v_lshlrev_b32 v192, 16, v24
  v_and_b32 v193, 0xffff0000, v24
  v_lshlrev_b32 v194, 16, v25
  v_and_b32 v195, 0xffff0000, v25
  v_pk_add_f32 v[132:133], v[132:133], v[152:153]
  v_pk_add_f32 v[134:135], v[134:135], v[154:155]
  v_pk_add_f32 v[200:201], v[200:201], v[132:133]
  v_pk_add_f32 v[202:203], v[202:203], v[134:135]
  v_pk_add_f32 v[192:193], v[192:193], v[200:201]
  v_pk_add_f32 v[194:195], v[194:195], v[202:203]
  v_cvt_pk_bf16_f32 v208, v192, v193
  v_cvt_pk_bf16_f32 v209, v194, v195
  ds_write_b64 v14, v[208:209] offset:0
  v_lshlrev_b32 v204, 16, v36
  v_and_b32 v205, 0xffff0000, v36
  v_lshlrev_b32 v206, 16, v37
  v_and_b32 v207, 0xffff0000, v37
  v_lshlrev_b32 v196, 16, v26
  v_and_b32 v197, 0xffff0000, v26
  v_lshlrev_b32 v198, 16, v27
  v_and_b32 v199, 0xffff0000, v27
  v_pk_add_f32 v[136:137], v[136:137], v[156:157]
  v_pk_add_f32 v[138:139], v[138:139], v[158:159]
  v_pk_add_f32 v[204:205], v[204:205], v[136:137]
  v_pk_add_f32 v[206:207], v[206:207], v[138:139]
  v_pk_add_f32 v[196:197], v[196:197], v[204:205]
  v_pk_add_f32 v[198:199], v[198:199], v[206:207]
  v_cvt_pk_bf16_f32 v210, v196, v197
  v_cvt_pk_bf16_f32 v211, v198, v199
  ds_write_b64 v14, v[210:211] offset:32
  v_lshlrev_b32 v200, 16, v38
  v_and_b32 v201, 0xffff0000, v38
  v_lshlrev_b32 v202, 16, v39
  v_and_b32 v203, 0xffff0000, v39
  v_lshlrev_b32 v192, 16, v28
  v_and_b32 v193, 0xffff0000, v28
  v_lshlrev_b32 v194, 16, v29
  v_and_b32 v195, 0xffff0000, v29
  v_pk_add_f32 v[140:141], v[140:141], v[160:161]
  v_pk_add_f32 v[142:143], v[142:143], v[162:163]
  v_pk_add_f32 v[200:201], v[200:201], v[140:141]
  v_pk_add_f32 v[202:203], v[202:203], v[142:143]
  v_pk_add_f32 v[192:193], v[192:193], v[200:201]
  v_pk_add_f32 v[194:195], v[194:195], v[202:203]
  v_cvt_pk_bf16_f32 v52, v192, v193
  v_cvt_pk_bf16_f32 v53, v194, v195
  ds_write_b64 v14, v[52:53] offset:64
  v_lshlrev_b32 v204, 16, v40
  v_and_b32 v205, 0xffff0000, v40
  v_lshlrev_b32 v206, 16, v41
  v_and_b32 v207, 0xffff0000, v41
  v_lshlrev_b32 v196, 16, v30
  v_and_b32 v197, 0xffff0000, v30
  v_lshlrev_b32 v198, 16, v31
  v_and_b32 v199, 0xffff0000, v31
  v_pk_add_f32 v[144:145], v[144:145], v[164:165]
  v_pk_add_f32 v[146:147], v[146:147], v[166:167]
  v_pk_add_f32 v[204:205], v[204:205], v[144:145]
  v_pk_add_f32 v[206:207], v[206:207], v[146:147]
  v_pk_add_f32 v[196:197], v[196:197], v[204:205]
  v_pk_add_f32 v[198:199], v[198:199], v[206:207]
  v_cvt_pk_bf16_f32 v54, v196, v197
  v_cvt_pk_bf16_f32 v55, v198, v199
  ds_write_b64 v14, v[54:55] offset:96
  v_lshlrev_b32 v200, 16, v42
  v_and_b32 v201, 0xffff0000, v42
  v_lshlrev_b32 v202, 16, v43
  v_and_b32 v203, 0xffff0000, v43
  v_lshlrev_b32 v192, 16, v32
  v_and_b32 v193, 0xffff0000, v32
  v_lshlrev_b32 v194, 16, v33
  v_and_b32 v195, 0xffff0000, v33
  v_pk_add_f32 v[148:149], v[148:149], v[168:169]
  v_pk_add_f32 v[150:151], v[150:151], v[170:171]
  v_pk_add_f32 v[200:201], v[200:201], v[148:149]
  v_pk_add_f32 v[202:203], v[202:203], v[150:151]
  v_pk_add_f32 v[192:193], v[192:193], v[200:201]
  v_pk_add_f32 v[194:195], v[194:195], v[202:203]
  v_cvt_pk_bf16_f32 v208, v192, v193
  v_cvt_pk_bf16_f32 v209, v194, v195
  ds_write_b64 v14, v[208:209] offset:128
  v_add_u32 v1, s59, v9
  s_waitcnt lgkmcnt(0)
  ds_read_b128 v[172:175], v1 offset:0
  ds_read_b128 v[176:179], v1 offset:1024
  ds_read_b128 v[180:183], v1 offset:2048
  s_waitcnt lgkmcnt(2)
  buffer_store_dwordx4 v[172:175], v20, s[16:19], s55 offen
  s_waitcnt lgkmcnt(1)
  buffer_store_dwordx4 v[176:179], v21, s[16:19], s55 offen
  s_waitcnt lgkmcnt(0)
  s_mov_b64 exec, 0xffffffff
  buffer_store_dwordx4 v[180:183], v22, s[16:19], s55 offen
  s_endpgm
kp_redo0:
  s_waitcnt vmcnt(0) lgkmcnt(0)
  s_mov_b32 s60, 400000
kp_pollr0:
  s_sub_u32 s60, s60, 1
  s_cbranch_scc1 kp_end
  buffer_load_dword v46, v45, s[36:39], 0 offen sc1
  s_waitcnt vmcnt(0)
  v_cmp_eq_u32 vcc, 0, v46
  s_cbranch_vccnz kp_pollr0
kp_gor0:
  s_add_u32 s12, s6, 0x1c00000
  s_addc_u32 s13, s7, 0
  s_mov_b32 s14, 0x6c0000
  s_mov_b32 s15, 0x00020000
  s_and_b32 s43, s47, 3
  s_mul_i32 s56, s43, 102400
  s_mul_i32 s43, s67, 3538944
  s_add_u32 s56, s56, s43
  s_add_u32 s56, s56, 0
  s_mov_b32 s71, 0
  v_mov_b32 v132, 0
  v_mov_b32 v133, 0
  v_mov_b32 v134, 0
  v_mov_b32 v135, 0
  v_mov_b32 v136, 0
  v_mov_b32 v137, 0
  v_mov_b32 v138, 0
  v_mov_b32 v139, 0
  v_mov_b32 v140, 0
  v_mov_b32 v141, 0
  v_mov_b32 v142, 0
  v_mov_b32 v143, 0
  v_mov_b32 v144, 0
  v_mov_b32 v145, 0
  v_mov_b32 v146, 0
  v_mov_b32 v147, 0
  v_mov_b32 v148, 0
  v_mov_b32 v149, 0
  v_mov_b32 v150, 0
  v_mov_b32 v151, 0
kp_rl0:
  s_add_u32 s62, s58, s71
  buffer_load_dwordx4 v[52:55], v9, s[8:11], s62 offen sc1
  s_cmp_lt_u32 s71, 16384
  s_cbranch_scc1 kp_rs0
  buffer_load_dwordx2 v[52:53], v15, s[8:11], s62 offen offset:0 sc1
  buffer_load_dwordx2 v[54:55], v15, s[8:11], s62 offen offset:128 sc1
kp_rs0:
  s_add_u32 s43, s56, 4096
  buffer_load_dwordx4 v[152:155], v9, s[12:15], s56 offen offset:0
  buffer_load_dwordx4 v[156:159], v9, s[12:15], s56 offen offset:1024
  buffer_load_dwordx4 v[160:163], v9, s[12:15], s56 offen offset:2048
  buffer_load_dwordx4 v[164:167], v9, s[12:15], s56 offen offset:3072
  buffer_load_dwordx4 v[168:171], v9, s[12:15], s43 offen offset:0
  s_waitcnt vmcnt(0)
  v_mfma_f32_16x16x32_bf16 v[132:135], v[152:155], v[52:55], v[132:135]
  v_mfma_f32_16x16x32_bf16 v[136:139], v[156:159], v[52:55], v[136:139]
  v_mfma_f32_16x16x32_bf16 v[140:143], v[160:163], v[52:55], v[140:143]
  v_mfma_f32_16x16x32_bf16 v[144:147], v[164:167], v[52:55], v[144:147]
  v_mfma_f32_16x16x32_bf16 v[148:151], v[168:171], v[52:55], v[148:151]
  s_add_u32 s56, s56, 5120
  s_add_u32 s71, s71, 1024
  s_cmp_lt_u32 s71, 20480
  s_cbranch_scc1 kp_rl0
  s_nop 7
  s_branch kp_back0
kp_redo1:
  s_waitcnt vmcnt(0) lgkmcnt(0)
  s_mov_b32 s60, 400000
kp_pollr1:
  s_sub_u32 s60, s60, 1
  s_cbranch_scc1 kp_end
  buffer_load_dword v46, v45, s[36:39], 0 offen sc1
  s_waitcnt vmcnt(0)
  v_cmp_eq_u32 vcc, 0, v46
  s_cbranch_vccnz kp_pollr1
kp_gor1:
  s_add_u32 s12, s6, 0x1c00000
  s_addc_u32 s13, s7, 0
  s_mov_b32 s14, 0x6c0000
  s_mov_b32 s15, 0x00020000
  s_and_b32 s43, s47, 3
  s_mul_i32 s56, s43, 102400
  s_mul_i32 s43, s67, 3538944
  s_add_u32 s56, s56, s43
  s_add_u32 s56, s56, 409600
  s_mov_b32 s71, 0
  v_mov_b32 v132, 0
  v_mov_b32 v133, 0
  v_mov_b32 v134, 0
  v_mov_b32 v135, 0
  v_mov_b32 v136, 0
  v_mov_b32 v137, 0
  v_mov_b32 v138, 0
  v_mov_b32 v139, 0
  v_mov_b32 v140, 0
  v_mov_b32 v141, 0
  v_mov_b32 v142, 0
  v_mov_b32 v143, 0
  v_mov_b32 v144, 0
  v_mov_b32 v145, 0
  v_mov_b32 v146, 0
  v_mov_b32 v147, 0
  v_mov_b32 v148, 0
  v_mov_b32 v149, 0
  v_mov_b32 v150, 0
  v_mov_b32 v151, 0
kp_rl1:
  s_add_u32 s62, s58, s71
  buffer_load_dwordx4 v[52:55], v9, s[8:11], s62 offen sc1
  s_add_u32 s43, s56, 4096
  buffer_load_dwordx4 v[152:155], v9, s[12:15], s56 offen offset:0
  buffer_load_dwordx4 v[156:159], v9, s[12:15], s56 offen offset:1024
  buffer_load_dwordx4 v[160:163], v9, s[12:15], s56 offen offset:2048
  buffer_load_dwordx4 v[164:167], v9, s[12:15], s56 offen offset:3072
  buffer_load_dwordx4 v[168:171], v9, s[12:15], s43 offen offset:0
  s_waitcnt vmcnt(0)
  v_mfma_f32_16x16x32_bf16 v[132:135], v[152:155], v[52:55], v[132:135]
  v_mfma_f32_16x16x32_bf16 v[136:139], v[156:159], v[52:55], v[136:139]
  v_mfma_f32_16x16x32_bf16 v[140:143], v[160:163], v[52:55], v[140:143]
  v_mfma_f32_16x16x32_bf16 v[144:147], v[164:167], v[52:55], v[144:147]
  v_mfma_f32_16x16x32_bf16 v[148:151], v[168:171], v[52:55], v[148:151]
  s_add_u32 s56, s56, 5120
  s_add_u32 s71, s71, 1024
  s_cmp_lt_u32 s71, 20480
  s_cbranch_scc1 kp_rl1
  s_nop 7
  s_branch kp_back1
kp_redo2:
  s_waitcnt vmcnt(0) lgkmcnt(0)
  s_mov_b32 s60, 400000
kp_pollr2:
  s_sub_u32 s60, s60, 1
  s_cbranch_scc1 kp_end
  buffer_load_dword v46, v45, s[36:39], 0 offen sc1
  s_waitcnt vmcnt(0)
  v_cmp_eq_u32 vcc, 0, v46
  s_cbranch_vccnz kp_pollr2
kp_gor2:
  s_add_u32 s12, s6, 0x1c00000
  s_addc_u32 s13, s7, 0
  s_mov_b32 s14, 0x6c0000
  s_mov_b32 s15, 0x00020000
  s_and_b32 s43, s47, 3
  s_mul_i32 s56, s43, 102400
  s_mul_i32 s43, s67, 3538944
  s_add_u32 s56, s56, s43
  s_add_u32 s56, s56, 819200
  s_mov_b32 s71, 0
  v_mov_b32 v132, 0
  v_mov_b32 v133, 0
  v_mov_b32 v134, 0
  v_mov_b32 v135, 0
  v_mov_b32 v136, 0
  v_mov_b32 v137, 0
  v_mov_b32 v138, 0
  v_mov_b32 v139, 0
  v_mov_b32 v140, 0
  v_mov_b32 v141, 0
  v_mov_b32 v142, 0
  v_mov_b32 v143, 0
  v_mov_b32 v144, 0
  v_mov_b32 v145, 0
  v_mov_b32 v146, 0
  v_mov_b32 v147, 0
  v_mov_b32 v148, 0
  v_mov_b32 v149, 0
  v_mov_b32 v150, 0
  v_mov_b32 v151, 0
kp_rl2:
  s_add_u32 s62, s58, s71
  buffer_load_dwordx4 v[52:55], v9, s[8:11], s62 offen sc1
  s_add_u32 s43, s56, 4096
  buffer_load_dwordx4 v[152:155], v9, s[12:15], s56 offen offset:0
  buffer_load_dwordx4 v[156:159], v9, s[12:15], s56 offen offset:1024
  buffer_load_dwordx4 v[160:163], v9, s[12:15], s56 offen offset:2048
  buffer_load_dwordx4 v[164:167], v9, s[12:15], s56 offen offset:3072
  buffer_load_dwordx4 v[168:171], v9, s[12:15], s43 offen offset:0
  s_waitcnt vmcnt(0)
  v_mfma_f32_16x16x32_bf16 v[132:135], v[152:155], v[52:55], v[132:135]
  v_mfma_f32_16x16x32_bf16 v[136:139], v[156:159], v[52:55], v[136:139]
  v_mfma_f32_16x16x32_bf16 v[140:143], v[160:163], v[52:55], v[140:143]
  v_mfma_f32_16x16x32_bf16 v[144:147], v[164:167], v[52:55], v[144:147]
  v_mfma_f32_16x16x32_bf16 v[148:151], v[168:171], v[52:55], v[148:151]
  s_add_u32 s56, s56, 5120
  s_add_u32 s71, s71, 1024
  s_cmp_lt_u32 s71, 20480
  s_cbranch_scc1 kp_rl2
  s_nop 7
  s_branch kp_back2
kp_redo3:
  s_waitcnt vmcnt(0) lgkmcnt(0)
  s_mov_b32 s60, 400000
kp_pollr3:
  s_sub_u32 s60, s60, 1
  s_cbranch_scc1 kp_end
  buffer_load_dword v46, v45, s[36:39], 0 offen sc1
  s_waitcnt vmcnt(0)
  v_cmp_eq_u32 vcc, 0, v46
  s_cbranch_vccnz kp_pollr3
kp_gor3:
  s_add_u32 s12, s6, 0x1c00000
  s_addc_u32 s13, s7, 0
  s_mov_b32 s14, 0x6c0000
  s_mov_b32 s15, 0x00020000
  s_and_b32 s43, s49, 7
  s_mul_i32 s56, s43, 143360
  s_mul_i32 s43, s67, 3538944
  s_add_u32 s56, s56, s43
  s_add_u32 s56, s56, 1228800
  s_mov_b32 s71, 0
  v_mov_b32 v116, 0
  v_mov_b32 v117, 0
  v_mov_b32 v118, 0
  v_mov_b32 v119, 0
  v_mov_b32 v120, 0
  v_mov_b32 v121, 0
  v_mov_b32 v122, 0
  v_mov_b32 v123, 0
  v_mov_b32 v124, 0
  v_mov_b32 v125, 0
  v_mov_b32 v126, 0
  v_mov_b32 v127, 0
  v_mov_b32 v128, 0
  v_mov_b32 v129, 0
  v_mov_b32 v130, 0
  v_mov_b32 v131, 0
  v_mov_b32 v132, 0
  v_mov_b32 v133, 0
  v_mov_b32 v134, 0
  v_mov_b32 v135, 0
  v_mov_b32 v136, 0
  v_mov_b32 v137, 0
  v_mov_b32 v138, 0
  v_mov_b32 v139, 0
  v_mov_b32 v140, 0
  v_mov_b32 v141, 0
  v_mov_b32 v142, 0
  v_mov_b32 v143, 0
  v_mov_b32 v144, 0
  v_mov_b32 v145, 0
  v_mov_b32 v146, 0
  v_mov_b32 v147, 0
  v_mov_b32 v148, 0
  v_mov_b32 v149, 0
  v_mov_b32 v150, 0
  v_mov_b32 v151, 0
  v_mov_b32 v152, 0
  v_mov_b32 v153, 0
  v_mov_b32 v154, 0
  v_mov_b32 v155, 0
  v_mov_b32 v156, 0
  v_mov_b32 v157, 0
  v_mov_b32 v158, 0
  v_mov_b32 v159, 0
  v_mov_b32 v160, 0
  v_mov_b32 v161, 0
  v_mov_b32 v162, 0
  v_mov_b32 v163, 0
  v_mov_b32 v164, 0
  v_mov_b32 v165, 0
  v_mov_b32 v166, 0
  v_mov_b32 v167, 0
  v_mov_b32 v168, 0
  v_mov_b32 v169, 0
  v_mov_b32 v170, 0
  v_mov_b32 v171, 0
kp_rl3:
  s_add_u32 s62, s58, s71
  s_add_u32 s63, s62, 20480
  buffer_load_dwordx4 v[52:55], v9, s[8:11], s62 offen sc1
  buffer_load_dwordx4 v[56:59], v9, s[8:11], s63 offen sc1
  s_add_u32 s43, s56, 4096
  buffer_load_dwordx4 v[172:175], v9, s[12:15], s56 offen offset:0
  buffer_load_dwordx4 v[176:179], v9, s[12:15], s56 offen offset:1024
  buffer_load_dwordx4 v[180:183], v9, s[12:15], s56 offen offset:2048
  buffer_load_dwordx4 v[184:187], v9, s[12:15], s56 offen offset:3072
  buffer_load_dwordx4 v[188:191], v9, s[12:15], s43 offen offset:0
  buffer_load_dwordx4 v[192:195], v9, s[12:15], s43 offen offset:1024
  buffer_load_dwordx4 v[196:199], v9, s[12:15], s43 offen offset:2048
  s_waitcnt vmcnt(0)
  v_mfma_f32_16x16x32_bf16 v[116:119], v[172:175], v[52:55], v[116:119]
  v_mfma_f32_16x16x32_bf16 v[144:147], v[172:175], v[56:59], v[144:147]
  v_mfma_f32_16x16x32_bf16 v[120:123], v[176:179], v[52:55], v[120:123]
  v_mfma_f32_16x16x32_bf16 v[148:151], v[176:179], v[56:59], v[148:151]
  v_mfma_f32_16x16x32_bf16 v[124:127], v[180:183], v[52:55], v[124:127]
  v_mfma_f32_16x16x32_bf16 v[152:155], v[180:183], v[56:59], v[152:155]
  v_mfma_f32_16x16x32_bf16 v[128:131], v[184:187], v[52:55], v[128:131]
  v_mfma_f32_16x16x32_bf16 v[156:159], v[184:187], v[56:59], v[156:159]
  v_mfma_f32_16x16x32_bf16 v[132:135], v[188:191], v[52:55], v[132:135]
  v_mfma_f32_16x16x32_bf16 v[160:163], v[188:191], v[56:59], v[160:163]
  v_mfma_f32_16x16x32_bf16 v[136:139], v[192:195], v[52:55], v[136:139]
  v_mfma_f32_16x16x32_bf16 v[164:167], v[192:195], v[56:59], v[164:167]
  v_mfma_f32_16x16x32_bf16 v[140:143], v[196:199], v[52:55], v[140:143]
  v_mfma_f32_16x16x32_bf16 v[168:171], v[196:199], v[56:59], v[168:171]
  s_add_u32 s56, s56, 7168
  s_add_u32 s71, s71, 1024
  s_cmp_lt_u32 s71, 20480
  s_cbranch_scc1 kp_rl3
  s_nop 7
  s_branch kp_back3
kp_load:
  s_add_u32 s36, s6, 0x2540000
  s_addc_u32 s37, s7, 0
  s_mov_b32 s38, 0x40000
  s_mov_b32 s39, 0x00020000
  v_mov_b32 v43, 1
  s_lshl_b32 s61, s41, 3
  s_and_b32 s45, s42, 7
  s_add_u32 s61, s61, s45
  s_lshl_b32 s61, s61, 4
  s_lshl_b32 s45, s67, 2
  s_add_u32 s61, s61, s45
  s_add_u32 s61, s61, s47
  s_lshl_b32 s61, s61, 2
  s_cmp_eq_u32 s40, 0
  s_cselect_b32 s61, s61, 0x70000000
  s_cselect_b32 s50, s50, 0x70000000
  s_mul_i32 s46, s40, 5120
  s_mul_i32 s48, s40, 7168
  s_add_u32 s12, s6, 0x1c00000
  s_addc_u32 s13, s7, 0
  s_mov_b32 s14, 0x6c0000
  s_mov_b32 s15, 0x00020000
  s_mul_i32 s57, s67, 3538944
  s_add_u32 s43, s46, 0
  v_add_u32 v5, s43, v9
  s_add_u32 s43, s46, 65536
  v_add_u32 v6, s43, v9
  s_add_u32 s43, s46, 131072
  v_add_u32 v7, s43, v9
  s_add_u32 s28, s6, 0x2500000
  s_addc_u32 s29, s7, 0
  s_mov_b32 s30, 0x2f800
  s_mov_b32 s31, 0x00020000
  s_lshl_b32 s43, s40, 6
  v_add_u32 v2, s43, v0
  s_lshl_b32 s43, s67, 2
  s_add_u32 s43, s43, s47
  s_mul_i32 s43, s43, 80
  s_lshl_b32 s44, s67, 3
  s_add_u32 s44, s44, s49
  s_mul_i32 s44, s44, 112
  s_add_u32 s44, s44, 560
  v_mov_b32 v3, s43
  v_mov_b32 v4, s44
  v_cmp_gt_u32 vcc, 80, v2
  s_nop 1
  v_cndmask_b32 v3, v4, v3, vcc
  v_add_lshl_u32 v3, v3, v2, 2
  v_lshlrev_b32 v2, 2, v2
  v_add_u32 v2, 143360, v2
  s_mov_b32 s43, 0
  buffer_load_dword v20, v3, s[28:31], s43 offen sc1
  s_add_u32 s43, s43, 9728
  buffer_load_dword v21, v3, s[28:31], s43 offen sc1
  s_add_u32 s43, s43, 9728
  buffer_load_dword v22, v3, s[28:31], s43 offen sc1
  s_add_u32 s43, s43, 9728
  buffer_load_dword v23, v3, s[28:31], s43 offen sc1
  s_add_u32 s43, s43, 9728
  buffer_load_dword v24, v3, s[28:31], s43 offen sc1
  s_add_u32 s43, s43, 9728
  buffer_load_dword v25, v3, s[28:31], s43 offen sc1
  s_add_u32 s43, s43, 9728
  buffer_load_dword v26, v3, s[28:31], s43 offen sc1
  s_add_u32 s43, s43, 9728
  buffer_load_dword v27, v3, s[28:31], s43 offen sc1
  s_add_u32 s43, s43, 9728
  buffer_load_dword v28, v3, s[28:31], s43 offen sc1
  s_add_u32 s43, s43, 9728
  buffer_load_dword v29, v3, s[28:31], s43 offen sc1
  s_add_u32 s43, s43, 9728
  buffer_load_dword v30, v3, s[28:31], s43 offen sc1
  s_add_u32 s43, s43, 9728
  buffer_load_dword v31, v3, s[28:31], s43 offen sc1
  s_add_u32 s43, s43, 9728
  buffer_load_dword v32, v3, s[28:31], s43 offen sc1
  s_add_u32 s43, s43, 9728
  buffer_load_dword v33, v3, s[28:31], s43 offen sc1
  s_add_u32 s43, s43, 9728
  buffer_load_dword v34, v3, s[28:31], s43 offen sc1
  s_add_u32 s43, s43, 9728
  buffer_load_dword v35, v3, s[28:31], s43 offen sc1
  s_add_u32 s43, s43, 9728
  buffer_load_dword v36, v3, s[28:31], s43 offen sc1
  s_add_u32 s43, s43, 9728
  buffer_load_dword v37, v3, s[28:31], s43 offen sc1
  s_add_u32 s43, s43, 9728
  buffer_load_dword v38, v3, s[28:31], s43 offen sc1
  s_add_u32 s43, s43, 9728
  buffer_load_dword v39, v3, s[28:31], s43 offen sc1
  s_add_u32 s43, s43, 9728
  s_waitcnt vmcnt(0)
  v_add_f32 v20, v20, v21
  v_add_f32 v20, v20, v22
  v_add_f32 v20, v20, v23
  v_add_f32 v20, v20, v24
  v_add_f32 v20, v20, v25
  v_add_f32 v20, v20, v26
  v_add_f32 v20, v20, v27
  v_add_f32 v20, v20, v28
  v_add_f32 v20, v20, v29
  v_add_f32 v20, v20, v30
  v_add_f32 v20, v20, v31
  v_add_f32 v20, v20, v32
  v_add_f32 v20, v20, v33
  v_add_f32 v20, v20, v34
  v_add_f32 v20, v20, v35
  v_add_f32 v20, v20, v36
  v_add_f32 v20, v20, v37
  v_add_f32 v20, v20, v38
  v_add_f32 v20, v20, v39
  ds_write_b32 v2, v20
  s_waitcnt lgkmcnt(0)
  s_waitcnt vmcnt(0)
  s_barrier
  s_mov_b64 exec, 1
  buffer_store_dword v43, off, s[36:39], s50 sc1
  s_mov_b64 exec, -1
  s_barrier
  s_mul_i32 s58, s47, 102400
  s_add_u32 s58, s58, s57
  s_add_u32 s58, s58, 409600
  s_add_u32 s71, s68, s40
  s_add_u32 s71, s71, 4
  s_sub_u32 s43, s71, 20
  s_cselect_b32 s71, s71, s43
  s_mul_i32 s71, s71, 5120
  s_add_u32 m0, s46, 122880
  s_add_u32 s56, s58, s71
  buffer_load_dwordx4 v9, s[12:15], s56 offen offset:0 lds
  buffer_load_dwordx4 v9, s[12:15], s56 offen offset:1024 lds
  buffer_load_dwordx4 v9, s[12:15], s56 offen offset:2048 lds
  buffer_load_dwordx4 v9, s[12:15], s56 offen offset:3072 lds
  s_add_u32 m0, s46, 126976
  s_add_u32 s56, s56, 4096
  buffer_load_dwordx4 v9, s[12:15], s56 offen offset:0 lds
  s_add_u32 s71, s68, s40
  s_add_u32 s71, s71, 8
  s_sub_u32 s43, s71, 20
  s_cselect_b32 s71, s71, s43
  s_mul_i32 s71, s71, 5120
  s_add_u32 m0, s46, 102400
  s_add_u32 s56, s58, s71
  buffer_load_dwordx4 v9, s[12:15], s56 offen offset:0 lds
  buffer_load_dwordx4 v9, s[12:15], s56 offen offset:1024 lds
  buffer_load_dwordx4 v9, s[12:15], s56 offen offset:2048 lds
  buffer_load_dwordx4 v9, s[12:15], s56 offen offset:3072 lds
  s_add_u32 m0, s46, 106496
  s_add_u32 s56, s56, 4096
  buffer_load_dwordx4 v9, s[12:15], s56 offen offset:0 lds
  s_barrier
  s_add_u32 s71, s68, s40
  s_add_u32 s71, s71, 12
  s_sub_u32 s43, s71, 20
  s_cselect_b32 s71, s71, s43
  s_mul_i32 s71, s71, 5120
  s_add_u32 m0, s46, 0
  s_add_u32 s56, s58, s71
  buffer_load_dwordx4 v9, s[12:15], s56 offen offset:0 lds
  buffer_load_dwordx4 v9, s[12:15], s56 offen offset:1024 lds
  buffer_load_dwordx4 v9, s[12:15], s56 offen offset:2048 lds
  buffer_load_dwordx4 v9, s[12:15], s56 offen offset:3072 lds
  s_add_u32 m0, s46, 4096
  s_add_u32 s56, s56, 4096
  buffer_load_dwordx4 v9, s[12:15], s56 offen offset:0 lds
  s_add_u32 s71, s68, s40
  s_add_u32 s71, s71, 16
  s_sub_u32 s43, s71, 20
  s_cselect_b32 s71, s71, s43
  s_mul_i32 s71, s71, 5120
  s_add_u32 m0, s46, 20480
  s_add_u32 s56, s58, s71
  buffer_load_dwordx4 v9, s[12:15], s56 offen offset:0 lds
  buffer_load_dwordx4 v9, s[12:15], s56 offen offset:1024 lds
  buffer_load_dwordx4 v9, s[12:15], s56 offen offset:2048 lds
  buffer_load_dwordx4 v9, s[12:15], s56 offen offset:3072 lds
  s_add_u32 m0, s46, 24576
  s_add_u32 s56, s56, 4096
  buffer_load_dwordx4 v9, s[12:15], s56 offen offset:0 lds
  s_barrier
  s_waitcnt vmcnt(0)
  s_barrier
  s_mov_b64 exec, 1
  s_add_u32 s43, s61, 0
  buffer_store_dword v43, off, s[36:39], s43 sc1
  s_mov_b64 exec, -1
  s_barrier
  s_mul_i32 s58, s47, 102400
  s_add_u32 s58, s58, s57
  s_add_u32 s58, s58, 819200
  s_add_u32 s71, s68, s40
  s_add_u32 s71, s71, 0
  s_sub_u32 s43, s71, 20
  s_cselect_b32 s71, s71, s43
  s_mul_i32 s71, s71, 5120
  s_add_u32 m0, s46, 40960
  s_add_u32 s56, s58, s71
  buffer_load_dwordx4 v9, s[12:15], s56 offen offset:0 lds
  buffer_load_dwordx4 v9, s[12:15], s56 offen offset:1024 lds
  buffer_load_dwordx4 v9, s[12:15], s56 offen offset:2048 lds
  buffer_load_dwordx4 v9, s[12:15], s56 offen offset:3072 lds
  s_add_u32 m0, s46, 45056
  s_add_u32 s56, s56, 4096
  buffer_load_dwordx4 v9, s[12:15], s56 offen offset:0 lds
  s_add_u32 s71, s68, s40
  s_add_u32 s71, s71, 4
  s_sub_u32 s43, s71, 20
  s_cselect_b32 s71, s71, s43
  s_mul_i32 s71, s71, 5120
  s_add_u32 m0, s46, 61440
  s_add_u32 s56, s58, s71
  buffer_load_dwordx4 v9, s[12:15], s56 offen offset:0 lds
  buffer_load_dwordx4 v9, s[12:15], s56 offen offset:1024 lds
  buffer_load_dwordx4 v9, s[12:15], s56 offen offset:2048 lds
  buffer_load_dwordx4 v9, s[12:15], s56 offen offset:3072 lds
  s_add_u32 m0, s46, 65536
  s_add_u32 s56, s56, 4096
  buffer_load_dwordx4 v9, s[12:15], s56 offen offset:0 lds
  s_add_u32 s71, s68, s40
  s_add_u32 s71, s71, 8
  s_sub_u32 s43, s71, 20
  s_cselect_b32 s71, s71, s43
  s_mul_i32 s71, s71, 5120
  s_add_u32 m0, s46, 81920
  s_add_u32 s56, s58, s71
  buffer_load_dwordx4 v9, s[12:15], s56 offen offset:0 lds
  buffer_load_dwordx4 v9, s[12:15], s56 offen offset:1024 lds
  buffer_load_dwordx4 v9, s[12:15], s56 offen offset:2048 lds
  buffer_load_dwordx4 v9, s[12:15], s56 offen offset:3072 lds
  s_add_u32 m0, s46, 86016
  s_add_u32 s56, s56, 4096
  buffer_load_dwordx4 v9, s[12:15], s56 offen offset:0 lds
  s_barrier
  s_add_u32 s71, s68, s40
  s_add_u32 s71, s71, 12
  s_sub_u32 s43, s71, 20
  s_cselect_b32 s71, s71, s43
  s_mul_i32 s71, s71, 5120
  s_add_u32 m0, s46, 122880
  s_add_u32 s56, s58, s71
  buffer_load_dwordx4 v9, s[12:15], s56 offen offset:0 lds
  buffer_load_dwordx4 v9, s[12:15], s56 offen offset:1024 lds
  buffer_load_dwordx4 v9, s[12:15], s56 offen offset:2048 lds
  buffer_load_dwordx4 v9, s[12:15], s56 offen offset:3072 lds
  s_add_u32 m0, s46, 126976
  s_add_u32 s56, s56, 4096
  buffer_load_dwordx4 v9, s[12:15], s56 offen offset:0 lds
  s_add_u32 s71, s68, s40
  s_add_u32 s71, s71, 16
  s_sub_u32 s43, s71, 20
  s_cselect_b32 s71, s71, s43
  s_mul_i32 s71, s71, 5120
  s_add_u32 m0, s46, 102400
  s_add_u32 s56, s58, s71
  buffer_load_dwordx4 v9, s[12:15], s56 offen offset:0 lds
  buffer_load_dwordx4 v9, s[12:15], s56 offen offset:1024 lds
  buffer_load_dwordx4 v9, s[12:15], s56 offen offset:2048 lds
  buffer_load_dwordx4 v9, s[12:15], s56 offen offset:3072 lds
  s_add_u32 m0, s46, 106496
  s_add_u32 s56, s56, 4096
  buffer_load_dwordx4 v9, s[12:15], s56 offen offset:0 lds
  s_barrier
  s_waitcnt vmcnt(0)
  s_barrier
  s_mov_b64 exec, 1
  s_add_u32 s43, s61, 8192
  buffer_store_dword v43, off, s[36:39], s43 sc1
  s_mov_b64 exec, -1
  s_barrier
  s_mul_i32 s58, s49, 143360
  s_add_u32 s58, s58, s57
  s_add_u32 s58, s58, 1228800
  s_add_u32 s71, s69, s40
  s_add_u32 s71, s71, 0
  s_sub_u32 s43, s71, 20
  s_cselect_b32 s71, s71, s43
  s_mul_i32 s71, s71, 7168
  s_add_u32 m0, s48, 0
  s_add_u32 s56, s58, s71
  buffer_load_dwordx4 v9, s[12:15], s56 offen offset:0 lds
  buffer_load_dwordx4 v9, s[12:15], s56 offen offset:1024 lds
  buffer_load_dwordx4 v9, s[12:15], s56 offen offset:2048 lds
  buffer_load_dwordx4 v9, s[12:15], s56 offen offset:3072 lds
  s_add_u32 m0, s48, 4096
  s_add_u32 s56, s56, 4096
  buffer_load_dwordx4 v9, s[12:15], s56 offen offset:0 lds
  buffer_load_dwordx4 v9, s[12:15], s56 offen offset:1024 lds
  buffer_load_dwordx4 v9, s[12:15], s56 offen offset:2048 lds
  s_add_u32 s71, s69, s40
  s_add_u32 s71, s71, 4
  s_sub_u32 s43, s71, 20
  s_cselect_b32 s71, s71, s43
  s_mul_i32 s71, s71, 7168
  s_add_u32 m0, s48, 28672
  s_add_u32 s56, s58, s71
  buffer_load_dwordx4 v9, s[12:15], s56 offen offset:0 lds
  buffer_load_dwordx4 v9, s[12:15], s56 offen offset:1024 lds
  buffer_load_dwordx4 v9, s[12:15], s56 offen offset:2048 lds
  buffer_load_dwordx4 v9, s[12:15], s56 offen offset:3072 lds
  s_add_u32 m0, s48, 32768
  s_add_u32 s56, s56, 4096
  buffer_load_dwordx4 v9, s[12:15], s56 offen offset:0 lds
  buffer_load_dwordx4 v9, s[12:15], s56 offen offset:1024 lds
  buffer_load_dwordx4 v9, s[12:15], s56 offen offset:2048 lds
  s_barrier
  s_add_u32 s71, s69, s40
  s_add_u32 s71, s71, 8
  s_sub_u32 s43, s71, 20
  s_cselect_b32 s71, s71, s43
  s_mul_i32 s71, s71, 7168
  s_add_u32 m0, s48, 57344
  s_add_u32 s56, s58, s71
  buffer_load_dwordx4 v9, s[12:15], s56 offen offset:0 lds
  buffer_load_dwordx4 v9, s[12:15], s56 offen offset:1024 lds
  buffer_load_dwordx4 v9, s[12:15], s56 offen offset:2048 lds
  buffer_load_dwordx4 v9, s[12:15], s56 offen offset:3072 lds
  s_add_u32 m0, s48, 61440
  s_add_u32 s56, s56, 4096
  buffer_load_dwordx4 v9, s[12:15], s56 offen offset:0 lds
  buffer_load_dwordx4 v9, s[12:15], s56 offen offset:1024 lds
  buffer_load_dwordx4 v9, s[12:15], s56 offen offset:2048 lds
  s_barrier
  s_add_u32 s71, s69, s40
  s_add_u32 s71, s71, 12
  s_sub_u32 s43, s71, 20
  s_cselect_b32 s71, s71, s43
  s_mul_i32 s71, s71, 7168
  s_add_u32 m0, s48, 114688
  s_add_u32 s56, s58, s71
  buffer_load_dwordx4 v9, s[12:15], s56 offen offset:0 lds
  buffer_load_dwordx4 v9, s[12:15], s56 offen offset:1024 lds
  buffer_load_dwordx4 v9, s[12:15], s56 offen offset:2048 lds
  buffer_load_dwordx4 v9, s[12:15], s56 offen offset:3072 lds
  s_add_u32 m0, s48, 118784
  s_add_u32 s56, s56, 4096
  buffer_load_dwordx4 v9, s[12:15], s56 offen offset:0 lds
  buffer_load_dwordx4 v9, s[12:15], s56 offen offset:1024 lds
  buffer_load_dwordx4 v9, s[12:15], s56 offen offset:2048 lds
  s_add_u32 s71, s69, s40
  s_add_u32 s71, s71, 16
  s_sub_u32 s43, s71, 20
  s_cselect_b32 s71, s71, s43
  s_mul_i32 s71, s71, 7168
  s_add_u32 m0, s48, 86016
  s_add_u32 s56, s58, s71
  buffer_load_dwordx4 v9, s[12:15], s56 offen offset:0 lds
  buffer_load_dwordx4 v9, s[12:15], s56 offen offset:1024 lds
  buffer_load_dwordx4 v9, s[12:15], s56 offen offset:2048 lds
  buffer_load_dwordx4 v9, s[12:15], s56 offen offset:3072 lds
  s_add_u32 m0, s48, 90112
  s_add_u32 s56, s56, 4096
  buffer_load_dwordx4 v9, s[12:15], s56 offen offset:0 lds
  buffer_load_dwordx4 v9, s[12:15], s56 offen offset:1024 lds
  buffer_load_dwordx4 v9, s[12:15], s56 offen offset:2048 lds
  s_waitcnt vmcnt(14)
  s_barrier
  s_mov_b64 exec, 1
  s_add_u32 s43, s61, 16384
  buffer_store_dword v43, off, s[36:39], s43 sc1
  s_mov_b64 exec, -1
  s_barrier
  s_mul_i32 s58, s47, 276480
  s_add_u32 s58, s58, s57
  s_add_u32 s58, s58, 2375680
  s_add_u32 s71, s70, s40
  s_add_u32 s71, s71, 0
  s_sub_u32 s43, s71, 54
  s_cselect_b32 s71, s71, s43
  s_mul_i32 s71, s71, 5120
  s_add_u32 m0, s46, 0
  s_add_u32 s56, s58, s71
  buffer_load_dwordx4 v9, s[12:15], s56 offen offset:0 lds
  buffer_load_dwordx4 v9, s[12:15], s56 offen offset:1024 lds
  buffer_load_dwordx4 v9, s[12:15], s56 offen offset:2048 lds
  buffer_load_dwordx4 v9, s[12:15], s56 offen offset:3072 lds
  s_add_u32 m0, s46, 4096
  s_add_u32 s56, s56, 4096
  buffer_load_dwordx4 v9, s[12:15], s56 offen offset:0 lds
  s_waitcnt vmcnt(12)
  s_barrier
  s_add_u32 s71, s70, s40
  s_add_u32 s71, s71, 4
  s_sub_u32 s43, s71, 54
  s_cselect_b32 s71, s71, s43
  s_mul_i32 s71, s71, 5120
  s_add_u32 m0, s46, 20480
  s_add_u32 s56, s58, s71
  buffer_load_dwordx4 v9, s[12:15], s56 offen offset:0 lds
  buffer_load_dwordx4 v9, s[12:15], s56 offen offset:1024 lds
  buffer_load_dwordx4 v9, s[12:15], s56 offen offset:2048 lds
  buffer_load_dwordx4 v9, s[12:15], s56 offen offset:3072 lds
  s_add_u32 m0, s46, 24576
  s_add_u32 s56, s56, 4096
  buffer_load_dwordx4 v9, s[12:15], s56 offen offset:0 lds
  s_waitcnt vmcnt(10)
  s_barrier
  s_add_u32 s71, s70, s40
  s_add_u32 s71, s71, 8
  s_sub_u32 s43, s71, 54
  s_cselect_b32 s71, s71, s43
  s_mul_i32 s71, s71, 5120
  s_add_u32 m0, s46, 40960
  s_add_u32 s56, s58, s71
  buffer_load_dwordx4 v9, s[12:15], s56 offen offset:0 lds
  buffer_load_dwordx4 v9, s[12:15], s56 offen offset:1024 lds
  buffer_load_dwordx4 v9, s[12:15], s56 offen offset:2048 lds
  buffer_load_dwordx4 v9, s[12:15], s56 offen offset:3072 lds
  s_add_u32 m0, s46, 45056
  s_add_u32 s56, s56, 4096
  buffer_load_dwordx4 v9, s[12:15], s56 offen offset:0 lds
  s_add_u32 s71, s70, s40
  s_add_u32 s71, s71, 12
  s_sub_u32 s43, s71, 54
  s_cselect_b32 s71, s71, s43
  s_mul_i32 s71, s71, 5120
  s_add_u32 m0, s46, 61440
  s_add_u32 s56, s58, s71
  buffer_load_dwordx4 v9, s[12:15], s56 offen offset:0 lds
  buffer_load_dwordx4 v9, s[12:15], s56 offen offset:1024 lds
  buffer_load_dwordx4 v9, s[12:15], s56 offen offset:2048 lds
  buffer_load_dwordx4 v9, s[12:15], s56 offen offset:3072 lds
  s_add_u32 m0, s46, 65536
  s_add_u32 s56, s56, 4096
  buffer_load_dwordx4 v9, s[12:15], s56 offen offset:0 lds
  s_barrier
  s_add_u32 s71, s70, s40
  s_add_u32 s71, s71, 16
  s_sub_u32 s43, s71, 54
  s_cselect_b32 s71, s71, s43
  s_mul_i32 s71, s71, 5120
  s_add_u32 m0, s46, 81920
  s_add_u32 s56, s58, s71
  buffer_load_dwordx4 v9, s[12:15], s56 offen offset:0 lds
  buffer_load_dwordx4 v9, s[12:15], s56 offen offset:1024 lds
  buffer_load_dwordx4 v9, s[12:15], s56 offen offset:2048 lds
  buffer_load_dwordx4 v9, s[12:15], s56 offen offset:3072 lds
  s_add_u32 m0, s46, 86016
  s_add_u32 s56, s56, 4096
  buffer_load_dwordx4 v9, s[12:15], s56 offen offset:0 lds
  s_add_u32 s71, s70, s40
  s_add_u32 s71, s71, 20
  s_sub_u32 s43, s71, 54
  s_cselect_b32 s71, s71, s43
  s_mul_i32 s71, s71, 5120
  s_add_u32 m0, s46, 102400
  s_add_u32 s56, s58, s71
  buffer_load_dwordx4 v9, s[12:15], s56 offen offset:0 lds
  buffer_load_dwordx4 v9, s[12:15], s56 offen offset:1024 lds
  buffer_load_dwordx4 v9, s[12:15], s56 offen offset:2048 lds
  buffer_load_dwordx4 v9, s[12:15], s56 offen offset:3072 lds
  s_add_u32 m0, s46, 106496
  s_add_u32 s56, s56, 4096
  buffer_load_dwordx4 v9, s[12:15], s56 offen offset:0 lds
  s_add_u32 s71, s70, s40
  s_add_u32 s71, s71, 24
  s_sub_u32 s43, s71, 54
  s_cselect_b32 s71, s71, s43
  s_mul_i32 s71, s71, 5120
  s_add_u32 m0, s46, 122880
  s_add_u32 s56, s58, s71
  buffer_load_dwordx4 v9, s[12:15], s56 offen offset:0 lds
  buffer_load_dwordx4 v9, s[12:15], s56 offen offset:1024 lds
  buffer_load_dwordx4 v9, s[12:15], s56 offen offset:2048 lds
  buffer_load_dwordx4 v9, s[12:15], s56 offen offset:3072 lds
  s_add_u32 m0, s46, 126976
  s_add_u32 s56, s56, 4096
  buffer_load_dwordx4 v9, s[12:15], s56 offen offset:0 lds
  s_add_u32 s71, s70, s40
  s_add_u32 s71, s71, 28
  s_sub_u32 s43, s71, 54
  s_cselect_b32 s71, s71, s43
  s_mul_i32 s71, s71, 5120
  s_add_u32 m0, s46, 143360
  s_add_u32 s56, s58, s71
  buffer_load_dwordx4 v9, s[12:15], s56 offen offset:0 lds
  buffer_load_dwordx4 v9, s[12:15], s56 offen offset:1024 lds
  buffer_load_dwordx4 v9, s[12:15], s56 offen offset:2048 lds
  buffer_load_dwordx4 v9, s[12:15], s56 offen offset:3072 lds
  s_add_u32 m0, s46, 147456
  s_add_u32 s56, s56, 4096
  buffer_load_dwordx4 v9, s[12:15], s56 offen offset:0 lds
  s_waitcnt vmcnt(20)
  s_barrier
  s_barrier
  s_add_u32 s71, s70, s40
  s_add_u32 s71, s71, 32
  s_sub_u32 s43, s71, 54
  s_cselect_b32 s71, s71, s43
  s_mul_i32 s71, s71, 5120
  s_add_u32 m0, s46, 0
  s_add_u32 s56, s58, s71
  buffer_load_dwordx4 v9, s[12:15], s56 offen offset:0 lds
  buffer_load_dwordx4 v9, s[12:15], s56 offen offset:1024 lds
  buffer_load_dwordx4 v9, s[12:15], s56 offen offset:2048 lds
  buffer_load_dwordx4 v9, s[12:15], s56 offen offset:3072 lds
  s_add_u32 m0, s46, 4096
  s_add_u32 s56, s56, 4096
  buffer_load_dwordx4 v9, s[12:15], s56 offen offset:0 lds
  s_barrier
  s_add_u32 s71, s70, s40
  s_add_u32 s71, s71, 36
  s_sub_u32 s43, s71, 54
  s_cselect_b32 s71, s71, s43
  s_mul_i32 s71, s71, 5120
  s_add_u32 m0, s46, 20480
  s_add_u32 s56, s58, s71
  buffer_load_dwordx4 v9, s[12:15], s56 offen offset:0 lds
  buffer_load_dwordx4 v9, s[12:15], s56 offen offset:1024 lds
  buffer_load_dwordx4 v9, s[12:15], s56 offen offset:2048 lds
  buffer_load_dwordx4 v9, s[12:15], s56 offen offset:3072 lds
  s_add_u32 m0, s46, 24576
  s_add_u32 s56, s56, 4096
  buffer_load_dwordx4 v9, s[12:15], s56 offen offset:0 lds
  s_waitcnt vmcnt(25)
  s_barrier
  s_add_u32 s71, s70, s40
  s_add_u32 s71, s71, 40
  s_sub_u32 s43, s71, 54
  s_cselect_b32 s71, s71, s43
  s_mul_i32 s71, s71, 5120
  s_add_u32 m0, s46, 40960
  s_add_u32 s56, s58, s71
  buffer_load_dwordx4 v9, s[12:15], s56 offen offset:0 lds
  buffer_load_dwordx4 v9, s[12:15], s56 offen offset:1024 lds
  buffer_load_dwordx4 v9, s[12:15], s56 offen offset:2048 lds
  buffer_load_dwordx4 v9, s[12:15], s56 offen offset:3072 lds
  s_add_u32 m0, s46, 45056
  s_add_u32 s56, s56, 4096
  buffer_load_dwordx4 v9, s[12:15], s56 offen offset:0 lds
  s_waitcnt vmcnt(25)
  s_barrier
  s_add_u32 s71, s70, s40
  s_add_u32 s71, s71, 44
  s_sub_u32 s43, s71, 54
  s_cselect_b32 s71, s71, s43
  s_mul_i32 s71, s71, 5120
  s_add_u32 m0, s46, 61440
  s_add_u32 s56, s58, s71
  buffer_load_dwordx4 v9, s[12:15], s56 offen offset:0 lds
  buffer_load_dwordx4 v9, s[12:15], s56 offen offset:1024 lds
  buffer_load_dwordx4 v9, s[12:15], s56 offen offset:2048 lds
  buffer_load_dwordx4 v9, s[12:15], s56 offen offset:3072 lds
  s_add_u32 m0, s46, 65536
  s_add_u32 s56, s56, 4096
  buffer_load_dwordx4 v9, s[12:15], s56 offen offset:0 lds
  s_waitcnt vmcnt(25)
  s_barrier
  s_add_u32 s71, s70, s40
  s_add_u32 s71, s71, 48
  s_sub_u32 s43, s71, 54
  s_cselect_b32 s71, s71, s43
  s_mul_i32 s71, s71, 5120
  s_add_u32 m0, s46, 81920
  s_add_u32 s56, s58, s71
  buffer_load_dwordx4 v9, s[12:15], s56 offen offset:0 lds
  buffer_load_dwordx4 v9, s[12:15], s56 offen offset:1024 lds
  buffer_load_dwordx4 v9, s[12:15], s56 offen offset:2048 lds
  buffer_load_dwordx4 v9, s[12:15], s56 offen offset:3072 lds
  s_add_u32 m0, s46, 86016
  s_add_u32 s56, s56, 4096
  buffer_load_dwordx4 v9, s[12:15], s56 offen offset:0 lds
  s_waitcnt vmcnt(25)
  s_barrier
  s_add_u32 s71, s70, s40
  s_add_u32 s71, s71, 52
  s_sub_u32 s43, s71, 54
  s_cselect_b32 s71, s71, s43
  s_mul_i32 s71, s71, 5120
  s_add_u32 m0, s46, 102400
  s_add_u32 s56, s58, s71
  buffer_load_dwordx4 v9, s[12:15], s56 offen offset:0 lds
  buffer_load_dwordx4 v9, s[12:15], s56 offen offset:1024 lds
  buffer_load_dwordx4 v9, s[12:15], s56 offen offset:2048 lds
  buffer_load_dwordx4 v9, s[12:15], s56 offen offset:3072 lds
  s_add_u32 m0, s46, 106496
  s_add_u32 s56, s56, 4096
  buffer_load_dwordx4 v9, s[12:15], s56 offen offset:0 lds
  s_waitcnt vmcnt(25)
  s_barrier
  s_waitcnt vmcnt(20)
  s_barrier
  s_waitcnt vmcnt(15)
  s_barrier
  s_waitcnt vmcnt(10)
  s_barrier
  s_waitcnt vmcnt(5)
  s_barrier
  s_waitcnt vmcnt(0)
  s_barrier
  s_barrier
kp_end:
  s_endpgm
k2_hook1:
  s_mov_b32 s73, 2
  s_setprio 2
  s_cmp_ge_u32 s66, 4
  s_cbranch_scc1 k2_loop
  s_add_u32 s24, s6, 0x2500000
  s_addc_u32 s25, s7, 0
  s_mov_b32 s26, 0x2f800
  s_mov_b32 s27, 0x00020000
  s_waitcnt vmcnt(0)
  ds_read_b64_tr_b16 v[144:145], v142 offset:0
  ds_read_b64_tr_b16 v[146:147], v142 offset:512
  ds_read_b64_tr_b16 v[148:149], v142 offset:32
  ds_read_b64_tr_b16 v[150:151], v142 offset:544
  ds_read_b64_tr_b16 v[152:153], v142 offset:64
  ds_read_b64_tr_b16 v[154:155], v142 offset:576
  ds_read_b64_tr_b16 v[156:157], v142 offset:96
  ds_read_b64_tr_b16 v[158:159], v142 offset:608
  s_waitcnt lgkmcnt(0)
  buffer_store_dwordx4 v[144:147], v143, s[20:23], s56 offen sc1
  v_mfma_f32_16x16x32_bf16 v[180:183], v[144:147], v[176:179], 0
  buffer_store_dwordx4 v[148:151], v143, s[20:23], s57 offen sc1
  v_mfma_f32_16x16x32_bf16 v[184:187], v[148:151], v[176:179], 0
  buffer_store_dwordx4 v[152:155], v143, s[20:23], s58 offen sc1
  v_mfma_f32_16x16x32_bf16 v[188:191], v[152:155], v[176:179], 0
  buffer_store_dwordx4 v[156:159], v143, s[20:23], s59 offen sc1
  v_mfma_f32_16x16x32_bf16 v[192:195], v[156:159], v[176:179], 0
  ds_read_b64_tr_b16 v[160:161], v142 offset:4096
  ds_read_b64_tr_b16 v[162:163], v142 offset:4608
  ds_read_b64_tr_b16 v[164:165], v142 offset:4128
  ds_read_b64_tr_b16 v[166:167], v142 offset:4640
  ds_read_b64_tr_b16 v[168:169], v142 offset:4160
  ds_read_b64_tr_b16 v[170:171], v142 offset:4672
  ds_read_b64_tr_b16 v[172:173], v142 offset:4192
  ds_read_b64_tr_b16 v[174:175], v142 offset:4704
  s_waitcnt lgkmcnt(0)
  buffer_store_dwordx4 v[160:163], v143, s[20:23], s60 offen sc1
  v_mfma_f32_16x16x32_bf16 v[196:199], v[160:163], v[176:179], 0
  buffer_store_dwordx4 v[164:167], v143, s[20:23], s61 offen sc1
  v_mfma_f32_16x16x32_bf16 v[200:203], v[164:167], v[176:179], 0
  buffer_store_dwordx4 v[168:171], v143, s[20:23], s62 offen sc1
  v_mfma_f32_16x16x32_bf16 v[204:207], v[168:171], v[176:179], 0
  buffer_store_dwordx4 v[172:175], v143, s[20:23], s63 offen sc1
  v_mfma_f32_16x16x32_bf16 v[208:211], v[172:175], v[176:179], 0
  s_mov_b32 exec_lo, 0x00010001
  s_mov_b32 exec_hi, 0x00010001
  buffer_store_dwordx4 v[180:183], v0, s[24:27], s42 offen offset:0 sc1
  buffer_store_dwordx4 v[184:187], v0, s[24:27], s42 offen offset:64 sc1
  buffer_store_dwordx4 v[188:191], v0, s[24:27], s42 offen offset:128 sc1
  buffer_store_dwordx4 v[192:195], v0, s[24:27], s42 offen offset:192 sc1
  buffer_store_dwordx4 v[196:199], v0, s[24:27], s43 offen offset:0 sc1
  buffer_store_dwordx4 v[200:203], v0, s[24:27], s43 offen offset:64 sc1
  buffer_store_dwordx4 v[204:207], v0, s[24:27], s43 offen offset:128 sc1
  buffer_store_dwordx4 v[208:211], v0, s[24:27], s43 offen offset:192 sc1
  s_mov_b64 exec, -1
  s_branch k2_loop
k2_hook2:
  s_mov_b32 s73, 1
  s_setprio 2
  s_cmp_ge_u32 s66, 4
  s_cbranch_scc1 k2_loop
  s_and_b32 s70, s2, 63
  s_lshl_b32 s70, s70, 7
  s_add_u32 s70, s70, 49152
  v_mov_b32 v1, 1
  s_mov_b64 exec, 1
  s_waitcnt vmcnt(0)
  buffer_atomic_add v1, off, s[28:31], s70 sc1
  s_mov_b64 exec, -1
  s_branch k2_loop
k2_hook3:
  s_mov_b32 s73, 2
  s_setprio 1
  s_lshr_b32 s70, s2, 3
  s_lshl_b32 s70, s70, 2
  s_add_u32 s70, s70, s66
  s_sub_u32 s70, s70, 4
  s_cmp_lt_u32 s66, 4
  s_cbranch_scc1 k2_nocpf
  s_cmp_ge_u32 s70, (code_end-k2_loop)>>13
  s_cbranch_scc1 k2_nocpf
  s_getpc_b64 s[82:83]
k2_pcref:
  s_sub_u32 s82, s82, k2_pcref-k2_loop
  s_subb_u32 s83, s83, 0
  s_lshl_b32 s70, s70, 13
  v_lshl_add_u32 v23, v0, 7, s70
  global_load_dword v22, v23, s[82:83]
k2_nocpf:
  s_cmp_ge_u32 s66, 4
  s_cbranch_scc1 k2_loop
  s_branch k2_loop
k2_hook4:
  s_mov_b32 s73, 1
  s_setprio 0
  s_cmp_lt_u32 s66, 4
  s_cbranch_scc1 k2_loop
  s_and_b32 s70, s2, 63
  s_lshl_b32 s70, s70, 7
  s_add_u32 s70, s70, 40960
  v_mov_b32 v1, 1
  s_mov_b64 exec, 1
  s_waitcnt vmcnt(0)
  buffer_atomic_add v1, off, s[28:31], s70 sc1
  s_mov_b64 exec, -1
  s_branch k2_loop
k2_fwait:
  s_mov_b32 s72, 400000
k2_fw1:
  buffer_load_dword v22, v23, s[28:31], 0 offen sc1
  s_sub_u32 s72, s72, 1
  s_cbranch_scc1 kp_end
  s_waitcnt vmcnt(0)
  v_cmp_gt_u32 vcc, 16, v22
  s_cbranch_vccnz k2_fw1
  s_branch k2_fok
k2_fallback:
  v_lshlrev_b32 v13, 3, v10
  v_mul_u32_u24 v14, 320, v11
  v_lshl_add_u32 v14, v10, 4, v14
  v_mov_b32 v5, 0xff800000
  s_mov_b32 s70, 0
k2_fb1:
  buffer_load_dwordx4 v[104:107], v9, s[8:11], s70 offen
  buffer_load_dwordx2 v[112:113], v13, s[8:11], s70 offen offset:1024
  s_waitcnt vmcnt(0)
  v_mfma_f32_32x32x8_bf16 v[56:71], v[112:113], v[20:21], 0
  v_mfma_f32_32x32x16_bf16 v[56:71], v[104:107], v[16:19], v[56:71]
  s_nop 11
  v_max3_f32 v5, v56, v57, v5
  v_max3_f32 v5, v58, v59, v5
  v_max3_f32 v5, v60, v61, v5
  v_max3_f32 v5, v62, v63, v5
  v_max3_f32 v5, v64, v65, v5
  v_max3_f32 v5, v66, v67, v5
  v_max3_f32 v5, v68, v69, v5
  v_max3_f32 v5, v70, v71, v5
  s_add_u32 s70, s70, 2560
  s_cmp_lt_u32 s70, 163840
  s_cbranch_scc1 k2_fb1
  v_mov_b32 v6, v5
  s_nop 1
  v_permlane32_swap_b32 v5, v6
  v_max_f32 v5, v5, v6
  v_sub_f32 v24, 0, v5
  v_mov_b32 v40, 0
  v_sub_f32 v25, 0, v5
  v_mov_b32 v41, 0
  v_sub_f32 v26, 0, v5
  v_mov_b32 v42, 0
  v_sub_f32 v27, 0, v5
  v_mov_b32 v43, 0
  v_sub_f32 v28, 0, v5
  v_mov_b32 v44, 0
  v_sub_f32 v29, 0, v5
  v_mov_b32 v45, 0
  v_sub_f32 v30, 0, v5
  v_mov_b32 v46, 0
  v_sub_f32 v31, 0, v5
  v_mov_b32 v47, 0
  v_sub_f32 v32, 0, v5
  v_mov_b32 v48, 0
  v_sub_f32 v33, 0, v5
  v_mov_b32 v49, 0
  v_sub_f32 v34, 0, v5
  v_mov_b32 v50, 0
  v_sub_f32 v35, 0, v5
  v_mov_b32 v51, 0
  v_sub_f32 v36, 0, v5
  v_mov_b32 v52, 0
  v_sub_f32 v37, 0, v5
  v_mov_b32 v53, 0
  v_sub_f32 v38, 0, v5
  v_mov_b32 v54, 0
  v_sub_f32 v39, 0, v5
  v_mov_b32 v55, 0
  s_mov_b32 s70, 0
k2_fb2:
  buffer_load_dwordx4 v[104:107], v9, s[8:11], s70 offen
  buffer_load_dwordx2 v[112:113], v13, s[8:11], s70 offen offset:1024
  s_mov_b64 exec, s[80:81]
  buffer_load_dwordx4 v[116:119], v14, s[8:11], s70 offen offset:1280
  buffer_load_dwordx4 v[120:123], v14, s[8:11], s70 offen offset:1920
  s_mov_b64 exec, -1
  s_waitcnt vmcnt(0)
  v_mfma_f32_32x32x8_bf16 v[56:71], v[112:113], v[20:21], v[24:39]
  v_mfma_f32_32x32x16_bf16 v[56:71], v[104:107], v[16:19], v[56:71]
  s_nop 11
  v_exp_f32 v56, v56
  v_exp_f32 v57, v57
  v_exp_f32 v58, v58
  v_exp_f32 v59, v59
  v_exp_f32 v60, v60
  v_exp_f32 v61, v61
  v_exp_f32 v62, v62
  v_exp_f32 v63, v63
  v_exp_f32 v64, v64
  v_exp_f32 v65, v65
  v_exp_f32 v66, v66
  v_exp_f32 v67, v67
  v_exp_f32 v68, v68
  v_exp_f32 v69, v69
  v_exp_f32 v70, v70
  v_exp_f32 v71, v71
  v_cvt_pk_bf16_f32 v88, v56, v57
  v_cvt_pk_bf16_f32 v89, v58, v59
  v_cvt_pk_bf16_f32 v90, v60, v61
  v_cvt_pk_bf16_f32 v91, v62, v63
  v_cvt_pk_bf16_f32 v92, v64, v65
  v_cvt_pk_bf16_f32 v93, v66, v67
  v_cvt_pk_bf16_f32 v94, v68, v69
  v_cvt_pk_bf16_f32 v95, v70, v71
  v_mfma_f32_32x32x16_bf16 v[40:55], v[116:119], v[88:91], v[40:55]
  s_nop 0
  v_mfma_f32_32x32x16_bf16 v[40:55], v[120:123], v[92:95], v[40:55]
  s_add_u32 s70, s70, 2560
  s_cmp_lt_u32 s70, 163840
  s_cbranch_scc1 k2_fb2
  s_nop 15
  v_mov_b32 v3, v48
  v_mov_b32 v4, v48
  s_nop 1
  v_permlane32_swap_b32 v3, v4
  s_branch k2_final
code_end:
  s_endpgm
.section .rodata,"a"
.p2align 6
.amdhsa_kernel sequential_preLN__mha_block__mixer_s_mlp__prompt_kernel
  .amdhsa_next_free_vgpr 256
  .amdhsa_next_free_sgpr 88
  .amdhsa_accum_offset 256
  .amdhsa_group_segment_fixed_size 0
  .amdhsa_kernarg_size 88
  .amdhsa_user_sgpr_count 2
  .amdhsa_user_sgpr_kernarg_segment_ptr 1
  .amdhsa_system_sgpr_workgroup_id_x 1
.end_amdhsa_kernel
```
